```python
import torch

def _softmax(x, axis=-1):
    return torch.softmax(x, dim=axis)
def _gelu(x):
    return torch.nn.functional.gelu(x, approximate="tanh")
def _silu(x):
    return torch.nn.functional.silu(x)
def _sigmoid(x):
    return torch.sigmoid(x)
def _layernorm(x, axis=-1, eps=1e-5):
    m = x.mean(dim=axis, keepdim=True)
    v = x.var(dim=axis, keepdim=True, unbiased=False)
    return (x - m) / torch.sqrt(v + eps)
def _scatter_add(tgt, idx, src, axis=0):
    return tgt.clone().index_add_(axis, idx, src)
def _segment_sum(src, seg, n):
    out = torch.zeros((n,) + src.shape[1:], dtype=src.dtype)
    return out.index_add_(0, seg, src)
def _pad(x, pw):
    flat = tuple(v for pair in reversed(pw) for v in pair)
    return torch.nn.functional.pad(x, flat)

kernel_name = 'parallel_sum__linear_attn_block__moe_arch_mod__prompt'

def setup_inputs():

    _w = (lambda a: (lambda t: t.to(torch.bfloat16) if t.is_floating_point() else t)(torch.as_tensor(a)))
    def _A_setup():
        B, S, D = 1, 2048, 1024
        return {
            "x": _w((lambda *s: torch.randn(*s, dtype=torch.bfloat16) * 0.05)(B, S, D)),
            "wqkv": _w((lambda *s: torch.randn(*s, dtype=torch.bfloat16) * 0.4)(D, 3 * D)),
            "wo": _w((lambda *s: torch.randn(*s, dtype=torch.bfloat16) * 0.2)(D, D)),
        }
    _A_in = _A_setup()

    def _B_setup():
        B, S, D, F, C = 1, 2048, 1024, 3584, 1
        return {
            "x": _w((lambda *s: torch.randn(*s, dtype=torch.bfloat16) * 0.05)(B, S, D)),
            "w_r": _w((lambda *s: torch.randn(*s, dtype=torch.bfloat16) * 0.05)(D)),
            "w_gate": _w((lambda *s: torch.randn(*s, dtype=torch.bfloat16) * 0.05)(D, F)),
            "w_up": _w((lambda *s: torch.randn(*s, dtype=torch.bfloat16) * 0.05)(D, F)),
            "w_down": _w((lambda *s: torch.randn(*s, dtype=torch.bfloat16) * 0.05)(F, D)),
        }
    _B_in = _B_setup()

    return {
        "A_x": _A_in["x"],
        "A_wqkv": _A_in["wqkv"],
        "A_wo": _A_in["wo"],
        "B_x": _B_in["x"],
        "B_w_r": _B_in["w_r"],
        "B_w_gate": _B_in["w_gate"],
        "B_w_up": _B_in["w_up"],
        "B_w_down": _B_in["w_down"],
    }

def reference(A_x, A_wqkv, A_wo, B_x, B_w_r, B_w_gate, B_w_up, B_w_down):
    def _A_ref(x, wqkv, wo):
        B, S, D = x.shape
        H = 32; Dh = D // H
        qkv = (lambda x, *d: x.permute(*d))((x @ wqkv).reshape(B, S, 3, H, Dh), 2, 0, 3, 1, 4)
        q, k, v = qkv[0], qkv[1], qkv[2]
        phi = lambda t: torch.where(t > 0, t + 1, torch.exp(t)) + 1e-6
        pq, pk = phi(q), phi(k)
        kv = torch.einsum("bhsd,bhse->bhde", pk, v)
        z = torch.einsum("bhsd->bhd", pk)
        num = torch.einsum("bhqd,bhde->bhqe", pq, kv)
        den = torch.einsum("bhqd,bhd->bhq", pq, z)[..., None] + 1e-6
        o = num / den
        return (lambda x, *d: x.permute(*d))(o, 0, 2, 1, 3).reshape(B, S, D) @ wo

    def _B_ref(x, w_r, w_gate, w_up, w_down):
        B, S, D = x.shape
        C = 1
        r = x @ w_r
        idx = torch.argsort(-r, axis=-1)[:, :C]
        idx_e = (lambda x, n, axis: torch.repeat_interleave(x, n, dim=axis))(idx.reshape(B, C, 1), D, axis=2)
        x_sel = (lambda x, i, axis: torch.take_along_dim(x, i, dim=axis))(x, idx_e, axis=1)
        g = _silu(x_sel @ w_gate)
        u = x_sel @ w_up
        y = (g * u) @ w_down
        r_sel = _sigmoid((lambda x, i, axis: torch.take_along_dim(x, i, dim=axis))(r, idx, axis=1))
        y = y * r_sel.reshape(B, C, 1)
        b_off = (torch.arange(B) * S).reshape(B, 1)
        flat_idx = (idx + b_off).reshape(B * C)
        zero = (x * 0.0).reshape(B * S, D)
        upd = _scatter_add(zero, flat_idx, y.reshape(B * C, D), axis=0)
        return x + upd.reshape(B, S, D)

    x = A_x
    xn = _layernorm(x, axis=-1)
    return x + _A_ref(xn, A_wqkv, A_wo) + _B_ref(xn, B_w_r, B_w_gate, B_w_up, B_w_down)
```

```asm
; @launch grid=(256,1,1) block=(512,1,1) lds=158720
.amdgcn_target "amdgcn-amd-amdhsa--gfx950"
.text
.globl parallel_sum__linear_attn_block__moe_arch_mod__prompt_kernel
.p2align 8
.type parallel_sum__linear_attn_block__moe_arch_mod__prompt_kernel,@function
parallel_sum__linear_attn_block__moe_arch_mod__prompt_kernel:
    s_cmp_ge_u32 s2, 256
    s_cbranch_scc1 L_end
    s_load_dwordx4 s[4:7], s[0:1], 0
    s_load_dwordx2 s[56:57], s[0:1], 16
    s_load_dwordx8 s[60:67], s[0:1], 32
    s_load_dwordx4 s[68:71], s[0:1], 64
    s_load_dwordx2 s[72:73], s[0:1], 80
    v_lshrrev_b32 v2, 6, v0
    v_and_b32 v1, 63, v0
    s_and_b32 s20, s2, 7
    v_readfirstlane_b32 s26, v2
    s_lshr_b32 s21, s2, 3
    s_and_b32 s24, s21, 7
    s_lshr_b32 s25, s21, 3
    s_and_b32 s30, s20, 1
    s_lshl_b32 s22, s30, 3
    s_add_u32 s22, s22, s24
    s_lshr_b32 s31, s20, 1
    s_lshl_b32 s23, s31, 2
    s_add_u32 s23, s23, s25
    s_and_b32 s27, s26, 3
    s_lshl_b32 s28, s30, 3
    s_and_b32 s58, s31, 1
    s_lshl_b32 s58, s58, 2
    s_add_u32 s28, s28, s58
    s_and_b32 s58, s21, 3
    s_add_u32 s28, s28, s58
    s_lshr_b32 s29, s20, 2
    s_lshl_b32 s29, s29, 3
    s_lshr_b32 s58, s21, 2
    s_add_u32 s29, s29, s58
    s_cmp_gt_u32 s23, 3
    s_subb_u32 s33, s23, 0
    s_cmp_gt_u32 s23, 11
    s_subb_u32 s33, s33, 0
    s_lshl_b32 s33, s33, 4
    s_add_u32 s33, s33, s22
    s_and_b32 s58, s23, 7
    s_cmp_eq_u32 s58, 3
    s_cselect_b32 s3, 255, s33
    s_waitcnt lgkmcnt(0)
    s_mov_b32 s8, s4
    s_mov_b32 s9, s5
    s_mov_b32 s10, 0x400000
    s_mov_b32 s11, 0x20000
    s_mov_b32 s12, s6
    s_mov_b32 s13, s7
    s_mov_b32 s14, 0x600000
    s_mov_b32 s15, 0x20000
    s_mov_b32 s16, s72
    s_mov_b32 s17, s73
    s_mov_b32 s18, 0x1000000
    s_mov_b32 s19, 0x20000
    s_cmp_ge_u32 s26, 4
    s_cbranch_scc1 L_helper
    s_mov_b32 s44, s60
    s_mov_b32 s45, s61
    s_mov_b32 s46, 0x800
    s_mov_b32 s47, 0x20000
    v_and_b32 v2, 31, v1
    v_lshlrev_b32 v2, 4, v2
    v_lshrrev_b32 v3, 5, v1
    v_lshl_add_u32 v4, v3, 11, v2
    s_lshl_b32 s85, s22, 7
    s_lshl_b32 s58, s23, 3
    s_add_u32 s85, s85, s58
    s_lshl_b32 s58, s27, 1
    s_add_u32 s85, s85, s58
    s_lshl_b32 s58, s85, 11
    buffer_load_dwordx4 v[192:195], v4, s[8:11], s58 offen offset:0
    buffer_load_dwordx4 v[196:199], v4, s[8:11], s58 offen offset:512
    buffer_load_dwordx4 v[200:203], v4, s[8:11], s58 offen offset:1024
    buffer_load_dwordx4 v[204:207], v4, s[8:11], s58 offen offset:1536
    buffer_load_dwordx4 v[208:211], v2, s[44:47], 0 offen offset:0
    buffer_load_dwordx4 v[212:215], v2, s[44:47], 0 offen offset:512
    buffer_load_dwordx4 v[216:219], v2, s[44:47], 0 offen offset:1024
    buffer_load_dwordx4 v[220:223], v2, s[44:47], 0 offen offset:1536
    s_branch L_kwave
L_helper:
    s_mov_b32 s48, s70
    s_mov_b32 s49, s71
    s_mov_b32 s50, 0x100
    s_mov_b32 s51, 0x20000
    s_or_b32 s58, s2, s27
    s_cmp_eq_u32 s58, 0
    s_cbranch_scc0 L_notag
    s_memrealtime s[58:59]
    v_lshlrev_b32 v2, 20, v1
    s_waitcnt lgkmcnt(0)
    s_lshl_b32 s58, s58, 1
    s_or_b32 s58, s58, 1
    v_mov_b32 v3, s58
    buffer_store_dword v3, v2, s[48:51], 0 offen sc1
L_notag:
    v_lshrrev_b32 v10, 3, v1
    v_lshrrev_b32 v11, 4, v1
    s_and_b32 s58, s27, 1
    s_lshl_b32 s59, s58, 2
    v_add_u32 v12, s59, v11
    v_and_b32 v13, 7, v1
    v_xor_b32 v12, v12, v13
    v_lshlrev_b32 v10, 11, v10
    v_lshl_add_u32 v62, v12, 4, v10
    v_and_b32 v14, 3, v1
    v_lshlrev_b32 v14, 4, v14
    v_bfe_u32 v15, v1, 4, 1
    v_lshl_add_u32 v14, v15, 6, v14
    v_bfe_u32 v15, v1, 2, 2
    v_lshrrev_b32 v16, 5, v1
    v_mul_u32_u24 v17, 6144, v15
    v_add_u32 v17, v17, v14
    v_lshl_add_u32 v63, v16, 11, v17
    v_mul_u32_u24 v16, 24576, v16
    v_add_u32 v6, v16, v17
    s_lshr_b32 s59, s27, 1
    s_lshl_b32 s59, s59, 5
    v_xor_b32 v63, s59, v63
    s_lshl_b32 s59, s58, 5
    v_xor_b32 v6, s59, v6
    s_sub_u32 s74, s24, s25
    s_and_b32 s74, s74, 3
    s_mov_b32 s76, 1703092544
    s_mov_b32 s77, 4275808711
    s_cmp_eq_u32 s74, 1
    s_cselect_b32 s76, 1766008065, s76
    s_cselect_b32 s77, 4274761095, s77
    s_cmp_eq_u32 s74, 2
    s_cselect_b32 s76, 2772656386, s76
    s_cselect_b32 s77, 4257999239, s77
    s_cmp_eq_u32 s74, 3
    s_cselect_b32 s76, 1699160323, s76
    s_cselect_b32 s77, 3989809547, s77
    s_lshl_b32 s75, s30, 1
    s_add_u32 s75, s75, s31
    s_lshl_b32 s75, s75, 2
    s_lshl_b32 s58, s23, 7
    s_xor_b32 s58, s58, 128
    s_mul_i32 s79, s27, 49152
    s_add_u32 s79, s79, s58
    s_lshl_b32 s80, s27, 10
    s_mov_b64 s[72:73], s[76:77]
    s_lshl_b32 s58, s23, 7
    s_mul_i32 s78, s27, 24576
    s_add_u32 s78, s78, s58
    s_add_u32 s78, s78, 2048
    s_lshl_b32 s86, s27, 12
    s_lshl_b32 s81, s22, 7
    s_lshl_b32 s58, s27, 3
    s_add_u32 s81, s81, s58
    s_lshl_b32 s81, s81, 11
    s_and_b32 s82, s76, 15
    s_lshr_b64 s[76:77], s[76:77], 4
    s_add_u32 s82, s82, s75
    s_and_b32 s82, s82, 15
    s_mul_i32 s83, s82, 393216
    s_lshl_b32 s82, s82, 7
    s_add_u32 s82, s82, s81
    s_add_u32 s83, s83, s78
    s_add_u32 m0, s80, 0
    s_nop 0
    buffer_load_dwordx4 v62, s[8:11], s82 offen lds
    s_add_u32 s82, s82, 65536
    s_add_u32 m0, s80, 65536
    s_nop 0
    buffer_load_dwordx4 v63, s[12:15], s83 offen lds
    s_add_u32 s83, s83, 98304
    s_add_u32 m0, s80, 4096
    s_nop 0
    buffer_load_dwordx4 v62, s[8:11], s82 offen lds
    s_add_u32 s82, s82, 65536
    s_add_u32 m0, s80, 69632
    s_nop 0
    buffer_load_dwordx4 v63, s[12:15], s83 offen lds
    s_add_u32 s83, s83, 98304
    s_add_u32 m0, s80, 8192
    s_nop 0
    buffer_load_dwordx4 v62, s[8:11], s82 offen lds
    s_add_u32 s82, s82, 65536
    s_add_u32 m0, s80, 73728
    s_nop 0
    buffer_load_dwordx4 v63, s[12:15], s83 offen lds
    s_add_u32 s83, s83, 98304
    s_add_u32 m0, s80, 12288
    s_nop 0
    buffer_load_dwordx4 v62, s[8:11], s82 offen lds
    s_add_u32 s82, s82, 65536
    s_add_u32 m0, s80, 77824
    s_nop 0
    buffer_load_dwordx4 v63, s[12:15], s83 offen lds
    s_add_u32 s83, s83, 98304
    s_setprio 3
    s_mov_b32 s32, s56
    s_mov_b32 s33, s57
    s_mov_b32 s34, 0x200000
    s_mov_b32 s35, 0x20000
    s_mov_b32 s44, s66
    s_mov_b32 s45, s67
    s_mov_b32 s46, 0x700000
    s_mov_b32 s47, 0x20000
    v_and_b32 v12, 15, v1
    v_lshrrev_b32 v13, 4, v1
    v_lshlrev_b32 v14, 7, v12
    v_add_u32 v14, s86, v14
    v_bfe_u32 v15, v12, 1, 3
    v_xor_b32 v10, v13, v15
    v_lshl_add_u32 v4, v10, 4, v14
    v_add_u32 v10, 4, v13
    v_xor_b32 v10, v10, v15
    v_lshl_add_u32 v5, v10, 4, v14
    v_bfe_u32 v10, v1, 2, 2
    v_lshlrev_b32 v10, 6, v10
    v_and_b32 v11, 3, v1
    v_lshl_add_u32 v10, v11, 3, v10
    v_and_b32 v11, 1, v13
    v_lshl_add_u32 v10, v11, 5, v10
    v_lshl_add_u32 v2, v13, 12, v10
    v_add_u32 v2, 65536, v2
    v_xor_b32 v3, 32, v2
    s_lshl_b32 s58, s27, 8
    s_add_u32 s58, s58, 65536
    v_lshl_add_u32 v240, v13, 11, v10
    v_add_u32 v240, s58, v240
    v_xor_b32 v241, 32, v240
    s_lshr_b32 s58, s27, 1
    s_lshl_b32 s58, s58, 8
    s_add_u32 s58, s58, 150528
    s_and_b32 s59, s27, 1
    s_lshl_b32 s59, s59, 5
    v_lshl_add_u32 v242, v13, 10, v10
    v_xor_b32 v242, s59, v242
    v_add_u32 v242, s58, v242
    v_mov_b32 v236, 0x3f803f80
    v_mov_b32 v237, 0x3f803f80
    v_mov_b32 v238, 0x3f803f80
    v_mov_b32 v239, 0x3f803f80
    v_mov_b32 v60, 1073741824
    v_mov_b32 v59, 0xff
    v_mov_b32 v0, 133376
    s_lshr_b32 s88, s3, 4
    s_and_b32 s89, s3, 15
    v_lshlrev_b32 v61, 4, v1
    s_add_u32 s85, s74, 1
    s_cmp_lt_u32 s24, 4
    s_cselect_b32 s85, 0, s85
    s_and_b32 s82, s76, 15
    s_lshr_b64 s[76:77], s[76:77], 4
    s_add_u32 s82, s82, s75
    s_and_b32 s82, s82, 15
    s_mul_i32 s83, s82, 393216
    s_lshl_b32 s82, s82, 7
    s_add_u32 s82, s82, s81
    s_add_u32 s83, s83, s78
    s_add_u32 m0, s80, 16384
    s_nop 0
    buffer_load_dwordx4 v62, s[8:11], s82 offen lds
    s_add_u32 s82, s82, 65536
    s_add_u32 m0, s80, 81920
    s_nop 0
    buffer_load_dwordx4 v63, s[12:15], s83 offen lds
    s_add_u32 s83, s83, 98304
    s_add_u32 m0, s80, 20480
    s_nop 0
    buffer_load_dwordx4 v62, s[8:11], s82 offen lds
    s_add_u32 s82, s82, 65536
    s_add_u32 m0, s80, 86016
    s_nop 0
    buffer_load_dwordx4 v63, s[12:15], s83 offen lds
    s_add_u32 s83, s83, 98304
    s_add_u32 m0, s80, 24576
    s_nop 0
    buffer_load_dwordx4 v62, s[8:11], s82 offen lds
    s_add_u32 s82, s82, 65536
    s_add_u32 m0, s80, 90112
    s_nop 0
    buffer_load_dwordx4 v63, s[12:15], s83 offen lds
    s_add_u32 s83, s83, 98304
    s_add_u32 m0, s80, 28672
    s_nop 0
    buffer_load_dwordx4 v62, s[8:11], s82 offen lds
    s_add_u32 s82, s82, 65536
    s_add_u32 m0, s80, 94208
    s_nop 0
    buffer_load_dwordx4 v63, s[12:15], s83 offen lds
    s_add_u32 s83, s83, 98304
    s_and_b32 s82, s76, 15
    s_lshr_b64 s[76:77], s[76:77], 4
    s_add_u32 s82, s82, s75
    s_and_b32 s82, s82, 15
    s_mul_i32 s83, s82, 393216
    s_lshl_b32 s82, s82, 7
    s_add_u32 s82, s82, s81
    s_add_u32 s83, s83, s78
    s_add_u32 m0, s80, 32768
    s_nop 0
    buffer_load_dwordx4 v62, s[8:11], s82 offen lds
    s_add_u32 s82, s82, 65536
    s_add_u32 m0, s80, 98304
    s_nop 0
    buffer_load_dwordx4 v63, s[12:15], s83 offen lds
    s_add_u32 s83, s83, 98304
    s_add_u32 m0, s80, 36864
    s_nop 0
    buffer_load_dwordx4 v62, s[8:11], s82 offen lds
    s_add_u32 s82, s82, 65536
    s_add_u32 m0, s80, 102400
    s_nop 0
    buffer_load_dwordx4 v63, s[12:15], s83 offen lds
    s_add_u32 s83, s83, 98304
    s_add_u32 m0, s80, 40960
    s_nop 0
    buffer_load_dwordx4 v62, s[8:11], s82 offen lds
    s_add_u32 s82, s82, 65536
    s_add_u32 m0, s80, 106496
    s_nop 0
    buffer_load_dwordx4 v63, s[12:15], s83 offen lds
    s_add_u32 s83, s83, 98304
    s_add_u32 m0, s80, 45056
    s_nop 0
    buffer_load_dwordx4 v62, s[8:11], s82 offen lds
    s_add_u32 s82, s82, 65536
    s_add_u32 m0, s80, 110592
    s_nop 0
    buffer_load_dwordx4 v63, s[12:15], s83 offen lds
    s_add_u32 s83, s83, 98304
    s_waitcnt vmcnt(16)
    s_barrier
    s_and_b32 s82, s76, 15
    s_lshr_b64 s[76:77], s[76:77], 4
    s_add_u32 s82, s82, s75
    s_and_b32 s82, s82, 15
    s_mul_i32 s83, s82, 393216
    s_lshl_b32 s82, s82, 7
    s_add_u32 s82, s82, s81
    s_add_u32 s83, s83, s78
    s_add_u32 m0, s80, 49152
    s_nop 0
    buffer_load_dwordx4 v62, s[8:11], s82 offen lds
    ds_read_b128 v[64:67], v4 offset:0
    ds_read_b128 v[68:71], v5 offset:0
    s_add_u32 s82, s82, 65536
    s_add_u32 m0, s80, 114688
    s_nop 0
    buffer_load_dwordx4 v63, s[12:15], s83 offen lds
    ds_read_b128 v[72:75], v4 offset:2048
    ds_read_b128 v[76:79], v5 offset:2048
    s_add_u32 s83, s83, 98304
    s_add_u32 m0, s80, 53248
    s_nop 0
    buffer_load_dwordx4 v62, s[8:11], s82 offen lds
    s_cmp_eq_u32 s85, 0
    s_cbranch_scc0 L_cs1
    ds_read_b64_tr_b16 v[200:201], v240 offset:0
    ds_read_b64_tr_b16 v[202:203], v240 offset:1024
    ds_read_b64_tr_b16 v[204:205], v240 offset:8192
    ds_read_b64_tr_b16 v[206:207], v240 offset:9216
    ds_read_b64_tr_b16 v[208:209], v241 offset:0
    ds_read_b64_tr_b16 v[210:211], v241 offset:1024
    ds_read_b64_tr_b16 v[212:213], v241 offset:8192
    ds_read_b64_tr_b16 v[214:215], v241 offset:9216
L_cs1:
    ds_read_b128 v[12:15], v0 offset:80
    s_add_u32 s82, s82, 65536
    s_add_u32 m0, s80, 118784
    s_nop 0
    buffer_load_dwordx4 v63, s[12:15], s83 offen lds
    v_and_b32 v10, 7, v1
    v_lshlrev_b32 v10, 3, v10
    s_add_u32 s83, s83, 98304
    s_add_u32 m0, s80, 57344
    s_nop 0
    buffer_load_dwordx4 v62, s[8:11], s82 offen lds
    v_add_u32 v9, 133472, v10
    ds_read_b64 v[16:17], v9
    s_add_u32 s82, s82, 65536
    s_add_u32 m0, s80, 122880
    s_nop 0
    buffer_load_dwordx4 v63, s[12:15], s83 offen lds
    ds_read_b32 v11, v0 offset:76
    s_add_u32 s83, s83, 98304
    s_add_u32 m0, s80, 61440
    s_nop 0
    buffer_load_dwordx4 v62, s[8:11], s82 offen lds
    s_add_u32 s82, s82, 65536
    s_add_u32 m0, s80, 126976
    s_nop 0
    buffer_load_dwordx4 v63, s[12:15], s83 offen lds
    s_add_u32 s83, s83, 98304
    s_waitcnt vmcnt(16)
    s_waitcnt lgkmcnt(0)
    s_barrier
    s_and_b32 s82, s76, 15
    s_lshr_b64 s[76:77], s[76:77], 4
    s_add_u32 s82, s82, s75
    s_and_b32 s82, s82, 15
    s_mul_i32 s83, s82, 393216
    s_lshl_b32 s82, s82, 7
    s_add_u32 s82, s82, s81
    s_add_u32 s83, s83, s78
    s_add_u32 m0, s80, 0
    s_nop 0
    buffer_load_dwordx4 v62, s[8:11], s82 offen lds
    ds_read_b128 v[80:83], v4 offset:16384
    ds_read_b128 v[84:87], v5 offset:16384
    s_add_u32 s82, s82, 65536
    s_add_u32 m0, s80, 65536
    s_nop 0
    buffer_load_dwordx4 v63, s[12:15], s83 offen lds
    ds_read_b128 v[88:91], v4 offset:18432
    ds_read_b128 v[92:95], v5 offset:18432
    s_add_u32 s83, s83, 98304
    s_add_u32 m0, s80, 4096
    s_nop 0
    buffer_load_dwordx4 v62, s[8:11], s82 offen lds
    s_cmp_eq_u32 s85, 1
    s_cbranch_scc0 L_cs2
    ds_read_b64_tr_b16 v[200:201], v240 offset:16384
    ds_read_b64_tr_b16 v[202:203], v240 offset:17408
    ds_read_b64_tr_b16 v[204:205], v240 offset:24576
    ds_read_b64_tr_b16 v[206:207], v240 offset:25600
    ds_read_b64_tr_b16 v[208:209], v241 offset:16384
    ds_read_b64_tr_b16 v[210:211], v241 offset:17408
    ds_read_b64_tr_b16 v[212:213], v241 offset:24576
    ds_read_b64_tr_b16 v[214:215], v241 offset:25600
L_cs2:
    v_readfirstlane_b32 s60, v11
    s_add_u32 s82, s82, 65536
    s_add_u32 m0, s80, 69632
    s_nop 0
    buffer_load_dwordx4 v63, s[12:15], s83 offen lds
    s_lshr_b32 s61, s60, 8
    s_lshr_b32 s62, s60, 16
    s_add_u32 s83, s83, 98304
    s_add_u32 m0, s80, 8192
    s_nop 0
    buffer_load_dwordx4 v62, s[8:11], s82 offen lds
    s_lshr_b32 s63, s60, 24
    s_mov_b32 s64, 0x0c0c0400
    s_add_u32 s82, s82, 65536
    s_add_u32 m0, s80, 73728
    s_nop 0
    buffer_load_dwordx4 v63, s[12:15], s83 offen lds
    s_mov_b32 s65, 0x04000c0c
    s_add_u32 s83, s83, 98304
    s_add_u32 m0, s80, 12288
    s_nop 0
    buffer_load_dwordx4 v62, s[8:11], s82 offen lds
    s_add_u32 s82, s82, 65536
    s_add_u32 m0, s80, 77824
    s_nop 0
    buffer_load_dwordx4 v63, s[12:15], s83 offen lds
    s_add_u32 s83, s83, 98304
    s_add_u32 s58, s74, 4
    s_cmp_lt_u32 s24, 4
    s_cselect_b32 s58, s74, s58
    s_add_u32 s58, s58, s75
    s_and_b32 s58, s58, 15
    s_mul_i32 s84, s58, 393216
    s_add_u32 s84, s84, s79
    s_add_u32 m0, s80, 150528
    s_nop 0
    buffer_load_dwordx4 v6, s[12:15], s84 offen lds
    s_add_u32 s84, s84, 196608
    s_add_u32 m0, s80, 154624
    s_nop 0
    buffer_load_dwordx4 v6, s[12:15], s84 offen lds
    s_waitcnt vmcnt(18)
    s_waitcnt lgkmcnt(0)
    s_barrier
    s_and_b32 s82, s76, 15
    s_lshr_b64 s[76:77], s[76:77], 4
    s_add_u32 s82, s82, s75
    s_and_b32 s82, s82, 15
    s_mul_i32 s83, s82, 393216
    s_lshl_b32 s82, s82, 7
    s_add_u32 s82, s82, s81
    s_add_u32 s83, s83, s78
    s_add_u32 m0, s80, 16384
    s_nop 0
    buffer_load_dwordx4 v62, s[8:11], s82 offen lds
    ds_read_b128 v[96:99], v4 offset:32768
    ds_read_b128 v[100:103], v5 offset:32768
    ds_read_b128 v[104:107], v4 offset:34816
    ds_read_b128 v[108:111], v5 offset:34816
    s_add_u32 s82, s82, 65536
    s_add_u32 m0, s80, 81920
    s_nop 0
    buffer_load_dwordx4 v63, s[12:15], s83 offen lds
    s_cmp_eq_u32 s85, 2
    s_cbranch_scc0 L_cs3
    ds_read_b64_tr_b16 v[200:201], v240 offset:32768
    ds_read_b64_tr_b16 v[202:203], v240 offset:33792
    ds_read_b64_tr_b16 v[204:205], v240 offset:40960
    ds_read_b64_tr_b16 v[206:207], v240 offset:41984
    ds_read_b64_tr_b16 v[208:209], v241 offset:32768
    ds_read_b64_tr_b16 v[210:211], v241 offset:33792
    ds_read_b64_tr_b16 v[212:213], v241 offset:40960
    ds_read_b64_tr_b16 v[214:215], v241 offset:41984
L_cs3:
    s_lshl_b32 s58, s27, 6
    v_add_u32 v9, s58, v1
    v_cmp_gt_u32 vcc, 8, v9
    s_add_u32 s83, s83, 98304
    s_add_u32 m0, s80, 20480
    s_nop 0
    buffer_load_dwordx4 v62, s[8:11], s82 offen lds
    v_cndmask_b32 v10, v60, v10, vcc
    v_cmp_eq_u32 vcc, 0, v9
    s_nop 1
    v_cndmask_b32 v9, v60, v9, vcc
    s_and_b32 s59, s60, 0xffff
    s_add_u32 s82, s82, 65536
    s_add_u32 m0, s80, 86016
    s_nop 0
    buffer_load_dwordx4 v63, s[12:15], s83 offen lds
    v_or_b32 v16, s59, v16
    v_or_b32 v17, s62, v17
    s_lshl_b32 s58, s22, 4
    s_add_u32 s58, s58, s23
    s_add_u32 s83, s83, 98304
    s_add_u32 m0, s80, 24576
    s_nop 0
    buffer_load_dwordx4 v62, s[8:11], s82 offen lds
    s_lshl_b32 s58, s58, 6
    s_add_u32 s58, s58, 8585216
    buffer_store_dwordx2 v[16:17], v10, s[16:19], s58 offen sc1
    v_max_u32 v12, v12, v13
    s_add_u32 s82, s82, 65536
    s_add_u32 m0, s80, 90112
    s_nop 0
    buffer_load_dwordx4 v63, s[12:15], s83 offen lds
    v_max3_u32 v12, v12, v14, v15
    v_mov_b32 v13, s60
    s_lshl_b32 s58, s2, 3
    s_add_u32 s58, s58, 8601600
    s_add_u32 s83, s83, 98304
    s_add_u32 m0, s80, 28672
    s_nop 0
    buffer_load_dwordx4 v62, s[8:11], s82 offen lds
    buffer_store_dwordx2 v[12:13], v9, s[16:19], s58 offen sc1
    s_add_u32 s82, s82, 65536
    s_add_u32 m0, s80, 94208
    s_nop 0
    buffer_load_dwordx4 v63, s[12:15], s83 offen lds
    s_add_u32 s83, s83, 98304
    s_waitcnt vmcnt(18)
    s_waitcnt lgkmcnt(0)
    s_barrier
    s_and_b32 s82, s76, 15
    s_lshr_b64 s[76:77], s[76:77], 4
    s_add_u32 s82, s82, s75
    s_and_b32 s82, s82, 15
    s_mul_i32 s83, s82, 393216
    s_lshl_b32 s82, s82, 7
    s_add_u32 s82, s82, s81
    s_add_u32 s83, s83, s78
    s_add_u32 m0, s80, 32768
    s_nop 0
    buffer_load_dwordx4 v62, s[8:11], s82 offen lds
    ds_read_b128 v[112:115], v4 offset:49152
    s_add_u32 s82, s82, 65536
    s_add_u32 m0, s80, 98304
    s_nop 0
    buffer_load_dwordx4 v63, s[12:15], s83 offen lds
    ds_read_b128 v[116:119], v5 offset:49152
    s_add_u32 s83, s83, 98304
    s_add_u32 m0, s80, 36864
    s_nop 0
    buffer_load_dwordx4 v62, s[8:11], s82 offen lds
    ds_read_b128 v[120:123], v4 offset:51200
    s_add_u32 s82, s82, 65536
    s_add_u32 m0, s80, 102400
    s_nop 0
    buffer_load_dwordx4 v63, s[12:15], s83 offen lds
    ds_read_b128 v[124:127], v5 offset:51200
    s_add_u32 s83, s83, 98304
    s_add_u32 m0, s80, 40960
    s_nop 0
    buffer_load_dwordx4 v62, s[8:11], s82 offen lds
    s_cmp_eq_u32 s85, 3
    s_cbranch_scc0 L_cs4
    ds_read_b64_tr_b16 v[200:201], v240 offset:49152
    ds_read_b64_tr_b16 v[202:203], v240 offset:50176
    ds_read_b64_tr_b16 v[204:205], v240 offset:57344
    ds_read_b64_tr_b16 v[206:207], v240 offset:58368
    ds_read_b64_tr_b16 v[208:209], v241 offset:49152
    ds_read_b64_tr_b16 v[210:211], v241 offset:50176
    ds_read_b64_tr_b16 v[212:213], v241 offset:57344
    ds_read_b64_tr_b16 v[214:215], v241 offset:58368
L_cs4:
    s_add_u32 s82, s82, 65536
    s_add_u32 m0, s80, 106496
    s_nop 0
    buffer_load_dwordx4 v63, s[12:15], s83 offen lds
    s_add_u32 s83, s83, 98304
    s_add_u32 m0, s80, 45056
    s_nop 0
    buffer_load_dwordx4 v62, s[8:11], s82 offen lds
    s_add_u32 s82, s82, 65536
    s_add_u32 m0, s80, 110592
    s_nop 0
    buffer_load_dwordx4 v63, s[12:15], s83 offen lds
    s_add_u32 s83, s83, 98304
    s_waitcnt vmcnt(16)
    s_waitcnt lgkmcnt(0)
    s_barrier
    s_and_b32 s82, s76, 15
    s_lshr_b64 s[76:77], s[76:77], 4
    s_add_u32 s82, s82, s75
    s_and_b32 s82, s82, 15
    s_mul_i32 s83, s82, 393216
    s_lshl_b32 s82, s82, 7
    s_add_u32 s82, s82, s81
    s_add_u32 s83, s83, s78
    s_add_u32 m0, s80, 49152
    s_nop 0
    buffer_load_dwordx4 v62, s[8:11], s82 offen lds
    ds_read_b128 v[128:131], v4 offset:0
    ds_read_b128 v[132:135], v5 offset:0
    s_add_u32 s82, s82, 65536
    s_add_u32 m0, s80, 114688
    s_nop 0
    buffer_load_dwordx4 v63, s[12:15], s83 offen lds
    ds_read_b128 v[136:139], v4 offset:2048
    ds_read_b128 v[140:143], v5 offset:2048
    s_add_u32 s83, s83, 98304
    s_add_u32 m0, s80, 53248
    s_nop 0
    buffer_load_dwordx4 v62, s[8:11], s82 offen lds
    s_cmp_eq_u32 s85, 4
    s_cbranch_scc0 L_cs5
    ds_read_b64_tr_b16 v[200:201], v240 offset:0
    ds_read_b64_tr_b16 v[202:203], v240 offset:1024
    ds_read_b64_tr_b16 v[204:205], v240 offset:8192
    ds_read_b64_tr_b16 v[206:207], v240 offset:9216
    ds_read_b64_tr_b16 v[208:209], v241 offset:0
    ds_read_b64_tr_b16 v[210:211], v241 offset:1024
    ds_read_b64_tr_b16 v[212:213], v241 offset:8192
    ds_read_b64_tr_b16 v[214:215], v241 offset:9216
L_cs5:
    ds_read_b64_tr_b16 v[216:217], v242 offset:0
    s_add_u32 s82, s82, 65536
    s_add_u32 m0, s80, 118784
    s_nop 0
    buffer_load_dwordx4 v63, s[12:15], s83 offen lds
    ds_read_b64_tr_b16 v[218:219], v242 offset:512
    ds_read_b64_tr_b16 v[220:221], v242 offset:4096
    s_add_u32 s83, s83, 98304
    s_add_u32 m0, s80, 57344
    s_nop 0
    buffer_load_dwordx4 v62, s[8:11], s82 offen lds
    ds_read_b64_tr_b16 v[222:223], v242 offset:4608
    s_add_u32 s82, s82, 65536
    s_add_u32 m0, s80, 122880
    s_nop 0
    buffer_load_dwordx4 v63, s[12:15], s83 offen lds
    s_add_u32 s83, s83, 98304
    s_add_u32 m0, s80, 61440
    s_nop 0
    buffer_load_dwordx4 v62, s[8:11], s82 offen lds
    s_add_u32 s82, s82, 65536
    s_add_u32 m0, s80, 126976
    s_nop 0
    buffer_load_dwordx4 v63, s[12:15], s83 offen lds
    s_add_u32 s83, s83, 98304
    s_waitcnt vmcnt(16)
    s_waitcnt lgkmcnt(0)
    s_barrier
    s_and_b32 s82, s76, 15
    s_lshr_b64 s[76:77], s[76:77], 4
    s_add_u32 s82, s82, s75
    s_and_b32 s82, s82, 15
    s_mul_i32 s83, s82, 393216
    s_lshl_b32 s82, s82, 7
    s_add_u32 s82, s82, s81
    s_add_u32 s83, s83, s78
    s_add_u32 m0, s80, 0
    s_nop 0
    buffer_load_dwordx4 v62, s[8:11], s82 offen lds
    ds_read_b128 v[144:147], v4 offset:16384
    ds_read_b128 v[148:151], v5 offset:16384
    s_add_u32 s82, s82, 65536
    s_add_u32 m0, s80, 65536
    s_nop 0
    buffer_load_dwordx4 v63, s[12:15], s83 offen lds
    ds_read_b128 v[152:155], v4 offset:18432
    ds_read_b128 v[156:159], v5 offset:18432
    s_add_u32 s83, s83, 98304
    s_add_u32 m0, s80, 4096
    s_nop 0
    buffer_load_dwordx4 v62, s[8:11], s82 offen lds
    v_mfma_f32_16x16x32_bf16 v[224:227], v[236:239], v[200:203], 0
    v_mfma_f32_16x16x32_bf16 v[224:227], v[236:239], v[204:207], v[224:227]
    s_add_u32 s82, s82, 65536
    s_add_u32 m0, s80, 69632
    s_nop 0
    buffer_load_dwordx4 v63, s[12:15], s83 offen lds
    v_mfma_f32_16x16x32_bf16 v[228:231], v[236:239], v[208:211], 0
    v_mfma_f32_16x16x32_bf16 v[228:231], v[236:239], v[212:215], v[228:231]
    s_add_u32 s83, s83, 98304
    s_add_u32 m0, s80, 8192
    s_nop 0
    buffer_load_dwordx4 v62, s[8:11], s82 offen lds
    v_mfma_f32_16x16x32_bf16 v[232:235], v[236:239], v[216:219], 0
    v_mfma_f32_16x16x32_bf16 v[232:235], v[236:239], v[220:223], v[232:235]
    s_add_u32 s82, s82, 65536
    s_add_u32 m0, s80, 73728
    s_nop 0
    buffer_load_dwordx4 v63, s[12:15], s83 offen lds
    s_add_u32 s83, s83, 98304
    s_add_u32 m0, s80, 12288
    s_nop 0
    buffer_load_dwordx4 v62, s[8:11], s82 offen lds
    s_add_u32 s82, s82, 65536
    s_add_u32 m0, s80, 77824
    s_nop 0
    buffer_load_dwordx4 v63, s[12:15], s83 offen lds
    s_add_u32 s83, s83, 98304
    s_waitcnt vmcnt(16)
    s_waitcnt lgkmcnt(0)
    s_barrier
    s_and_b32 s82, s76, 15
    s_lshr_b64 s[76:77], s[76:77], 4
    s_add_u32 s82, s82, s75
    s_and_b32 s82, s82, 15
    s_mul_i32 s83, s82, 393216
    s_lshl_b32 s82, s82, 7
    s_add_u32 s82, s82, s81
    s_add_u32 s83, s83, s78
    s_add_u32 m0, s80, 16384
    s_nop 0
    buffer_load_dwordx4 v62, s[8:11], s82 offen lds
    ds_read_b128 v[160:163], v4 offset:32768
    ds_read_b128 v[164:167], v5 offset:32768
    ds_read_b128 v[168:171], v4 offset:34816
    ds_read_b128 v[172:175], v5 offset:34816
    s_add_u32 s82, s82, 65536
    s_add_u32 m0, s80, 81920
    s_nop 0
    buffer_load_dwordx4 v63, s[12:15], s83 offen lds
    v_lshrrev_b32 v8, 4, v1
    v_cmp_eq_u32 vcc, 1, v8
    s_nop 1
    v_cndmask_b32 v224, v224, v228, vcc
    v_cmp_eq_u32 vcc, 2, v8
    s_add_u32 s83, s83, 98304
    s_add_u32 m0, s80, 20480
    s_nop 0
    buffer_load_dwordx4 v62, s[8:11], s82 offen lds
    v_cndmask_b32 v224, v224, v232, vcc
    s_lshl_b32 s58, s27, 7
    v_lshl_add_u32 v9, v1, 2, s58
    s_lshl_b32 s58, s27, 6
    s_add_u32 s82, s82, 65536
    s_add_u32 m0, s80, 86016
    s_nop 0
    buffer_load_dwordx4 v63, s[12:15], s83 offen lds
    s_add_u32 s58, s58, 384
    v_lshl_add_u32 v10, v1, 2, s58
    v_cndmask_b32 v9, v9, v10, vcc
    v_cmp_eq_u32 vcc, 3, v8
    s_add_u32 s83, s83, 98304
    s_add_u32 m0, s80, 24576
    s_nop 0
    buffer_load_dwordx4 v62, s[8:11], s82 offen lds
    v_cndmask_b32 v9, v9, v60, vcc
    v_and_b32 v10, 3, v1
    v_lshlrev_b32 v10, 3, v10
    v_lshrrev_b32 v10, v10, s60
    s_add_u32 s82, s82, 65536
    s_add_u32 m0, s80, 90112
    s_nop 0
    buffer_load_dwordx4 v63, s[12:15], s83 offen lds
    v_bfi_b32 v224, v59, v10, v224
    s_lshl_b32 s58, s23, 4
    s_add_u32 s58, s58, s22
    s_lshl_b32 s58, s58, 10
    s_add_u32 s83, s83, 98304
    s_add_u32 m0, s80, 28672
    s_nop 0
    buffer_load_dwordx4 v62, s[8:11], s82 offen lds
    s_add_u32 s58, s58, 9043968
    buffer_store_dword v224, v9, s[16:19], s58 offen sc1
    s_add_u32 s82, s82, 65536
    s_add_u32 m0, s80, 94208
    s_nop 0
    buffer_load_dwordx4 v63, s[12:15], s83 offen lds
    s_add_u32 s83, s83, 98304
    s_waitcnt vmcnt(16)
    s_waitcnt lgkmcnt(0)
    s_barrier
    s_and_b32 s82, s76, 15
    s_lshr_b64 s[76:77], s[76:77], 4
    s_add_u32 s82, s82, s75
    s_and_b32 s82, s82, 15
    s_mul_i32 s83, s82, 393216
    s_lshl_b32 s82, s82, 7
    s_add_u32 s82, s82, s81
    s_add_u32 s83, s83, s78
    s_add_u32 m0, s80, 32768
    s_nop 0
    buffer_load_dwordx4 v62, s[8:11], s82 offen lds
    ds_read_b128 v[176:179], v4 offset:49152
    ds_read_b128 v[180:183], v5 offset:49152
    ds_read_b128 v[184:187], v4 offset:51200
    s_add_u32 s82, s82, 65536
    s_add_u32 m0, s80, 98304
    s_nop 0
    buffer_load_dwordx4 v63, s[12:15], s83 offen lds
    ds_read_b128 v[188:191], v5 offset:51200
    v_and_b32 v32, 15, v1
    v_lshlrev_b32 v32, 4, v32
    s_add_u32 s83, s83, 98304
    s_add_u32 m0, s80, 36864
    s_nop 0
    buffer_load_dwordx4 v62, s[8:11], s82 offen lds
    v_lshrrev_b32 v33, 4, v1
    v_lshl_add_u32 v32, v33, 10, v32
    s_lshl_b32 s90, s23, 14
    s_add_u32 s82, s82, 65536
    s_add_u32 m0, s80, 102400
    s_nop 0
    buffer_load_dwordx4 v63, s[12:15], s83 offen lds
    s_lshl_b32 s59, s27, 8
    s_add_u32 s90, s90, s59
    s_add_u32 s90, s90, 9043968
    s_add_u32 s83, s83, 98304
    s_add_u32 m0, s80, 40960
    s_nop 0
    buffer_load_dwordx4 v62, s[8:11], s82 offen lds
    s_lshl_b32 s59, s22, 10
    s_add_u32 s59, s59, 8585216
    s_sub_u32 s95, s28, s22
    s_add_u32 s82, s82, 65536
    s_add_u32 m0, s80, 106496
    s_nop 0
    buffer_load_dwordx4 v63, s[12:15], s83 offen lds
    s_lshl_b32 s95, s95, 10
    s_lshl_b32 s87, s28, 10
    s_sub_u32 s87, 16384, s87
    s_add_u32 s83, s83, 98304
    s_add_u32 m0, s80, 45056
    s_nop 0
    buffer_load_dwordx4 v62, s[8:11], s82 offen lds
    s_cmp_eq_u32 s27, 3
    s_cselect_b32 s90, s59, s90
    s_movk_i32 s59, 4096
    s_cselect_b32 s95, s95, s59
    s_cselect_b32 s87, s87, s59
    s_cselect_b32 s74, 1024, s59
    s_cselect_b64 vcc, -1, 0
    v_cndmask_b32 v32, v32, v61, vcc
    s_add_u32 s82, s82, 65536
    s_add_u32 m0, s80, 110592
    s_nop 0
    buffer_load_dwordx4 v63, s[12:15], s83 offen lds
    s_add_u32 s83, s83, 98304
    s_waitcnt vmcnt(16)
    s_waitcnt lgkmcnt(0)
    s_barrier
    s_and_b32 s82, s76, 15
    s_lshr_b64 s[76:77], s[76:77], 4
    s_add_u32 s82, s82, s75
    s_and_b32 s82, s82, 15
    s_mul_i32 s83, s82, 393216
    s_lshl_b32 s82, s82, 7
    s_add_u32 s82, s82, s81
    s_add_u32 s83, s83, s78
    s_add_u32 m0, s80, 49152
    s_nop 0
    buffer_load_dwordx4 v62, s[8:11], s82 offen lds
    ds_read_b128 v[192:195], v4 offset:0
    s_add_u32 s82, s82, 65536
    s_add_u32 m0, s80, 114688
    s_nop 0
    buffer_load_dwordx4 v63, s[12:15], s83 offen lds
    ds_read_b128 v[196:199], v5 offset:0
    s_add_u32 s83, s83, 98304
    s_add_u32 m0, s80, 53248
    s_nop 0
    buffer_load_dwordx4 v62, s[8:11], s82 offen lds
    ds_read_b128 v[200:203], v4 offset:2048
    s_add_u32 s82, s82, 65536
    s_add_u32 m0, s80, 118784
    s_nop 0
    buffer_load_dwordx4 v63, s[12:15], s83 offen lds
    ds_read_b128 v[204:207], v5 offset:2048
    s_add_u32 s83, s83, 98304
    s_add_u32 m0, s80, 57344
    s_nop 0
    buffer_load_dwordx4 v62, s[8:11], s82 offen lds
    s_add_u32 s82, s82, 65536
    s_add_u32 m0, s80, 122880
    s_nop 0
    buffer_load_dwordx4 v63, s[12:15], s83 offen lds
    s_add_u32 s83, s83, 98304
    s_add_u32 m0, s80, 61440
    s_nop 0
    buffer_load_dwordx4 v62, s[8:11], s82 offen lds
    s_add_u32 s82, s82, 65536
    s_add_u32 m0, s80, 126976
    s_nop 0
    buffer_load_dwordx4 v63, s[12:15], s83 offen lds
    s_add_u32 s83, s83, 98304
    s_waitcnt vmcnt(16)
    s_waitcnt lgkmcnt(0)
    s_barrier
    s_and_b32 s82, s76, 15
    s_lshr_b64 s[76:77], s[76:77], 4
    s_add_u32 s82, s82, s75
    s_and_b32 s82, s82, 15
    s_mul_i32 s83, s82, 393216
    s_lshl_b32 s82, s82, 7
    s_add_u32 s82, s82, s81
    s_add_u32 s83, s83, s78
    s_add_u32 m0, s80, 0
    s_nop 0
    buffer_load_dwordx4 v62, s[8:11], s82 offen lds
    ds_read_b128 v[208:211], v4 offset:16384
    s_add_u32 s82, s82, 65536
    s_add_u32 m0, s80, 65536
    s_nop 0
    buffer_load_dwordx4 v63, s[12:15], s83 offen lds
    ds_read_b128 v[212:215], v5 offset:16384
    s_add_u32 s83, s83, 98304
    s_add_u32 m0, s80, 4096
    s_nop 0
    buffer_load_dwordx4 v62, s[8:11], s82 offen lds
    ds_read_b128 v[216:219], v4 offset:18432
    s_add_u32 s82, s82, 65536
    s_add_u32 m0, s80, 69632
    s_nop 0
    buffer_load_dwordx4 v63, s[12:15], s83 offen lds
    ds_read_b128 v[220:223], v5 offset:18432
    s_add_u32 s83, s83, 98304
    s_add_u32 m0, s80, 8192
    s_nop 0
    buffer_load_dwordx4 v62, s[8:11], s82 offen lds
    s_add_u32 s82, s82, 65536
    s_add_u32 m0, s80, 73728
    s_nop 0
    buffer_load_dwordx4 v63, s[12:15], s83 offen lds
    s_add_u32 s83, s83, 98304
    s_add_u32 m0, s80, 12288
    s_nop 0
    buffer_load_dwordx4 v62, s[8:11], s82 offen lds
    s_add_u32 s82, s82, 65536
    s_add_u32 m0, s80, 77824
    s_nop 0
    buffer_load_dwordx4 v63, s[12:15], s83 offen lds
    s_add_u32 s83, s83, 98304
    s_waitcnt vmcnt(16)
    s_waitcnt lgkmcnt(0)
    s_barrier
    s_and_b32 s82, s76, 15
    s_lshr_b64 s[76:77], s[76:77], 4
    s_add_u32 s82, s82, s75
    s_and_b32 s82, s82, 15
    s_mul_i32 s83, s82, 393216
    s_lshl_b32 s82, s82, 7
    s_add_u32 s82, s82, s81
    s_add_u32 s83, s83, s78
    s_add_u32 m0, s80, 16384
    s_nop 0
    buffer_load_dwordx4 v62, s[8:11], s82 offen lds
    ds_read_b128 v[224:227], v4 offset:32768
    s_add_u32 s82, s82, 65536
    s_add_u32 m0, s80, 81920
    s_nop 0
    buffer_load_dwordx4 v63, s[12:15], s83 offen lds
    ds_read_b128 v[228:231], v5 offset:32768
    s_add_u32 s83, s83, 98304
    s_add_u32 m0, s80, 20480
    s_nop 0
    buffer_load_dwordx4 v62, s[8:11], s82 offen lds
    ds_read_b128 v[232:235], v4 offset:34816
    s_add_u32 s82, s82, 65536
    s_add_u32 m0, s80, 86016
    s_nop 0
    buffer_load_dwordx4 v63, s[12:15], s83 offen lds
    ds_read_b128 v[236:239], v5 offset:34816
    s_add_u32 s83, s83, 98304
    s_add_u32 m0, s80, 24576
    s_nop 0
    buffer_load_dwordx4 v62, s[8:11], s82 offen lds
    s_add_u32 s82, s82, 65536
    s_add_u32 m0, s80, 90112
    s_nop 0
    buffer_load_dwordx4 v63, s[12:15], s83 offen lds
    s_add_u32 s83, s83, 98304
    s_add_u32 m0, s80, 28672
    s_nop 0
    buffer_load_dwordx4 v62, s[8:11], s82 offen lds
    s_add_u32 s82, s82, 65536
    s_add_u32 m0, s80, 94208
    s_nop 0
    buffer_load_dwordx4 v63, s[12:15], s83 offen lds
    s_add_u32 s83, s83, 98304
    s_mov_b32 s58, s90
    buffer_load_dwordx4 v[8:11], v32, s[16:19], s58 offen sc1
    s_add_u32 s58, s58, s95
    buffer_load_dwordx4 v[12:15], v32, s[16:19], s58 offen sc1
    s_add_u32 s58, s58, s87
    buffer_load_dwordx4 v[16:19], v32, s[16:19], s58 offen sc1
    s_add_u32 s58, s58, s74
    buffer_load_dwordx4 v[20:23], v32, s[16:19], s58 offen sc1
    s_waitcnt vmcnt(20)
    s_waitcnt lgkmcnt(0)
    s_barrier
    s_and_b32 s82, s76, 15
    s_lshr_b64 s[76:77], s[76:77], 4
    s_add_u32 s82, s82, s75
    s_and_b32 s82, s82, 15
    s_mul_i32 s83, s82, 393216
    s_lshl_b32 s82, s82, 7
    s_add_u32 s82, s82, s81
    s_add_u32 s83, s83, s78
    s_add_u32 m0, s80, 32768
    s_nop 0
    buffer_load_dwordx4 v62, s[8:11], s82 offen lds
    ds_read_b128 v[240:243], v4 offset:49152
    s_add_u32 s82, s82, 65536
    s_add_u32 m0, s80, 98304
    s_nop 0
    buffer_load_dwordx4 v63, s[12:15], s83 offen lds
    ds_read_b128 v[244:247], v5 offset:49152
    s_add_u32 s83, s83, 98304
    s_add_u32 m0, s80, 36864
    s_nop 0
    buffer_load_dwordx4 v62, s[8:11], s82 offen lds
    ds_read_b128 v[248:251], v4 offset:51200
    s_add_u32 s82, s82, 65536
    s_add_u32 m0, s80, 102400
    s_nop 0
    buffer_load_dwordx4 v63, s[12:15], s83 offen lds
    ds_read_b128 v[252:255], v5 offset:51200
    s_add_u32 s83, s83, 98304
    s_add_u32 m0, s80, 40960
    s_nop 0
    buffer_load_dwordx4 v62, s[8:11], s82 offen lds
    s_add_u32 s82, s82, 65536
    s_add_u32 m0, s80, 106496
    s_nop 0
    buffer_load_dwordx4 v63, s[12:15], s83 offen lds
    s_add_u32 s83, s83, 98304
    s_add_u32 m0, s80, 45056
    s_nop 0
    buffer_load_dwordx4 v62, s[8:11], s82 offen lds
    s_add_u32 s82, s82, 65536
    s_add_u32 m0, s80, 110592
    s_nop 0
    buffer_load_dwordx4 v63, s[12:15], s83 offen lds
    s_add_u32 s83, s83, 98304
    s_waitcnt vmcnt(20)
    s_waitcnt lgkmcnt(0)
    s_barrier
    s_cmp_eq_u32 s27, 3
    s_cbranch_scc1 L_path3
    s_and_b32 s82, s76, 15
    s_lshr_b64 s[76:77], s[76:77], 4
    s_add_u32 s82, s82, s75
    s_and_b32 s82, s82, 15
    s_mul_i32 s83, s82, 393216
    s_lshl_b32 s82, s82, 7
    s_add_u32 s82, s82, s81
    s_add_u32 s83, s83, s78
    s_add_u32 m0, s80, 49152
    s_nop 0
    buffer_load_dwordx4 v62, s[8:11], s82 offen lds
    s_waitcnt vmcnt(9)
    v_perm_b32 v24, v9, v8, s64
    v_perm_b32 v35, v11, v10, s65
    s_add_u32 s82, s82, 65536
    s_add_u32 m0, s80, 114688
    s_nop 0
    buffer_load_dwordx4 v63, s[12:15], s83 offen lds
    v_or_b32 v24, v24, v35
    v_perm_b32 v25, v13, v12, s64
    v_perm_b32 v35, v15, v14, s65
    s_add_u32 s83, s83, 98304
    s_add_u32 m0, s80, 53248
    s_nop 0
    buffer_load_dwordx4 v62, s[8:11], s82 offen lds
    v_or_b32 v25, v25, v35
    v_perm_b32 v26, v17, v16, s64
    v_perm_b32 v35, v19, v18, s65
    s_add_u32 s82, s82, 65536
    s_add_u32 m0, s80, 118784
    s_nop 0
    buffer_load_dwordx4 v63, s[12:15], s83 offen lds
    v_or_b32 v26, v26, v35
    v_perm_b32 v27, v21, v20, s64
    v_perm_b32 v35, v23, v22, s65
    s_add_u32 s83, s83, 98304
    s_add_u32 m0, s80, 57344
    s_nop 0
    buffer_load_dwordx4 v62, s[8:11], s82 offen lds
    v_or_b32 v27, v27, v35
    v_max3_u32 v33, v24, v25, v26
    v_min3_u32 v34, v24, v25, v26
    s_add_u32 s82, s82, 65536
    s_add_u32 m0, s80, 122880
    s_nop 0
    buffer_load_dwordx4 v63, s[12:15], s83 offen lds
    v_max_u32 v33, v33, v27
    v_min_u32 v34, v34, v27
    s_add_u32 s83, s83, 98304
    s_add_u32 m0, s80, 61440
    s_nop 0
    buffer_load_dwordx4 v62, s[8:11], s82 offen lds
    s_add_u32 s82, s82, 65536
    s_add_u32 m0, s80, 126976
    s_nop 0
    buffer_load_dwordx4 v63, s[12:15], s83 offen lds
    s_add_u32 s83, s83, 98304
    s_waitcnt lgkmcnt(0)
    s_barrier
    s_lshl_b32 s58, s2, 13
    s_lshl_b32 s59, s27, 11
    s_add_u32 s58, s58, s59
    buffer_load_dwordx4 v[40:43], v61, s[32:35], s58 offen
    buffer_load_dwordx4 v[44:47], v61, s[32:35], s58 offen offset:1024
    s_and_b32 s84, s72, 15
    s_lshr_b64 s[72:73], s[72:73], 4
    s_add_u32 s84, s84, s75
    s_and_b32 s84, s84, 15
    s_mul_i32 s84, s84, 393216
    s_add_u32 s84, s84, s79
    s_add_u32 m0, s86, 65536
    s_nop 0
    buffer_load_dwordx4 v6, s[12:15], s84 offen lds
    v_cmp_ne_u32 vcc, s60, v33
    v_cmp_ne_u32 s[66:67], s60, v34
    s_nop 0
    s_or_b64 vcc, vcc, s[66:67]
    s_cbranch_scc1 L_s1slow0
L_s1back0:
    v_and_b32 v8, 0xffffff00, v8
    v_and_b32 v9, 0xffffff00, v9
    s_add_u32 s84, s84, 196608
    s_add_u32 m0, s86, 66560
    s_nop 0
    buffer_load_dwordx4 v6, s[12:15], s84 offen lds
    v_and_b32 v10, 0xffffff00, v10
    v_and_b32 v11, 0xffffff00, v11
    v_and_b32 v12, 0xffffff00, v12
    v_and_b32 v13, 0xffffff00, v13
    v_and_b32 v14, 0xffffff00, v14
    s_and_b32 s84, s72, 15
    s_lshr_b64 s[72:73], s[72:73], 4
    s_add_u32 s84, s84, s75
    s_and_b32 s84, s84, 15
    s_mul_i32 s84, s84, 393216
    s_add_u32 s84, s84, s79
    s_add_u32 m0, s86, 67584
    s_nop 0
    buffer_load_dwordx4 v6, s[12:15], s84 offen lds
    v_and_b32 v15, 0xffffff00, v15
    v_and_b32 v16, 0xffffff00, v16
    v_and_b32 v17, 0xffffff00, v17
    v_and_b32 v18, 0xffffff00, v18
    v_and_b32 v19, 0xffffff00, v19
    s_add_u32 s84, s84, 196608
    s_add_u32 m0, s86, 68608
    s_nop 0
    buffer_load_dwordx4 v6, s[12:15], s84 offen lds
    v_and_b32 v20, 0xffffff00, v20
    v_and_b32 v21, 0xffffff00, v21
    s_waitcnt vmcnt(14)
    s_waitcnt lgkmcnt(0)
    s_barrier
    s_and_b32 s84, s72, 15
    s_lshr_b64 s[72:73], s[72:73], 4
    s_add_u32 s84, s84, s75
    s_and_b32 s84, s84, 15
    s_mul_i32 s84, s84, 393216
    s_add_u32 s84, s84, s79
    s_add_u32 m0, s86, 81920
    s_nop 0
    buffer_load_dwordx4 v6, s[12:15], s84 offen lds
    v_and_b32 v22, 0xffffff00, v22
    v_and_b32 v23, 0xffffff00, v23
    v_pk_add_f32 v[8:9], v[8:9], v[12:13]
    v_pk_add_f32 v[16:17], v[16:17], v[20:21]
    v_pk_add_f32 v[10:11], v[10:11], v[14:15]
    s_add_u32 s84, s84, 196608
    s_add_u32 m0, s86, 82944
    s_nop 0
    buffer_load_dwordx4 v6, s[12:15], s84 offen lds
    v_pk_add_f32 v[18:19], v[18:19], v[22:23]
    v_pk_add_f32 v[8:9], v[8:9], v[16:17]
    v_pk_add_f32 v[10:11], v[10:11], v[18:19]
    v_mov_b32 v12, v8
    v_mov_b32 v13, v9
    s_and_b32 s84, s72, 15
    s_lshr_b64 s[72:73], s[72:73], 4
    s_add_u32 s84, s84, s75
    s_and_b32 s84, s84, 15
    s_mul_i32 s84, s84, 393216
    s_add_u32 s84, s84, s79
    s_add_u32 m0, s86, 83968
    s_nop 0
    buffer_load_dwordx4 v6, s[12:15], s84 offen lds
    v_mov_b32 v14, v10
    v_mov_b32 v15, v11
    v_permlane16_swap_b32 v8, v12
    v_permlane16_swap_b32 v9, v13
    v_permlane16_swap_b32 v10, v14
    s_add_u32 s84, s84, 196608
    s_add_u32 m0, s86, 84992
    s_nop 0
    buffer_load_dwordx4 v6, s[12:15], s84 offen lds
    v_permlane16_swap_b32 v11, v15
    v_pk_add_f32 v[8:9], v[8:9], v[12:13]
    s_waitcnt vmcnt(10)
    s_waitcnt lgkmcnt(0)
    s_barrier
    s_and_b32 s84, s72, 15
    s_lshr_b64 s[72:73], s[72:73], 4
    s_add_u32 s84, s84, s75
    s_and_b32 s84, s84, 15
    s_mul_i32 s84, s84, 393216
    s_add_u32 s84, s84, s79
    s_add_u32 m0, s86, 98304
    s_nop 0
    buffer_load_dwordx4 v6, s[12:15], s84 offen lds
    v_pk_add_f32 v[10:11], v[10:11], v[14:15]
    v_mov_b32 v12, v8
    v_mov_b32 v13, v9
    v_mov_b32 v14, v10
    s_add_u32 s84, s84, 196608
    s_add_u32 m0, s86, 99328
    s_nop 0
    buffer_load_dwordx4 v6, s[12:15], s84 offen lds
    v_mov_b32 v15, v11
    v_permlane32_swap_b32 v8, v12
    v_permlane32_swap_b32 v9, v13
    v_permlane32_swap_b32 v10, v14
    s_and_b32 s84, s72, 15
    s_lshr_b64 s[72:73], s[72:73], 4
    s_add_u32 s84, s84, s75
    s_and_b32 s84, s84, 15
    s_mul_i32 s84, s84, 393216
    s_add_u32 s84, s84, s79
    s_add_u32 m0, s86, 100352
    s_nop 0
    buffer_load_dwordx4 v6, s[12:15], s84 offen lds
    v_permlane32_swap_b32 v11, v15
    v_pk_add_f32 v[8:9], v[8:9], v[12:13]
    v_pk_add_f32 v[10:11], v[10:11], v[14:15]
    s_lshl_b32 s58, s27, 8
    s_add_u32 s84, s84, 196608
    s_add_u32 m0, s86, 101376
    s_nop 0
    buffer_load_dwordx4 v6, s[12:15], s84 offen lds
    s_add_u32 s58, s58, 132608
    v_and_b32 v33, 15, v1
    v_lshl_add_u32 v33, v33, 4, s58
    ds_write_b128 v33, v[8:11]
    s_waitcnt vmcnt(4)
    s_waitcnt lgkmcnt(0)
    s_barrier
    s_branch L_pathj
L_path3:
    s_and_b32 s82, s76, 15
    s_lshr_b64 s[76:77], s[76:77], 4
    s_add_u32 s82, s82, s75
    s_and_b32 s82, s82, 15
    s_mul_i32 s83, s82, 393216
    s_lshl_b32 s82, s82, 7
    s_add_u32 s82, s82, s81
    s_add_u32 s83, s83, s78
    s_add_u32 m0, s80, 49152
    s_nop 0
    buffer_load_dwordx4 v62, s[8:11], s82 offen lds
    s_waitcnt vmcnt(9)
    s_mov_b32 s58, 0x05040100
    s_add_u32 s82, s82, 65536
    s_add_u32 m0, s80, 114688
    s_nop 0
    buffer_load_dwordx4 v63, s[12:15], s83 offen lds
    v_perm_b32 v24, v9, v8, s58
    v_perm_b32 v25, v11, v10, s58
    s_add_u32 s83, s83, 98304
    s_add_u32 m0, s80, 53248
    s_nop 0
    buffer_load_dwordx4 v62, s[8:11], s82 offen lds
    v_perm_b32 v26, v13, v12, s58
    v_perm_b32 v27, v15, v14, s58
    s_add_u32 s82, s82, 65536
    s_add_u32 m0, s80, 118784
    s_nop 0
    buffer_load_dwordx4 v63, s[12:15], s83 offen lds
    v_max3_u32 v33, v17, v19, v21
    v_min3_u32 v34, v17, v19, v21
    s_add_u32 s83, s83, 98304
    s_add_u32 m0, s80, 57344
    s_nop 0
    buffer_load_dwordx4 v62, s[8:11], s82 offen lds
    v_max3_u32 v33, v33, v23, v24
    v_min3_u32 v34, v34, v23, v24
    s_add_u32 s82, s82, 65536
    s_add_u32 m0, s80, 122880
    s_nop 0
    buffer_load_dwordx4 v63, s[12:15], s83 offen lds
    v_max3_u32 v33, v33, v25, v26
    v_min3_u32 v34, v34, v25, v26
    s_add_u32 s83, s83, 98304
    s_add_u32 m0, s80, 61440
    s_nop 0
    buffer_load_dwordx4 v62, s[8:11], s82 offen lds
    v_max_u32 v33, v33, v27
    v_min_u32 v34, v34, v27
    s_add_u32 s82, s82, 65536
    s_add_u32 m0, s80, 126976
    s_nop 0
    buffer_load_dwordx4 v63, s[12:15], s83 offen lds
    s_add_u32 s83, s83, 98304
    s_waitcnt lgkmcnt(0)
    s_barrier
    s_lshl_b32 s58, s2, 13
    s_lshl_b32 s59, s27, 11
    s_add_u32 s58, s58, s59
    buffer_load_dwordx4 v[40:43], v61, s[32:35], s58 offen
    buffer_load_dwordx4 v[44:47], v61, s[32:35], s58 offen offset:1024
    s_and_b32 s84, s72, 15
    s_lshr_b64 s[72:73], s[72:73], 4
    s_add_u32 s84, s84, s75
    s_and_b32 s84, s84, 15
    s_mul_i32 s84, s84, 393216
    s_add_u32 s84, s84, s79
    s_add_u32 m0, s86, 65536
    s_nop 0
    buffer_load_dwordx4 v6, s[12:15], s84 offen lds
    v_cmp_ne_u32 vcc, s60, v33
    v_cmp_ne_u32 s[66:67], s60, v34
    s_nop 0
    s_or_b64 vcc, vcc, s[66:67]
    s_cbranch_scc1 L_s1slow1
L_s1back1:
    v_and_b32 v8, 0xffff0000, v8
    s_add_u32 s84, s84, 196608
    s_add_u32 m0, s86, 66560
    s_nop 0
    buffer_load_dwordx4 v6, s[12:15], s84 offen lds
    v_and_b32 v9, 0xffff0000, v9
    v_and_b32 v10, 0xffff0000, v10
    v_and_b32 v11, 0xffff0000, v11
    v_and_b32 v12, 0xffff0000, v12
    s_and_b32 s84, s72, 15
    s_lshr_b64 s[72:73], s[72:73], 4
    s_add_u32 s84, s84, s75
    s_and_b32 s84, s84, 15
    s_mul_i32 s84, s84, 393216
    s_add_u32 s84, s84, s79
    s_add_u32 m0, s86, 67584
    s_nop 0
    buffer_load_dwordx4 v6, s[12:15], s84 offen lds
    v_and_b32 v13, 0xffff0000, v13
    v_and_b32 v14, 0xffff0000, v14
    v_and_b32 v15, 0xffff0000, v15
    v_rcp_f32 v9, v9
    s_add_u32 s84, s84, 196608
    s_add_u32 m0, s86, 68608
    s_nop 0
    buffer_load_dwordx4 v6, s[12:15], s84 offen lds
    v_rcp_f32 v11, v11
    v_rcp_f32 v13, v13
    s_waitcnt vmcnt(14)
    s_waitcnt lgkmcnt(0)
    s_barrier
    s_and_b32 s84, s72, 15
    s_lshr_b64 s[72:73], s[72:73], 4
    s_add_u32 s84, s84, s75
    s_and_b32 s84, s84, 15
    s_mul_i32 s84, s84, 393216
    s_add_u32 s84, s84, s79
    s_add_u32 m0, s86, 81920
    s_nop 0
    buffer_load_dwordx4 v6, s[12:15], s84 offen lds
    v_rcp_f32 v15, v15
    v_add_u32 v33, 135168, v61
    v_mov_b32 v24, v8
    v_mov_b32 v25, v10
    s_add_u32 s84, s84, 196608
    s_add_u32 m0, s86, 82944
    s_nop 0
    buffer_load_dwordx4 v6, s[12:15], s84 offen lds
    ds_write_b128 v33, v[12:15]
    v_mov_b32 v26, v9
    v_mov_b32 v27, v11
    v_mul_f32 v28, 0x3fb8aa3b, v9
    s_and_b32 s84, s72, 15
    s_lshr_b64 s[72:73], s[72:73], 4
    s_add_u32 s84, s84, s75
    s_and_b32 s84, s84, 15
    s_mul_i32 s84, s84, 393216
    s_add_u32 s84, s84, s79
    s_add_u32 m0, s86, 83968
    s_nop 0
    buffer_load_dwordx4 v6, s[12:15], s84 offen lds
    v_mul_f32 v29, 0x3fb8aa3b, v11
    v_lshlrev_b32 v33, 3, v1
    v_add_u32 v33, 131072, v33
    ds_write_b64 v33, v[24:25]
    s_add_u32 s84, s84, 196608
    s_add_u32 m0, s86, 84992
    s_nop 0
    buffer_load_dwordx4 v6, s[12:15], s84 offen lds
    ds_write_b64 v33, v[26:27] offset:512
    ds_write_b64 v33, v[28:29] offset:1024
    s_waitcnt vmcnt(10)
    s_waitcnt lgkmcnt(0)
    s_barrier
    s_and_b32 s84, s72, 15
    s_lshr_b64 s[72:73], s[72:73], 4
    s_add_u32 s84, s84, s75
    s_and_b32 s84, s84, 15
    s_mul_i32 s84, s84, 393216
    s_add_u32 s84, s84, s79
    s_add_u32 m0, s86, 98304
    s_nop 0
    buffer_load_dwordx4 v6, s[12:15], s84 offen lds
    v_max_u32 v16, v16, v18
    v_max3_u32 v16, v16, v20, v22
    s_nop 1
    v_max_u32_dpp v16, v16, v16 row_ror:8 row_mask:0xf bank_mask:0xf
    s_nop 1
    v_max_u32_dpp v16, v16, v16 row_ror:4 row_mask:0xf bank_mask:0xf
    s_add_u32 s84, s84, 196608
    s_add_u32 m0, s86, 99328
    s_nop 0
    buffer_load_dwordx4 v6, s[12:15], s84 offen lds
    v_max_u32_dpp v16, v16, v16 row_ror:2 row_mask:0xf bank_mask:0xf
    s_nop 1
    v_max_u32_dpp v16, v16, v16 row_ror:1 row_mask:0xf bank_mask:0xf
    v_mov_b32 v17, v16
    s_nop 1
    v_permlane16_swap_b32 v16, v17
    s_and_b32 s84, s72, 15
    s_lshr_b64 s[72:73], s[72:73], 4
    s_add_u32 s84, s84, s75
    s_and_b32 s84, s84, 15
    s_mul_i32 s84, s84, 393216
    s_add_u32 s84, s84, s79
    s_add_u32 m0, s86, 100352
    s_nop 0
    buffer_load_dwordx4 v6, s[12:15], s84 offen lds
    v_max_u32 v16, v16, v17
    v_mov_b32 v17, v16
    s_nop 1
    v_permlane32_swap_b32 v16, v17
    v_max_u32 v16, v16, v17
    s_add_u32 s84, s84, 196608
    s_add_u32 m0, s86, 101376
    s_nop 0
    buffer_load_dwordx4 v6, s[12:15], s84 offen lds
    s_mov_b64 exec, 1
    ds_write_b32 v0, v16 offset:72
    s_mov_b64 exec, -1
    s_waitcnt vmcnt(4)
    s_waitcnt lgkmcnt(0)
    s_barrier
L_pathj:
    s_and_b32 s84, s72, 15
    s_lshr_b64 s[72:73], s[72:73], 4
    s_add_u32 s84, s84, s75
    s_and_b32 s84, s84, 15
    s_mul_i32 s84, s84, 393216
    s_add_u32 s84, s84, s79
    s_add_u32 m0, s86, 114688
    s_nop 0
    buffer_load_dwordx4 v6, s[12:15], s84 offen lds
    s_add_u32 s84, s84, 196608
    s_add_u32 m0, s86, 115712
    s_nop 0
    buffer_load_dwordx4 v6, s[12:15], s84 offen lds
    s_and_b32 s84, s72, 15
    s_lshr_b64 s[72:73], s[72:73], 4
    s_add_u32 s84, s84, s75
    s_and_b32 s84, s84, 15
    s_mul_i32 s84, s84, 393216
    s_add_u32 s84, s84, s79
    s_add_u32 m0, s86, 116736
    s_nop 0
    buffer_load_dwordx4 v6, s[12:15], s84 offen lds
    s_add_u32 s84, s84, 196608
    s_add_u32 m0, s86, 117760
    s_nop 0
    buffer_load_dwordx4 v6, s[12:15], s84 offen lds
    s_setprio 0
    v_add_u32 v1, s27, v0
    s_mov_b32 s57, 0
L_sl8:
    ds_read_b32 v7, v0 offset:60
    s_waitcnt lgkmcnt(0)
    v_cmp_ne_u32 vcc, 0x1010101, v7
    s_add_u32 s57, s57, 1
    s_nop 0
    s_cbranch_vccz L_sld9
    s_sleep 1
    s_cmp_lt_u32 s57, 262144
    s_cbranch_scc1 L_sl8
L_sld9:
    ds_read_b64_tr_b16 v[8:9], v2 offset:0
    ds_read_b64_tr_b16 v[10:11], v2 offset:512
    ds_read_b64_tr_b16 v[12:13], v2 offset:1024
    ds_read_b64_tr_b16 v[14:15], v2 offset:1536
    ds_read_b64_tr_b16 v[16:17], v3 offset:0
    ds_read_b64_tr_b16 v[18:19], v3 offset:512
    ds_read_b64_tr_b16 v[20:21], v3 offset:1024
    ds_read_b64_tr_b16 v[22:23], v3 offset:1536
    v_cmp_ne_u32 vcc, 0x1010101, v7
    s_nop 1
    s_cbranch_vccnz L_cs10
L_cb11:
    s_waitcnt lgkmcnt(4)
    v_mfma_f32_16x16x32_bf16 v[32:35], v[8:11], v[64:67], 0
    ds_read_b64_tr_b16 v[24:25], v2 offset:256
    v_mfma_f32_16x16x32_bf16 v[32:35], v[12:15], v[68:71], v[32:35]
    ds_read_b64_tr_b16 v[26:27], v2 offset:768
    v_mfma_f32_16x16x32_bf16 v[48:51], v[12:15], v[76:79], 0
    ds_read_b64_tr_b16 v[28:29], v2 offset:1280
    v_mfma_f32_16x16x32_bf16 v[48:51], v[8:11], v[72:75], v[48:51]
    ds_read_b64_tr_b16 v[30:31], v2 offset:1792
    s_waitcnt lgkmcnt(4)
    v_mfma_f32_16x16x32_bf16 v[36:39], v[16:19], v[64:67], 0
    ds_read_b64_tr_b16 v[8:9], v3 offset:256
    v_mfma_f32_16x16x32_bf16 v[36:39], v[20:23], v[68:71], v[36:39]
    ds_read_b64_tr_b16 v[10:11], v3 offset:768
    v_mfma_f32_16x16x32_bf16 v[52:55], v[20:23], v[76:79], 0
    ds_read_b64_tr_b16 v[12:13], v3 offset:1280
    v_mfma_f32_16x16x32_bf16 v[52:55], v[16:19], v[72:75], v[52:55]
    ds_read_b64_tr_b16 v[14:15], v3 offset:1792
    s_waitcnt lgkmcnt(4)
    v_mfma_f32_16x16x32_bf16 v[40:43], v[24:27], v[64:67], 0
    ds_read_b64_tr_b16 v[16:17], v2 offset:2048
    v_mfma_f32_16x16x32_bf16 v[40:43], v[28:31], v[68:71], v[40:43]
    ds_read_b64_tr_b16 v[18:19], v2 offset:2560
    v_mfma_f32_16x16x32_bf16 v[56:59], v[28:31], v[76:79], 0
    ds_read_b64_tr_b16 v[20:21], v2 offset:3072
    v_mfma_f32_16x16x32_bf16 v[56:59], v[24:27], v[72:75], v[56:59]
    ds_read_b64_tr_b16 v[22:23], v2 offset:3584
    s_waitcnt lgkmcnt(4)
    v_mfma_f32_16x16x32_bf16 v[44:47], v[8:11], v[64:67], 0
    ds_read_b64_tr_b16 v[24:25], v3 offset:2048
    v_mfma_f32_16x16x32_bf16 v[44:47], v[12:15], v[68:71], v[44:47]
    ds_read_b64_tr_b16 v[26:27], v3 offset:2560
    v_mfma_f32_16x16x32_bf16 v[60:63], v[12:15], v[76:79], 0
    ds_read_b64_tr_b16 v[28:29], v3 offset:3072
    v_mfma_f32_16x16x32_bf16 v[60:63], v[8:11], v[72:75], v[60:63]
    ds_read_b64_tr_b16 v[30:31], v3 offset:3584
    s_waitcnt vmcnt(4)
    v_mov_b32 v7, 1
    s_mov_b64 exec, 1
    ds_write_b8 v1, v7 offset:28
    s_mov_b64 exec, -1
    s_waitcnt lgkmcnt(5)
    s_nop 0
    v_mfma_f32_16x16x32_bf16 v[32:35], v[16:19], v[80:83], v[32:35]
    ds_read_b64_tr_b16 v[8:9], v2 offset:2304
    v_mfma_f32_16x16x32_bf16 v[32:35], v[20:23], v[84:87], v[32:35]
    ds_read_b64_tr_b16 v[10:11], v2 offset:2816
    v_mfma_f32_16x16x32_bf16 v[48:51], v[20:23], v[92:95], v[48:51]
    ds_read_b64_tr_b16 v[12:13], v2 offset:3328
    v_mfma_f32_16x16x32_bf16 v[48:51], v[16:19], v[88:91], v[48:51]
    ds_read_b64_tr_b16 v[14:15], v2 offset:3840
    ds_read_b128 v[64:67], v4 offset:0
    ds_read_b128 v[68:71], v5 offset:0
    ds_read_b128 v[72:75], v4 offset:2048
    ds_read_b128 v[76:79], v5 offset:2048
    s_waitcnt lgkmcnt(9)
    v_mfma_f32_16x16x32_bf16 v[36:39], v[24:27], v[80:83], v[36:39]
    ds_read_b64_tr_b16 v[16:17], v3 offset:2304
    v_mfma_f32_16x16x32_bf16 v[36:39], v[28:31], v[84:87], v[36:39]
    ds_read_b64_tr_b16 v[18:19], v3 offset:2816
    v_mfma_f32_16x16x32_bf16 v[52:55], v[28:31], v[92:95], v[52:55]
    ds_read_b64_tr_b16 v[20:21], v3 offset:3328
    v_mfma_f32_16x16x32_bf16 v[52:55], v[24:27], v[88:91], v[52:55]
    ds_read_b64_tr_b16 v[22:23], v3 offset:3840
    s_waitcnt lgkmcnt(8)
    v_mfma_f32_16x16x32_bf16 v[40:43], v[8:11], v[80:83], v[40:43]
    ds_read_b64_tr_b16 v[24:25], v2 offset:16384
    v_mfma_f32_16x16x32_bf16 v[40:43], v[12:15], v[84:87], v[40:43]
    ds_read_b64_tr_b16 v[26:27], v2 offset:16896
    v_mfma_f32_16x16x32_bf16 v[56:59], v[12:15], v[92:95], v[56:59]
    ds_read_b64_tr_b16 v[28:29], v2 offset:17408
    v_mfma_f32_16x16x32_bf16 v[56:59], v[8:11], v[88:91], v[56:59]
    ds_read_b64_tr_b16 v[30:31], v2 offset:17920
    s_waitcnt lgkmcnt(8)
    s_waitcnt lgkmcnt(4)
    v_mfma_f32_16x16x32_bf16 v[44:47], v[16:19], v[80:83], v[44:47]
    ds_read_b64_tr_b16 v[8:9], v3 offset:16384
    v_mfma_f32_16x16x32_bf16 v[44:47], v[20:23], v[84:87], v[44:47]
    ds_read_b64_tr_b16 v[10:11], v3 offset:16896
    v_mfma_f32_16x16x32_bf16 v[60:63], v[20:23], v[92:95], v[60:63]
    ds_read_b64_tr_b16 v[12:13], v3 offset:17408
    s_and_b32 s84, s72, 15
    s_lshr_b64 s[72:73], s[72:73], 4
    s_add_u32 s84, s84, s75
    s_and_b32 s84, s84, 15
    s_mul_i32 s84, s84, 393216
    s_add_u32 s84, s84, s79
    s_add_u32 m0, s86, 0
    s_nop 0
    buffer_load_dwordx4 v6, s[12:15], s84 offen lds
    v_mfma_f32_16x16x32_bf16 v[60:63], v[16:19], v[88:91], v[60:63]
    ds_read_b64_tr_b16 v[14:15], v3 offset:17920
    s_waitcnt lgkmcnt(4)
    v_mfma_f32_16x16x32_bf16 v[32:35], v[24:27], v[96:99], v[32:35]
    ds_read_b64_tr_b16 v[16:17], v2 offset:16640
    v_mfma_f32_16x16x32_bf16 v[32:35], v[28:31], v[100:103], v[32:35]
    ds_read_b64_tr_b16 v[18:19], v2 offset:17152
    v_mfma_f32_16x16x32_bf16 v[48:51], v[28:31], v[108:111], v[48:51]
    ds_read_b64_tr_b16 v[20:21], v2 offset:17664
    s_add_u32 s84, s84, 196608
    s_add_u32 m0, s86, 1024
    s_nop 0
    buffer_load_dwordx4 v6, s[12:15], s84 offen lds
    v_mfma_f32_16x16x32_bf16 v[48:51], v[24:27], v[104:107], v[48:51]
    ds_read_b64_tr_b16 v[22:23], v2 offset:18176
    ds_read_b128 v[80:83], v4 offset:16384
    ds_read_b128 v[84:87], v5 offset:16384
    ds_read_b128 v[88:91], v4 offset:18432
    ds_read_b128 v[92:95], v5 offset:18432
    s_waitcnt lgkmcnt(8)
    v_mfma_f32_16x16x32_bf16 v[36:39], v[8:11], v[96:99], v[36:39]
    ds_read_b64_tr_b16 v[24:25], v3 offset:16640
    v_mfma_f32_16x16x32_bf16 v[36:39], v[12:15], v[100:103], v[36:39]
    ds_read_b64_tr_b16 v[26:27], v3 offset:17152
    v_mfma_f32_16x16x32_bf16 v[52:55], v[12:15], v[108:111], v[52:55]
    ds_read_b64_tr_b16 v[28:29], v3 offset:17664
    s_and_b32 s84, s72, 15
    s_lshr_b64 s[72:73], s[72:73], 4
    s_add_u32 s84, s84, s75
    s_and_b32 s84, s84, 15
    s_mul_i32 s84, s84, 393216
    s_add_u32 s84, s84, s79
    s_add_u32 m0, s86, 2048
    s_nop 0
    buffer_load_dwordx4 v6, s[12:15], s84 offen lds
    v_mfma_f32_16x16x32_bf16 v[52:55], v[8:11], v[104:107], v[52:55]
    ds_read_b64_tr_b16 v[30:31], v3 offset:18176
    s_waitcnt vmcnt(3)
    v_mov_b32 v7, 1
    s_mov_b64 exec, 1
    ds_write_b8 v1, v7 offset:32
    s_mov_b64 exec, -1
    s_waitcnt lgkmcnt(9)
    s_nop 0
    v_mfma_f32_16x16x32_bf16 v[40:43], v[16:19], v[96:99], v[40:43]
    ds_read_b64_tr_b16 v[8:9], v2 offset:18432
    v_mfma_f32_16x16x32_bf16 v[40:43], v[20:23], v[100:103], v[40:43]
    ds_read_b64_tr_b16 v[10:11], v2 offset:18944
    v_mfma_f32_16x16x32_bf16 v[56:59], v[20:23], v[108:111], v[56:59]
    ds_read_b64_tr_b16 v[12:13], v2 offset:19456
    s_add_u32 s84, s84, 196608
    s_add_u32 m0, s86, 3072
    s_nop 0
    buffer_load_dwordx4 v6, s[12:15], s84 offen lds
    v_mfma_f32_16x16x32_bf16 v[56:59], v[16:19], v[104:107], v[56:59]
    ds_read_b64_tr_b16 v[14:15], v2 offset:19968
    s_waitcnt lgkmcnt(9)
    s_waitcnt lgkmcnt(5)
    v_mfma_f32_16x16x32_bf16 v[44:47], v[24:27], v[96:99], v[44:47]
    ds_read_b64_tr_b16 v[16:17], v3 offset:18432
    v_mfma_f32_16x16x32_bf16 v[44:47], v[28:31], v[100:103], v[44:47]
    ds_read_b64_tr_b16 v[18:19], v3 offset:18944
    v_mfma_f32_16x16x32_bf16 v[60:63], v[28:31], v[108:111], v[60:63]
    ds_read_b64_tr_b16 v[20:21], v3 offset:19456
    s_and_b32 s84, s72, 15
    s_lshr_b64 s[72:73], s[72:73], 4
    s_add_u32 s84, s84, s75
    s_and_b32 s84, s84, 15
    s_mul_i32 s84, s84, 393216
    s_add_u32 s84, s84, s79
    s_add_u32 m0, s86, 16384
    s_nop 0
    buffer_load_dwordx4 v6, s[12:15], s84 offen lds
    v_mfma_f32_16x16x32_bf16 v[60:63], v[24:27], v[104:107], v[60:63]
    ds_read_b64_tr_b16 v[22:23], v3 offset:19968
    s_waitcnt lgkmcnt(4)
    v_mfma_f32_16x16x32_bf16 v[32:35], v[8:11], v[112:115], v[32:35]
    ds_read_b64_tr_b16 v[24:25], v2 offset:18688
    v_mfma_f32_16x16x32_bf16 v[32:35], v[12:15], v[116:119], v[32:35]
    ds_read_b64_tr_b16 v[26:27], v2 offset:19200
    v_mfma_f32_16x16x32_bf16 v[48:51], v[12:15], v[124:127], v[48:51]
    ds_read_b64_tr_b16 v[28:29], v2 offset:19712
    s_add_u32 s84, s84, 196608
    s_add_u32 m0, s86, 17408
    s_nop 0
    buffer_load_dwordx4 v6, s[12:15], s84 offen lds
    v_mfma_f32_16x16x32_bf16 v[48:51], v[8:11], v[120:123], v[48:51]
    ds_read_b64_tr_b16 v[30:31], v2 offset:20224
    ds_read_b128 v[96:99], v4 offset:32768
    ds_read_b128 v[100:103], v5 offset:32768
    ds_read_b128 v[104:107], v4 offset:34816
    ds_read_b128 v[108:111], v5 offset:34816
    ds_read_b32 v7, v0 offset:28
    s_waitcnt lgkmcnt(9)
    v_mfma_f32_16x16x32_bf16 v[36:39], v[16:19], v[112:115], v[36:39]
    ds_read_b64_tr_b16 v[8:9], v3 offset:18688
    v_mfma_f32_16x16x32_bf16 v[36:39], v[20:23], v[116:119], v[36:39]
    ds_read_b64_tr_b16 v[10:11], v3 offset:19200
    v_mfma_f32_16x16x32_bf16 v[52:55], v[20:23], v[124:127], v[52:55]
    ds_read_b64_tr_b16 v[12:13], v3 offset:19712
    s_and_b32 s84, s72, 15
    s_lshr_b64 s[72:73], s[72:73], 4
    s_add_u32 s84, s84, s75
    s_and_b32 s84, s84, 15
    s_mul_i32 s84, s84, 393216
    s_add_u32 s84, s84, s79
    s_add_u32 m0, s86, 18432
    s_nop 0
    buffer_load_dwordx4 v6, s[12:15], s84 offen lds
    v_mfma_f32_16x16x32_bf16 v[52:55], v[16:19], v[120:123], v[52:55]
    ds_read_b64_tr_b16 v[14:15], v3 offset:20224
    s_waitcnt lgkmcnt(4)
    v_cmp_ne_u32 vcc, 0x1010101, v7
    s_nop 1
    s_cbranch_vccnz L_cs13
L_cb14:
    v_mfma_f32_16x16x32_bf16 v[40:43], v[24:27], v[112:115], v[40:43]
    ds_read_b64_tr_b16 v[16:17], v2 offset:32768
    v_mfma_f32_16x16x32_bf16 v[40:43], v[28:31], v[116:119], v[40:43]
    ds_read_b64_tr_b16 v[18:19], v2 offset:33280
    v_mfma_f32_16x16x32_bf16 v[56:59], v[28:31], v[124:127], v[56:59]
    ds_read_b64_tr_b16 v[20:21], v2 offset:33792
    s_add_u32 s84, s84, 196608
    s_add_u32 m0, s86, 19456
    s_nop 0
    buffer_load_dwordx4 v6, s[12:15], s84 offen lds
    v_mfma_f32_16x16x32_bf16 v[56:59], v[24:27], v[120:123], v[56:59]
    ds_read_b64_tr_b16 v[22:23], v2 offset:34304
    s_waitcnt lgkmcnt(4)
    v_mfma_f32_16x16x32_bf16 v[44:47], v[8:11], v[112:115], v[44:47]
    ds_read_b64_tr_b16 v[24:25], v3 offset:32768
    v_mfma_f32_16x16x32_bf16 v[44:47], v[12:15], v[116:119], v[44:47]
    ds_read_b64_tr_b16 v[26:27], v3 offset:33280
    v_mfma_f32_16x16x32_bf16 v[60:63], v[12:15], v[124:127], v[60:63]
    ds_read_b64_tr_b16 v[28:29], v3 offset:33792
    s_and_b32 s84, s72, 15
    s_lshr_b64 s[72:73], s[72:73], 4
    s_add_u32 s84, s84, s75
    s_and_b32 s84, s84, 15
    s_mul_i32 s84, s84, 393216
    s_add_u32 s84, s84, s79
    s_add_u32 m0, s86, 32768
    s_nop 0
    buffer_load_dwordx4 v6, s[12:15], s84 offen lds
    v_mfma_f32_16x16x32_bf16 v[60:63], v[8:11], v[120:123], v[60:63]
    ds_read_b64_tr_b16 v[30:31], v3 offset:34304
    s_waitcnt lgkmcnt(4)
    v_mfma_f32_16x16x32_bf16 v[32:35], v[16:19], v[128:131], v[32:35]
    ds_read_b64_tr_b16 v[8:9], v2 offset:33024
    v_mfma_f32_16x16x32_bf16 v[32:35], v[20:23], v[132:135], v[32:35]
    ds_read_b64_tr_b16 v[10:11], v2 offset:33536
    v_mfma_f32_16x16x32_bf16 v[48:51], v[20:23], v[140:143], v[48:51]
    ds_read_b64_tr_b16 v[12:13], v2 offset:34048
    s_add_u32 s84, s84, 196608
    s_add_u32 m0, s86, 33792
    s_nop 0
    buffer_load_dwordx4 v6, s[12:15], s84 offen lds
    v_mfma_f32_16x16x32_bf16 v[48:51], v[16:19], v[136:139], v[48:51]
    ds_read_b64_tr_b16 v[14:15], v2 offset:34560
    ds_read_b128 v[112:115], v4 offset:49152
    ds_read_b128 v[116:119], v5 offset:49152
    ds_read_b128 v[120:123], v4 offset:51200
    ds_read_b128 v[124:127], v5 offset:51200
    s_waitcnt lgkmcnt(8)
    v_mfma_f32_16x16x32_bf16 v[36:39], v[24:27], v[128:131], v[36:39]
    ds_read_b64_tr_b16 v[16:17], v3 offset:33024
    v_mfma_f32_16x16x32_bf16 v[36:39], v[28:31], v[132:135], v[36:39]
    ds_read_b64_tr_b16 v[18:19], v3 offset:33536
    v_mfma_f32_16x16x32_bf16 v[52:55], v[28:31], v[140:143], v[52:55]
    ds_read_b64_tr_b16 v[20:21], v3 offset:34048
    s_and_b32 s84, s72, 15
    s_lshr_b64 s[72:73], s[72:73], 4
    s_add_u32 s84, s84, s75
    s_and_b32 s84, s84, 15
    s_mul_i32 s84, s84, 393216
    s_add_u32 s84, s84, s79
    s_add_u32 m0, s86, 34816
    s_nop 0
    buffer_load_dwordx4 v6, s[12:15], s84 offen lds
    v_mfma_f32_16x16x32_bf16 v[52:55], v[24:27], v[136:139], v[52:55]
    ds_read_b64_tr_b16 v[22:23], v3 offset:34560
    s_waitcnt lgkmcnt(8)
    v_mfma_f32_16x16x32_bf16 v[40:43], v[8:11], v[128:131], v[40:43]
    ds_read_b64_tr_b16 v[24:25], v2 offset:34816
    v_mfma_f32_16x16x32_bf16 v[40:43], v[12:15], v[132:135], v[40:43]
    ds_read_b64_tr_b16 v[26:27], v2 offset:35328
    v_mfma_f32_16x16x32_bf16 v[56:59], v[12:15], v[140:143], v[56:59]
    ds_read_b64_tr_b16 v[28:29], v2 offset:35840
    s_add_u32 s84, s84, 196608
    s_add_u32 m0, s86, 35840
    s_nop 0
    buffer_load_dwordx4 v6, s[12:15], s84 offen lds
    v_mfma_f32_16x16x32_bf16 v[56:59], v[8:11], v[136:139], v[56:59]
    ds_read_b64_tr_b16 v[30:31], v2 offset:36352
    s_waitcnt lgkmcnt(8)
    s_waitcnt lgkmcnt(4)
    v_mfma_f32_16x16x32_bf16 v[44:47], v[16:19], v[128:131], v[44:47]
    ds_read_b64_tr_b16 v[8:9], v3 offset:34816
    v_mfma_f32_16x16x32_bf16 v[44:47], v[20:23], v[132:135], v[44:47]
    ds_read_b64_tr_b16 v[10:11], v3 offset:35328
    v_mfma_f32_16x16x32_bf16 v[60:63], v[20:23], v[140:143], v[60:63]
    ds_read_b64_tr_b16 v[12:13], v3 offset:35840
    s_and_b32 s84, s72, 15
    s_lshr_b64 s[72:73], s[72:73], 4
    s_add_u32 s84, s84, s75
    s_and_b32 s84, s84, 15
    s_mul_i32 s84, s84, 393216
    s_add_u32 s84, s84, s79
    s_add_u32 m0, s86, 49152
    s_nop 0
    buffer_load_dwordx4 v6, s[12:15], s84 offen lds
    v_mfma_f32_16x16x32_bf16 v[60:63], v[16:19], v[136:139], v[60:63]
    ds_read_b64_tr_b16 v[14:15], v3 offset:36352
    s_waitcnt lgkmcnt(4)
    v_mfma_f32_16x16x32_bf16 v[32:35], v[24:27], v[144:147], v[32:35]
    ds_read_b64_tr_b16 v[16:17], v2 offset:35072
    v_mfma_f32_16x16x32_bf16 v[32:35], v[28:31], v[148:151], v[32:35]
    ds_read_b64_tr_b16 v[18:19], v2 offset:35584
    v_mfma_f32_16x16x32_bf16 v[48:51], v[28:31], v[156:159], v[48:51]
    ds_read_b64_tr_b16 v[20:21], v2 offset:36096
    s_add_u32 s84, s84, 196608
    s_add_u32 m0, s86, 50176
    s_nop 0
    buffer_load_dwordx4 v6, s[12:15], s84 offen lds
    v_mfma_f32_16x16x32_bf16 v[48:51], v[24:27], v[152:155], v[48:51]
    ds_read_b64_tr_b16 v[22:23], v2 offset:36608
    ds_read_b32 v7, v0 offset:32
    s_waitcnt lgkmcnt(5)
    v_mfma_f32_16x16x32_bf16 v[36:39], v[8:11], v[144:147], v[36:39]
    ds_read_b64_tr_b16 v[24:25], v3 offset:35072
    v_mfma_f32_16x16x32_bf16 v[36:39], v[12:15], v[148:151], v[36:39]
    ds_read_b64_tr_b16 v[26:27], v3 offset:35584
    v_mfma_f32_16x16x32_bf16 v[52:55], v[12:15], v[156:159], v[52:55]
    ds_read_b64_tr_b16 v[28:29], v3 offset:36096
    s_and_b32 s84, s72, 15
    s_lshr_b64 s[72:73], s[72:73], 4
    s_add_u32 s84, s84, s75
    s_and_b32 s84, s84, 15
    s_mul_i32 s84, s84, 393216
    s_add_u32 s84, s84, s79
    s_add_u32 m0, s86, 51200
    s_nop 0
    buffer_load_dwordx4 v6, s[12:15], s84 offen lds
    v_mfma_f32_16x16x32_bf16 v[52:55], v[8:11], v[152:155], v[52:55]
    ds_read_b64_tr_b16 v[30:31], v3 offset:36608
    s_waitcnt lgkmcnt(4)
    v_cmp_ne_u32 vcc, 0x1010101, v7
    s_nop 1
    s_cbranch_vccnz L_cs16
L_cb17:
    v_mfma_f32_16x16x32_bf16 v[40:43], v[16:19], v[144:147], v[40:43]
    ds_read_b64_tr_b16 v[8:9], v2 offset:49152
    v_mfma_f32_16x16x32_bf16 v[40:43], v[20:23], v[148:151], v[40:43]
    ds_read_b64_tr_b16 v[10:11], v2 offset:49664
    v_mfma_f32_16x16x32_bf16 v[56:59], v[20:23], v[156:159], v[56:59]
    ds_read_b64_tr_b16 v[12:13], v2 offset:50176
    s_add_u32 s84, s84, 196608
    s_add_u32 m0, s86, 52224
    s_nop 0
    buffer_load_dwordx4 v6, s[12:15], s84 offen lds
    v_mfma_f32_16x16x32_bf16 v[56:59], v[16:19], v[152:155], v[56:59]
    ds_read_b64_tr_b16 v[14:15], v2 offset:50688
    s_waitcnt lgkmcnt(4)
    v_mfma_f32_16x16x32_bf16 v[44:47], v[24:27], v[144:147], v[44:47]
    ds_read_b64_tr_b16 v[16:17], v3 offset:49152
    v_mfma_f32_16x16x32_bf16 v[44:47], v[28:31], v[148:151], v[44:47]
    ds_read_b64_tr_b16 v[18:19], v3 offset:49664
    v_mfma_f32_16x16x32_bf16 v[60:63], v[28:31], v[156:159], v[60:63]
    ds_read_b64_tr_b16 v[20:21], v3 offset:50176
    v_mfma_f32_16x16x32_bf16 v[60:63], v[24:27], v[152:155], v[60:63]
    ds_read_b64_tr_b16 v[22:23], v3 offset:50688
    v_mbcnt_lo_u32_b32 v7, -1, 0
    v_mbcnt_hi_u32_b32 v7, -1, v7
    v_lshrrev_b32 v6, 5, v7
    v_and_b32 v5, 31, v7
    v_lshlrev_b32 v5, 4, v5
    v_lshl_add_u32 v5, v6, 11, v5
    v_bfe_u32 v4, v7, 2, 2
    v_lshl_add_u32 v4, v6, 2, v4
    v_lshlrev_b32 v4, 11, v4
    v_lshlrev_b32 v6, 1, v6
    v_xor_b32 v6, v6, v7
    v_and_b32 v6, 3, v6
    v_lshl_add_u32 v4, v6, 4, v4
    v_bfe_u32 v6, v7, 4, 1
    v_lshl_add_u32 v6, v6, 6, v4
    s_lshl_b32 s93, s27, 14
    s_lshl_b32 s58, s29, 7
    s_add_u32 s93, s93, s58
    s_and_b32 s92, s29, 7
    s_lshl_b32 s58, s28, 1
    s_add_u32 s92, s92, s58
    s_lshl_b32 s92, s92, 2
    s_lshl_b32 s69, s3, 15
    s_lshl_b32 s59, s27, 9
    s_add_u32 s69, s69, s59
    s_cmp_lt_u32 s3, 224
    s_cselect_b32 s69, s69, 0
    s_cselect_b64 vcc, -1, 0
    v_cndmask_b32 v5, 0, v5, vcc
    s_waitcnt lgkmcnt(4)
    v_mfma_f32_16x16x32_bf16 v[32:35], v[8:11], v[160:163], v[32:35]
    ds_read_b64_tr_b16 v[24:25], v2 offset:49408
    v_mfma_f32_16x16x32_bf16 v[32:35], v[12:15], v[164:167], v[32:35]
    ds_read_b64_tr_b16 v[26:27], v2 offset:49920
    v_mfma_f32_16x16x32_bf16 v[48:51], v[12:15], v[172:175], v[48:51]
    ds_read_b64_tr_b16 v[28:29], v2 offset:50432
    v_mfma_f32_16x16x32_bf16 v[48:51], v[8:11], v[168:171], v[48:51]
    ds_read_b64_tr_b16 v[30:31], v2 offset:50944
    s_waitcnt vmcnt(12)
    v_mov_b32 v7, 1
    s_mov_b64 exec, 1
    ds_write_b8 v1, v7 offset:36
    s_mov_b64 exec, -1
    s_waitcnt lgkmcnt(5)
    s_nop 0
    v_mfma_f32_16x16x32_bf16 v[36:39], v[16:19], v[160:163], v[36:39]
    ds_read_b64_tr_b16 v[8:9], v3 offset:49408
    v_mfma_f32_16x16x32_bf16 v[36:39], v[20:23], v[164:167], v[36:39]
    ds_read_b64_tr_b16 v[10:11], v3 offset:49920
    v_mfma_f32_16x16x32_bf16 v[52:55], v[20:23], v[172:175], v[52:55]
    ds_read_b64_tr_b16 v[12:13], v3 offset:50432
    v_mfma_f32_16x16x32_bf16 v[52:55], v[16:19], v[168:171], v[52:55]
    ds_read_b64_tr_b16 v[14:15], v3 offset:50944
    s_waitcnt lgkmcnt(5)
    v_mfma_f32_16x16x32_bf16 v[40:43], v[24:27], v[160:163], v[40:43]
    ds_read_b64_tr_b16 v[16:17], v2 offset:51200
    v_mfma_f32_16x16x32_bf16 v[40:43], v[28:31], v[164:167], v[40:43]
    ds_read_b64_tr_b16 v[18:19], v2 offset:51712
    v_mfma_f32_16x16x32_bf16 v[56:59], v[28:31], v[172:175], v[56:59]
    ds_read_b64_tr_b16 v[20:21], v2 offset:52224
    buffer_load_dwordx4 v[128:131], v5, s[44:47], s69 offen nt
    v_mfma_f32_16x16x32_bf16 v[56:59], v[24:27], v[168:171], v[56:59]
    ds_read_b64_tr_b16 v[22:23], v2 offset:52736
    s_waitcnt lgkmcnt(4)
    v_mfma_f32_16x16x32_bf16 v[44:47], v[8:11], v[160:163], v[44:47]
    ds_read_b64_tr_b16 v[24:25], v3 offset:51200
    v_mfma_f32_16x16x32_bf16 v[44:47], v[12:15], v[164:167], v[44:47]
    ds_read_b64_tr_b16 v[26:27], v3 offset:51712
    v_mfma_f32_16x16x32_bf16 v[60:63], v[12:15], v[172:175], v[60:63]
    ds_read_b64_tr_b16 v[28:29], v3 offset:52224
    s_add_u32 s69, s69, 4096
    buffer_load_dwordx4 v[132:135], v5, s[44:47], s69 offen nt
    v_mfma_f32_16x16x32_bf16 v[60:63], v[8:11], v[168:171], v[60:63]
    ds_read_b64_tr_b16 v[30:31], v3 offset:52736
    s_waitcnt lgkmcnt(4)
    v_mfma_f32_16x16x32_bf16 v[32:35], v[16:19], v[176:179], v[32:35]
    ds_read_b64_tr_b16 v[8:9], v2 offset:51456
    v_mfma_f32_16x16x32_bf16 v[32:35], v[20:23], v[180:183], v[32:35]
    ds_read_b64_tr_b16 v[10:11], v2 offset:51968
    v_mfma_f32_16x16x32_bf16 v[48:51], v[20:23], v[188:191], v[48:51]
    ds_read_b64_tr_b16 v[12:13], v2 offset:52480
    s_add_u32 s69, s69, 4096
    buffer_load_dwordx4 v[136:139], v5, s[44:47], s69 offen nt
    v_mfma_f32_16x16x32_bf16 v[48:51], v[16:19], v[184:187], v[48:51]
    ds_read_b64_tr_b16 v[14:15], v2 offset:52992
    ds_read_b32 v7, v0 offset:36
    s_waitcnt lgkmcnt(5)
    v_mfma_f32_16x16x32_bf16 v[36:39], v[24:27], v[176:179], v[36:39]
    ds_read_b64_tr_b16 v[16:17], v3 offset:51456
    v_mfma_f32_16x16x32_bf16 v[36:39], v[28:31], v[180:183], v[36:39]
    ds_read_b64_tr_b16 v[18:19], v3 offset:51968
    v_mfma_f32_16x16x32_bf16 v[52:55], v[28:31], v[188:191], v[52:55]
    ds_read_b64_tr_b16 v[20:21], v3 offset:52480
    s_add_u32 s69, s69, 4096
    buffer_load_dwordx4 v[140:143], v5, s[44:47], s69 offen nt
    v_mfma_f32_16x16x32_bf16 v[52:55], v[24:27], v[184:187], v[52:55]
    ds_read_b64_tr_b16 v[22:23], v3 offset:52992
    s_waitcnt lgkmcnt(4)
    v_cmp_ne_u32 vcc, 0x1010101, v7
    s_nop 1
    s_cbranch_vccnz L_cs19
L_cb20:
    v_subrev_u32 v2, 65536, v2
    v_subrev_u32 v3, 65536, v3
    v_mfma_f32_16x16x32_bf16 v[40:43], v[8:11], v[176:179], v[40:43]
    ds_read_b64_tr_b16 v[24:25], v2 offset:0
    v_mfma_f32_16x16x32_bf16 v[40:43], v[12:15], v[180:183], v[40:43]
    ds_read_b64_tr_b16 v[26:27], v2 offset:512
    v_mfma_f32_16x16x32_bf16 v[56:59], v[12:15], v[188:191], v[56:59]
    ds_read_b64_tr_b16 v[28:29], v2 offset:1024
    s_add_u32 s69, s69, 4096
    buffer_load_dwordx4 v[144:147], v5, s[44:47], s69 offen nt
    v_mfma_f32_16x16x32_bf16 v[56:59], v[8:11], v[184:187], v[56:59]
    ds_read_b64_tr_b16 v[30:31], v2 offset:1536
    s_waitcnt vmcnt(13)
    v_mov_b32 v7, 1
    s_mov_b64 exec, 1
    ds_write_b8 v1, v7 offset:40
    s_mov_b64 exec, -1
    s_waitcnt lgkmcnt(5)
    s_nop 0
    v_mfma_f32_16x16x32_bf16 v[44:47], v[16:19], v[176:179], v[44:47]
    ds_read_b64_tr_b16 v[8:9], v3 offset:0
    v_mfma_f32_16x16x32_bf16 v[44:47], v[20:23], v[180:183], v[44:47]
    ds_read_b64_tr_b16 v[10:11], v3 offset:512
    v_mfma_f32_16x16x32_bf16 v[60:63], v[20:23], v[188:191], v[60:63]
    ds_read_b64_tr_b16 v[12:13], v3 offset:1024
    s_add_u32 s69, s69, 4096
    buffer_load_dwordx4 v[148:151], v5, s[44:47], s69 offen nt
    v_mfma_f32_16x16x32_bf16 v[60:63], v[16:19], v[184:187], v[60:63]
    ds_read_b64_tr_b16 v[14:15], v3 offset:1536
    v_mov_b32 v7, 1
    s_mov_b64 exec, 1
    ds_write_b8 v1, v7 offset:52
    s_mov_b64 exec, -1
    s_waitcnt lgkmcnt(6)
    s_nop 0
    v_mfma_f32_16x16x32_bf16 v[32:35], v[24:27], v[192:195], v[32:35]
    ds_read_b64_tr_b16 v[16:17], v2 offset:256
    v_mfma_f32_16x16x32_bf16 v[32:35], v[28:31], v[196:199], v[32:35]
    ds_read_b64_tr_b16 v[18:19], v2 offset:768
    v_mfma_f32_16x16x32_bf16 v[48:51], v[28:31], v[204:207], v[48:51]
    ds_read_b64_tr_b16 v[20:21], v2 offset:1280
    s_add_u32 s69, s69, 4096
    buffer_load_dwordx4 v[152:155], v5, s[44:47], s69 offen nt
    v_mfma_f32_16x16x32_bf16 v[48:51], v[24:27], v[200:203], v[48:51]
    ds_read_b64_tr_b16 v[22:23], v2 offset:1792
    s_waitcnt lgkmcnt(5)
    v_mfma_f32_16x16x32_bf16 v[36:39], v[8:11], v[192:195], v[36:39]
    ds_read_b64_tr_b16 v[24:25], v3 offset:256
    v_mfma_f32_16x16x32_bf16 v[36:39], v[12:15], v[196:199], v[36:39]
    ds_read_b64_tr_b16 v[26:27], v3 offset:768
    v_mfma_f32_16x16x32_bf16 v[52:55], v[12:15], v[204:207], v[52:55]
    ds_read_b64_tr_b16 v[28:29], v3 offset:1280
    s_add_u32 s69, s69, 4096
    buffer_load_dwordx4 v[156:159], v5, s[44:47], s69 offen nt
    v_mfma_f32_16x16x32_bf16 v[52:55], v[8:11], v[200:203], v[52:55]
    ds_read_b64_tr_b16 v[30:31], v3 offset:1792
    s_waitcnt lgkmcnt(4)
    v_mfma_f32_16x16x32_bf16 v[40:43], v[16:19], v[192:195], v[40:43]
    ds_read_b64_tr_b16 v[8:9], v2 offset:2048
    v_mfma_f32_16x16x32_bf16 v[40:43], v[20:23], v[196:199], v[40:43]
    ds_read_b64_tr_b16 v[10:11], v2 offset:2560
    v_mfma_f32_16x16x32_bf16 v[56:59], v[20:23], v[204:207], v[56:59]
    ds_read_b64_tr_b16 v[12:13], v2 offset:3072
    v_mfma_f32_16x16x32_bf16 v[56:59], v[16:19], v[200:203], v[56:59]
    ds_read_b64_tr_b16 v[14:15], v2 offset:3584
    s_waitcnt lgkmcnt(4)
    v_mfma_f32_16x16x32_bf16 v[44:47], v[24:27], v[192:195], v[44:47]
    ds_read_b64_tr_b16 v[16:17], v3 offset:2048
    v_mfma_f32_16x16x32_bf16 v[44:47], v[28:31], v[196:199], v[44:47]
    ds_read_b64_tr_b16 v[18:19], v3 offset:2560
    v_mfma_f32_16x16x32_bf16 v[60:63], v[28:31], v[204:207], v[60:63]
    ds_read_b64_tr_b16 v[20:21], v3 offset:3072
    v_mfma_f32_16x16x32_bf16 v[60:63], v[24:27], v[200:203], v[60:63]
    ds_read_b64_tr_b16 v[22:23], v3 offset:3584
    s_waitcnt lgkmcnt(4)
    v_mfma_f32_16x16x32_bf16 v[32:35], v[8:11], v[208:211], v[32:35]
    ds_read_b64_tr_b16 v[24:25], v2 offset:2304
    v_mfma_f32_16x16x32_bf16 v[32:35], v[12:15], v[212:215], v[32:35]
    ds_read_b64_tr_b16 v[26:27], v2 offset:2816
    v_mfma_f32_16x16x32_bf16 v[48:51], v[12:15], v[220:223], v[48:51]
    ds_read_b64_tr_b16 v[28:29], v2 offset:3328
    v_mfma_f32_16x16x32_bf16 v[48:51], v[8:11], v[216:219], v[48:51]
    ds_read_b64_tr_b16 v[30:31], v2 offset:3840
    ds_read_b32 v7, v0 offset:40
    s_waitcnt lgkmcnt(5)
    v_mfma_f32_16x16x32_bf16 v[36:39], v[16:19], v[208:211], v[36:39]
    ds_read_b64_tr_b16 v[8:9], v3 offset:2304
    v_mfma_f32_16x16x32_bf16 v[36:39], v[20:23], v[212:215], v[36:39]
    ds_read_b64_tr_b16 v[10:11], v3 offset:2816
    v_mfma_f32_16x16x32_bf16 v[52:55], v[20:23], v[220:223], v[52:55]
    ds_read_b64_tr_b16 v[12:13], v3 offset:3328
    v_mfma_f32_16x16x32_bf16 v[52:55], v[16:19], v[216:219], v[52:55]
    ds_read_b64_tr_b16 v[14:15], v3 offset:3840
    s_waitcnt lgkmcnt(4)
    v_cmp_ne_u32 vcc, 0x1010101, v7
    s_nop 1
    s_cbranch_vccnz L_cs22
L_cb23:
    v_mfma_f32_16x16x32_bf16 v[40:43], v[24:27], v[208:211], v[40:43]
    ds_read_b64_tr_b16 v[16:17], v2 offset:16384
    v_mfma_f32_16x16x32_bf16 v[40:43], v[28:31], v[212:215], v[40:43]
    ds_read_b64_tr_b16 v[18:19], v2 offset:16896
    v_mfma_f32_16x16x32_bf16 v[56:59], v[28:31], v[220:223], v[56:59]
    ds_read_b64_tr_b16 v[20:21], v2 offset:17408
    v_mfma_f32_16x16x32_bf16 v[56:59], v[24:27], v[216:219], v[56:59]
    ds_read_b64_tr_b16 v[22:23], v2 offset:17920
    s_waitcnt vmcnt(12)
    v_mov_b32 v7, 1
    s_mov_b64 exec, 1
    ds_write_b8 v1, v7 offset:44
    s_mov_b64 exec, -1
    s_waitcnt lgkmcnt(5)
    s_nop 0
    v_mfma_f32_16x16x32_bf16 v[44:47], v[8:11], v[208:211], v[44:47]
    ds_read_b64_tr_b16 v[24:25], v3 offset:16384
    v_mfma_f32_16x16x32_bf16 v[44:47], v[12:15], v[212:215], v[44:47]
    ds_read_b64_tr_b16 v[26:27], v3 offset:16896
    v_mfma_f32_16x16x32_bf16 v[60:63], v[12:15], v[220:223], v[60:63]
    ds_read_b64_tr_b16 v[28:29], v3 offset:17408
    v_mfma_f32_16x16x32_bf16 v[60:63], v[8:11], v[216:219], v[60:63]
    ds_read_b64_tr_b16 v[30:31], v3 offset:17920
    s_waitcnt lgkmcnt(5)
    v_mfma_f32_16x16x32_bf16 v[32:35], v[16:19], v[224:227], v[32:35]
    ds_read_b64_tr_b16 v[8:9], v2 offset:16640
    v_mfma_f32_16x16x32_bf16 v[32:35], v[20:23], v[228:231], v[32:35]
    ds_read_b64_tr_b16 v[10:11], v2 offset:17152
    v_mfma_f32_16x16x32_bf16 v[48:51], v[20:23], v[236:239], v[48:51]
    ds_read_b64_tr_b16 v[12:13], v2 offset:17664
    v_mfma_f32_16x16x32_bf16 v[48:51], v[16:19], v[232:235], v[48:51]
    ds_read_b64_tr_b16 v[14:15], v2 offset:18176
    s_waitcnt lgkmcnt(4)
    v_mfma_f32_16x16x32_bf16 v[36:39], v[24:27], v[224:227], v[36:39]
    ds_read_b64_tr_b16 v[16:17], v3 offset:16640
    v_mfma_f32_16x16x32_bf16 v[36:39], v[28:31], v[228:231], v[36:39]
    ds_read_b64_tr_b16 v[18:19], v3 offset:17152
    v_mfma_f32_16x16x32_bf16 v[52:55], v[28:31], v[236:239], v[52:55]
    ds_read_b64_tr_b16 v[20:21], v3 offset:17664
    v_mfma_f32_16x16x32_bf16 v[52:55], v[24:27], v[232:235], v[52:55]
    ds_read_b64_tr_b16 v[22:23], v3 offset:18176
    s_waitcnt lgkmcnt(4)
    v_mfma_f32_16x16x32_bf16 v[40:43], v[8:11], v[224:227], v[40:43]
    ds_read_b64_tr_b16 v[24:25], v2 offset:18432
    v_mfma_f32_16x16x32_bf16 v[40:43], v[12:15], v[228:231], v[40:43]
    ds_read_b64_tr_b16 v[26:27], v2 offset:18944
    v_mfma_f32_16x16x32_bf16 v[56:59], v[12:15], v[236:239], v[56:59]
    ds_read_b64_tr_b16 v[28:29], v2 offset:19456
    v_mfma_f32_16x16x32_bf16 v[56:59], v[8:11], v[232:235], v[56:59]
    ds_read_b64_tr_b16 v[30:31], v2 offset:19968
    s_waitcnt lgkmcnt(4)
    v_mfma_f32_16x16x32_bf16 v[44:47], v[16:19], v[224:227], v[44:47]
    ds_read_b64_tr_b16 v[8:9], v3 offset:18432
    v_mfma_f32_16x16x32_bf16 v[44:47], v[20:23], v[228:231], v[44:47]
    ds_read_b64_tr_b16 v[10:11], v3 offset:18944
    v_mfma_f32_16x16x32_bf16 v[60:63], v[20:23], v[236:239], v[60:63]
    ds_read_b64_tr_b16 v[12:13], v3 offset:19456
    v_mfma_f32_16x16x32_bf16 v[60:63], v[16:19], v[232:235], v[60:63]
    ds_read_b64_tr_b16 v[14:15], v3 offset:19968
    s_waitcnt lgkmcnt(4)
    v_mfma_f32_16x16x32_bf16 v[32:35], v[24:27], v[240:243], v[32:35]
    ds_read_b64_tr_b16 v[16:17], v2 offset:18688
    v_mfma_f32_16x16x32_bf16 v[32:35], v[28:31], v[244:247], v[32:35]
    ds_read_b64_tr_b16 v[18:19], v2 offset:19200
    v_mfma_f32_16x16x32_bf16 v[48:51], v[28:31], v[252:255], v[48:51]
    ds_read_b64_tr_b16 v[20:21], v2 offset:19712
    v_mfma_f32_16x16x32_bf16 v[48:51], v[24:27], v[248:251], v[48:51]
    ds_read_b64_tr_b16 v[22:23], v2 offset:20224
    ds_read_b32 v7, v0 offset:44
    s_waitcnt lgkmcnt(5)
    v_mfma_f32_16x16x32_bf16 v[36:39], v[8:11], v[240:243], v[36:39]
    ds_read_b64_tr_b16 v[24:25], v3 offset:18688
    v_mfma_f32_16x16x32_bf16 v[36:39], v[12:15], v[244:247], v[36:39]
    ds_read_b64_tr_b16 v[26:27], v3 offset:19200
    v_mfma_f32_16x16x32_bf16 v[52:55], v[12:15], v[252:255], v[52:55]
    ds_read_b64_tr_b16 v[28:29], v3 offset:19712
    v_mfma_f32_16x16x32_bf16 v[52:55], v[8:11], v[248:251], v[52:55]
    ds_read_b64_tr_b16 v[30:31], v3 offset:20224
    s_waitcnt lgkmcnt(4)
    v_cmp_ne_u32 vcc, 0x1010101, v7
    s_nop 1
    s_cbranch_vccnz L_cs25
L_cb26:
    v_mfma_f32_16x16x32_bf16 v[40:43], v[16:19], v[240:243], v[40:43]
    ds_read_b64_tr_b16 v[8:9], v2 offset:32768
    v_mfma_f32_16x16x32_bf16 v[40:43], v[20:23], v[244:247], v[40:43]
    ds_read_b64_tr_b16 v[10:11], v2 offset:33280
    v_mfma_f32_16x16x32_bf16 v[56:59], v[20:23], v[252:255], v[56:59]
    ds_read_b64_tr_b16 v[12:13], v2 offset:33792
    v_mfma_f32_16x16x32_bf16 v[56:59], v[16:19], v[248:251], v[56:59]
    ds_read_b64_tr_b16 v[14:15], v2 offset:34304
    s_waitcnt vmcnt(8)
    v_mov_b32 v7, 1
    s_mov_b64 exec, 1
    ds_write_b8 v1, v7 offset:48
    s_mov_b64 exec, -1
    s_waitcnt lgkmcnt(5)
    s_nop 0
    v_mfma_f32_16x16x32_bf16 v[44:47], v[24:27], v[240:243], v[44:47]
    ds_read_b64_tr_b16 v[16:17], v3 offset:32768
    v_mfma_f32_16x16x32_bf16 v[44:47], v[28:31], v[244:247], v[44:47]
    ds_read_b64_tr_b16 v[18:19], v3 offset:33280
    v_mfma_f32_16x16x32_bf16 v[60:63], v[28:31], v[252:255], v[60:63]
    ds_read_b64_tr_b16 v[20:21], v3 offset:33792
    v_mfma_f32_16x16x32_bf16 v[60:63], v[24:27], v[248:251], v[60:63]
    ds_read_b64_tr_b16 v[22:23], v3 offset:34304
    s_waitcnt lgkmcnt(5)
    v_mfma_f32_16x16x32_bf16 v[32:35], v[8:11], v[64:67], v[32:35]
    ds_read_b64_tr_b16 v[24:25], v2 offset:33024
    v_mfma_f32_16x16x32_bf16 v[32:35], v[12:15], v[68:71], v[32:35]
    ds_read_b64_tr_b16 v[26:27], v2 offset:33536
    v_mfma_f32_16x16x32_bf16 v[48:51], v[12:15], v[76:79], v[48:51]
    ds_read_b64_tr_b16 v[28:29], v2 offset:34048
    v_mfma_f32_16x16x32_bf16 v[48:51], v[8:11], v[72:75], v[48:51]
    ds_read_b64_tr_b16 v[30:31], v2 offset:34560
    s_waitcnt lgkmcnt(4)
    v_mfma_f32_16x16x32_bf16 v[36:39], v[16:19], v[64:67], v[36:39]
    ds_read_b64_tr_b16 v[8:9], v3 offset:33024
    v_mfma_f32_16x16x32_bf16 v[36:39], v[20:23], v[68:71], v[36:39]
    ds_read_b64_tr_b16 v[10:11], v3 offset:33536
    v_mfma_f32_16x16x32_bf16 v[52:55], v[20:23], v[76:79], v[52:55]
    ds_read_b64_tr_b16 v[12:13], v3 offset:34048
    v_mfma_f32_16x16x32_bf16 v[52:55], v[16:19], v[72:75], v[52:55]
    ds_read_b64_tr_b16 v[14:15], v3 offset:34560
    s_waitcnt lgkmcnt(4)
    v_mfma_f32_16x16x32_bf16 v[40:43], v[24:27], v[64:67], v[40:43]
    ds_read_b64_tr_b16 v[16:17], v2 offset:34816
    v_mfma_f32_16x16x32_bf16 v[40:43], v[28:31], v[68:71], v[40:43]
    ds_read_b64_tr_b16 v[18:19], v2 offset:35328
    v_mfma_f32_16x16x32_bf16 v[56:59], v[28:31], v[76:79], v[56:59]
    ds_read_b64_tr_b16 v[20:21], v2 offset:35840
    v_mfma_f32_16x16x32_bf16 v[56:59], v[24:27], v[72:75], v[56:59]
    ds_read_b64_tr_b16 v[22:23], v2 offset:36352
    s_waitcnt lgkmcnt(4)
    v_mfma_f32_16x16x32_bf16 v[44:47], v[8:11], v[64:67], v[44:47]
    ds_read_b64_tr_b16 v[24:25], v3 offset:34816
    v_mfma_f32_16x16x32_bf16 v[44:47], v[12:15], v[68:71], v[44:47]
    ds_read_b64_tr_b16 v[26:27], v3 offset:35328
    v_mfma_f32_16x16x32_bf16 v[60:63], v[12:15], v[76:79], v[60:63]
    ds_read_b64_tr_b16 v[28:29], v3 offset:35840
    v_mfma_f32_16x16x32_bf16 v[60:63], v[8:11], v[72:75], v[60:63]
    ds_read_b64_tr_b16 v[30:31], v3 offset:36352
    s_waitcnt lgkmcnt(4)
    v_mfma_f32_16x16x32_bf16 v[32:35], v[16:19], v[80:83], v[32:35]
    ds_read_b64_tr_b16 v[8:9], v2 offset:35072
    v_mfma_f32_16x16x32_bf16 v[32:35], v[20:23], v[84:87], v[32:35]
    ds_read_b64_tr_b16 v[10:11], v2 offset:35584
    v_mfma_f32_16x16x32_bf16 v[48:51], v[20:23], v[92:95], v[48:51]
    ds_read_b64_tr_b16 v[12:13], v2 offset:36096
    v_mfma_f32_16x16x32_bf16 v[48:51], v[16:19], v[88:91], v[48:51]
    ds_read_b64_tr_b16 v[14:15], v2 offset:36608
    ds_read_b32 v7, v0 offset:48
    s_waitcnt lgkmcnt(5)
    v_mfma_f32_16x16x32_bf16 v[36:39], v[24:27], v[80:83], v[36:39]
    ds_read_b64_tr_b16 v[16:17], v3 offset:35072
    v_mfma_f32_16x16x32_bf16 v[36:39], v[28:31], v[84:87], v[36:39]
    ds_read_b64_tr_b16 v[18:19], v3 offset:35584
    v_mfma_f32_16x16x32_bf16 v[52:55], v[28:31], v[92:95], v[52:55]
    ds_read_b64_tr_b16 v[20:21], v3 offset:36096
    v_mfma_f32_16x16x32_bf16 v[52:55], v[24:27], v[88:91], v[52:55]
    ds_read_b64_tr_b16 v[22:23], v3 offset:36608
    s_waitcnt lgkmcnt(4)
    v_cmp_ne_u32 vcc, 0x1010101, v7
    s_nop 1
    s_cbranch_vccnz L_cs28
L_cb29:
    v_mfma_f32_16x16x32_bf16 v[40:43], v[8:11], v[80:83], v[40:43]
    ds_read_b64_tr_b16 v[24:25], v2 offset:49152
    v_mfma_f32_16x16x32_bf16 v[40:43], v[12:15], v[84:87], v[40:43]
    ds_read_b64_tr_b16 v[26:27], v2 offset:49664
    v_mfma_f32_16x16x32_bf16 v[56:59], v[12:15], v[92:95], v[56:59]
    ds_read_b64_tr_b16 v[28:29], v2 offset:50176
    v_mfma_f32_16x16x32_bf16 v[56:59], v[8:11], v[88:91], v[56:59]
    ds_read_b64_tr_b16 v[30:31], v2 offset:50688
    s_waitcnt lgkmcnt(4)
    v_mfma_f32_16x16x32_bf16 v[44:47], v[16:19], v[80:83], v[44:47]
    ds_read_b64_tr_b16 v[8:9], v3 offset:49152
    v_mfma_f32_16x16x32_bf16 v[44:47], v[20:23], v[84:87], v[44:47]
    ds_read_b64_tr_b16 v[10:11], v3 offset:49664
    v_mfma_f32_16x16x32_bf16 v[60:63], v[20:23], v[92:95], v[60:63]
    ds_read_b64_tr_b16 v[12:13], v3 offset:50176
    v_mfma_f32_16x16x32_bf16 v[60:63], v[16:19], v[88:91], v[60:63]
    ds_read_b64_tr_b16 v[14:15], v3 offset:50688
    s_waitcnt lgkmcnt(4)
    v_mfma_f32_16x16x32_bf16 v[32:35], v[24:27], v[96:99], v[32:35]
    ds_read_b64_tr_b16 v[16:17], v2 offset:49408
    v_mfma_f32_16x16x32_bf16 v[32:35], v[28:31], v[100:103], v[32:35]
    ds_read_b64_tr_b16 v[18:19], v2 offset:49920
    v_mfma_f32_16x16x32_bf16 v[48:51], v[28:31], v[108:111], v[48:51]
    ds_read_b64_tr_b16 v[20:21], v2 offset:50432
    v_mfma_f32_16x16x32_bf16 v[48:51], v[24:27], v[104:107], v[48:51]
    ds_read_b64_tr_b16 v[22:23], v2 offset:50944
    s_waitcnt lgkmcnt(4)
    v_mfma_f32_16x16x32_bf16 v[36:39], v[8:11], v[96:99], v[36:39]
    ds_read_b64_tr_b16 v[24:25], v3 offset:49408
    v_mfma_f32_16x16x32_bf16 v[36:39], v[12:15], v[100:103], v[36:39]
    ds_read_b64_tr_b16 v[26:27], v3 offset:49920
    v_mfma_f32_16x16x32_bf16 v[52:55], v[12:15], v[108:111], v[52:55]
    ds_read_b64_tr_b16 v[28:29], v3 offset:50432
    v_mfma_f32_16x16x32_bf16 v[52:55], v[8:11], v[104:107], v[52:55]
    ds_read_b64_tr_b16 v[30:31], v3 offset:50944
    s_waitcnt lgkmcnt(4)
    v_mfma_f32_16x16x32_bf16 v[40:43], v[16:19], v[96:99], v[40:43]
    ds_read_b64_tr_b16 v[8:9], v2 offset:51200
    v_mfma_f32_16x16x32_bf16 v[40:43], v[20:23], v[100:103], v[40:43]
    ds_read_b64_tr_b16 v[10:11], v2 offset:51712
    v_mfma_f32_16x16x32_bf16 v[56:59], v[20:23], v[108:111], v[56:59]
    ds_read_b64_tr_b16 v[12:13], v2 offset:52224
    v_mfma_f32_16x16x32_bf16 v[56:59], v[16:19], v[104:107], v[56:59]
    ds_read_b64_tr_b16 v[14:15], v2 offset:52736
    s_waitcnt lgkmcnt(4)
    v_mfma_f32_16x16x32_bf16 v[44:47], v[24:27], v[96:99], v[44:47]
    ds_read_b64_tr_b16 v[16:17], v3 offset:51200
    v_mfma_f32_16x16x32_bf16 v[44:47], v[28:31], v[100:103], v[44:47]
    ds_read_b64_tr_b16 v[18:19], v3 offset:51712
    v_mfma_f32_16x16x32_bf16 v[60:63], v[28:31], v[108:111], v[60:63]
    ds_read_b64_tr_b16 v[20:21], v3 offset:52224
    v_mfma_f32_16x16x32_bf16 v[60:63], v[24:27], v[104:107], v[60:63]
    ds_read_b64_tr_b16 v[22:23], v3 offset:52736
    s_waitcnt lgkmcnt(4)
    v_mfma_f32_16x16x32_bf16 v[32:35], v[8:11], v[112:115], v[32:35]
    ds_read_b64_tr_b16 v[24:25], v2 offset:51456
    v_mfma_f32_16x16x32_bf16 v[32:35], v[12:15], v[116:119], v[32:35]
    ds_read_b64_tr_b16 v[26:27], v2 offset:51968
    v_mfma_f32_16x16x32_bf16 v[48:51], v[12:15], v[124:127], v[48:51]
    ds_read_b64_tr_b16 v[28:29], v2 offset:52480
    v_mfma_f32_16x16x32_bf16 v[48:51], v[8:11], v[120:123], v[48:51]
    ds_read_b64_tr_b16 v[30:31], v2 offset:52992
    s_waitcnt lgkmcnt(4)
    v_mfma_f32_16x16x32_bf16 v[36:39], v[16:19], v[112:115], v[36:39]
    ds_read_b64_tr_b16 v[8:9], v3 offset:51456
    v_mfma_f32_16x16x32_bf16 v[36:39], v[20:23], v[116:119], v[36:39]
    ds_read_b64_tr_b16 v[10:11], v3 offset:51968
    v_mfma_f32_16x16x32_bf16 v[52:55], v[20:23], v[124:127], v[52:55]
    ds_read_b64_tr_b16 v[12:13], v3 offset:52480
    v_mfma_f32_16x16x32_bf16 v[52:55], v[16:19], v[120:123], v[52:55]
    ds_read_b64_tr_b16 v[14:15], v3 offset:52992
    s_waitcnt lgkmcnt(4)
    v_mfma_f32_16x16x32_bf16 v[40:43], v[24:27], v[112:115], v[40:43]
    v_mfma_f32_16x16x32_bf16 v[40:43], v[28:31], v[116:119], v[40:43]
    v_mfma_f32_16x16x32_bf16 v[56:59], v[28:31], v[124:127], v[56:59]
    v_mfma_f32_16x16x32_bf16 v[56:59], v[24:27], v[120:123], v[56:59]
    s_waitcnt lgkmcnt(0)
    v_mfma_f32_16x16x32_bf16 v[44:47], v[8:11], v[112:115], v[44:47]
    v_mfma_f32_16x16x32_bf16 v[44:47], v[12:15], v[116:119], v[44:47]
    v_mfma_f32_16x16x32_bf16 v[60:63], v[12:15], v[124:127], v[60:63]
    v_mfma_f32_16x16x32_bf16 v[60:63], v[8:11], v[120:123], v[60:63]
    s_setprio 3
    v_mov_b32 v112, 1
    s_mov_b64 exec, 1
    ds_write_b8 v1, v112 offset:56
    s_mov_b64 exec, -1
    v_mbcnt_lo_u32_b32 v113, -1, 0
    v_mbcnt_hi_u32_b32 v113, -1, v113
    v_and_b32 v118, 15, v113
    s_lshl_b32 s58, s27, 7
    s_add_u32 s58, s58, 131072
    v_lshl_add_u32 v118, v118, 2, s58
    v_lshrrev_b32 v119, 4, v113
    v_lshlrev_b32 v119, 4, v119
    v_add_u32 v119, 133120, v119
    ds_read_b32 v8, v118 offset:0
    ds_read_b32 v12, v118 offset:1024
    ds_read_b32 v10, v118 offset:64
    ds_read_b32 v14, v118 offset:1088
    ds_read_b128 v[16:19], v119 offset:0
    ds_read_b128 v[20:23], v119 offset:64
    ds_read_b128 v[24:27], v119 offset:128
    ds_read_b128 v[28:31], v119 offset:192
    v_mov_b32 v114, 0xff
    v_mov_b32 v115, 1073741824
    v_lshlrev_b32 v116, 4, v113
    s_mov_b32 s52, 0x3f317218
    s_mov_b32 s53, 0x3f317218
    s_mov_b32 s54, 0x35c1a2a0
    s_waitcnt lgkmcnt(0)
    v_pk_fma_f32 v[64:65], v[8:9], v[16:17], v[32:33] op_sel_hi:[0,1,1] neg_lo:[1,0,0] neg_hi:[1,0,0]
    v_pk_fma_f32 v[72:73], v[8:9], v[20:21], v[36:37] op_sel_hi:[0,1,1] neg_lo:[1,0,0] neg_hi:[1,0,0]
    v_pk_fma_f32 v[80:81], v[8:9], v[24:25], v[40:41] op_sel_hi:[0,1,1] neg_lo:[1,0,0] neg_hi:[1,0,0]
    v_pk_fma_f32 v[88:89], v[8:9], v[28:29], v[44:45] op_sel_hi:[0,1,1] neg_lo:[1,0,0] neg_hi:[1,0,0]
    v_pk_fma_f32 v[66:67], v[8:9], v[18:19], v[34:35] op_sel_hi:[0,1,1] neg_lo:[1,0,0] neg_hi:[1,0,0]
    v_pk_fma_f32 v[74:75], v[8:9], v[22:23], v[38:39] op_sel_hi:[0,1,1] neg_lo:[1,0,0] neg_hi:[1,0,0]
    v_pk_fma_f32 v[82:83], v[8:9], v[26:27], v[42:43] op_sel_hi:[0,1,1] neg_lo:[1,0,0] neg_hi:[1,0,0]
    v_pk_fma_f32 v[90:91], v[8:9], v[30:31], v[46:47] op_sel_hi:[0,1,1] neg_lo:[1,0,0] neg_hi:[1,0,0]
    v_pk_mul_f32 v[64:65], v[64:65], v[12:13] op_sel_hi:[1,0]
    v_pk_mul_f32 v[72:73], v[72:73], v[12:13] op_sel_hi:[1,0]
    v_pk_mul_f32 v[80:81], v[80:81], v[12:13] op_sel_hi:[1,0]
    v_pk_mul_f32 v[88:89], v[88:89], v[12:13] op_sel_hi:[1,0]
    v_pk_mul_f32 v[66:67], v[66:67], v[12:13] op_sel_hi:[1,0]
    v_pk_mul_f32 v[74:75], v[74:75], v[12:13] op_sel_hi:[1,0]
    v_pk_mul_f32 v[82:83], v[82:83], v[12:13] op_sel_hi:[1,0]
    v_pk_mul_f32 v[90:91], v[90:91], v[12:13] op_sel_hi:[1,0]
    v_exp_f32 v68, v64 clamp
    v_exp_f32 v76, v72 clamp
    v_exp_f32 v84, v80 clamp
    v_exp_f32 v92, v88 clamp
    v_exp_f32 v69, v65 clamp
    v_exp_f32 v77, v73 clamp
    v_exp_f32 v85, v81 clamp
    v_exp_f32 v93, v89 clamp
    v_exp_f32 v70, v66 clamp
    v_exp_f32 v78, v74 clamp
    v_exp_f32 v86, v82 clamp
    v_exp_f32 v94, v90 clamp
    v_exp_f32 v71, v67 clamp
    v_exp_f32 v79, v75 clamp
    v_exp_f32 v87, v83 clamp
    v_exp_f32 v95, v91 clamp
    v_max_f32 v64, s54, v64
    v_max_f32 v72, s54, v72
    v_max_f32 v80, s54, v80
    v_max_f32 v88, s54, v88
    v_max_f32 v65, s54, v65
    v_max_f32 v73, s54, v73
    v_max_f32 v81, s54, v81
    v_max_f32 v89, s54, v89
    v_max_f32 v66, s54, v66
    v_max_f32 v74, s54, v74
    v_max_f32 v82, s54, v82
    v_max_f32 v90, s54, v90
    v_max_f32 v67, s54, v67
    v_max_f32 v75, s54, v75
    v_max_f32 v83, s54, v83
    v_max_f32 v91, s54, v91
    v_pk_fma_f32 v[64:65], v[64:65], s[52:53], v[68:69]
    v_pk_fma_f32 v[72:73], v[72:73], s[52:53], v[76:77]
    v_pk_fma_f32 v[80:81], v[80:81], s[52:53], v[84:85]
    v_pk_fma_f32 v[88:89], v[88:89], s[52:53], v[92:93]
    v_pk_fma_f32 v[66:67], v[66:67], s[52:53], v[70:71]
    v_pk_fma_f32 v[74:75], v[74:75], s[52:53], v[78:79]
    v_pk_fma_f32 v[82:83], v[82:83], s[52:53], v[86:87]
    v_pk_fma_f32 v[90:91], v[90:91], s[52:53], v[94:95]
    v_cvt_pk_bf16_f32 v240, v64, v65
    v_cvt_pk_bf16_f32 v242, v72, v73
    v_cvt_pk_bf16_f32 v244, v80, v81
    v_cvt_pk_bf16_f32 v246, v88, v89
    v_cvt_pk_bf16_f32 v241, v66, v67
    v_cvt_pk_bf16_f32 v243, v74, v75
    v_cvt_pk_bf16_f32 v245, v82, v83
    v_cvt_pk_bf16_f32 v247, v90, v91
    v_pk_fma_f32 v[64:65], v[10:11], v[16:17], v[48:49] op_sel_hi:[0,1,1] neg_lo:[1,0,0] neg_hi:[1,0,0]
    v_pk_fma_f32 v[72:73], v[10:11], v[20:21], v[52:53] op_sel_hi:[0,1,1] neg_lo:[1,0,0] neg_hi:[1,0,0]
    v_pk_fma_f32 v[80:81], v[10:11], v[24:25], v[56:57] op_sel_hi:[0,1,1] neg_lo:[1,0,0] neg_hi:[1,0,0]
    v_pk_fma_f32 v[88:89], v[10:11], v[28:29], v[60:61] op_sel_hi:[0,1,1] neg_lo:[1,0,0] neg_hi:[1,0,0]
    v_pk_fma_f32 v[66:67], v[10:11], v[18:19], v[50:51] op_sel_hi:[0,1,1] neg_lo:[1,0,0] neg_hi:[1,0,0]
    v_pk_fma_f32 v[74:75], v[10:11], v[22:23], v[54:55] op_sel_hi:[0,1,1] neg_lo:[1,0,0] neg_hi:[1,0,0]
    v_pk_fma_f32 v[82:83], v[10:11], v[26:27], v[58:59] op_sel_hi:[0,1,1] neg_lo:[1,0,0] neg_hi:[1,0,0]
    v_pk_fma_f32 v[90:91], v[10:11], v[30:31], v[62:63] op_sel_hi:[0,1,1] neg_lo:[1,0,0] neg_hi:[1,0,0]
    v_pk_mul_f32 v[64:65], v[64:65], v[14:15] op_sel_hi:[1,0]
    v_pk_mul_f32 v[72:73], v[72:73], v[14:15] op_sel_hi:[1,0]
    v_pk_mul_f32 v[80:81], v[80:81], v[14:15] op_sel_hi:[1,0]
    v_pk_mul_f32 v[88:89], v[88:89], v[14:15] op_sel_hi:[1,0]
    v_pk_mul_f32 v[66:67], v[66:67], v[14:15] op_sel_hi:[1,0]
    v_pk_mul_f32 v[74:75], v[74:75], v[14:15] op_sel_hi:[1,0]
    v_pk_mul_f32 v[82:83], v[82:83], v[14:15] op_sel_hi:[1,0]
    v_pk_mul_f32 v[90:91], v[90:91], v[14:15] op_sel_hi:[1,0]
    v_exp_f32 v68, v64 clamp
    v_exp_f32 v76, v72 clamp
    v_exp_f32 v84, v80 clamp
    v_exp_f32 v92, v88 clamp
    v_exp_f32 v69, v65 clamp
    v_exp_f32 v77, v73 clamp
    v_exp_f32 v85, v81 clamp
    v_exp_f32 v93, v89 clamp
    v_exp_f32 v70, v66 clamp
    v_exp_f32 v78, v74 clamp
    v_exp_f32 v86, v82 clamp
    v_exp_f32 v94, v90 clamp
    v_exp_f32 v71, v67 clamp
    v_exp_f32 v79, v75 clamp
    v_exp_f32 v87, v83 clamp
    v_exp_f32 v95, v91 clamp
    v_max_f32 v64, s54, v64
    v_max_f32 v72, s54, v72
    v_max_f32 v80, s54, v80
    v_max_f32 v88, s54, v88
    v_max_f32 v65, s54, v65
    v_max_f32 v73, s54, v73
    v_max_f32 v81, s54, v81
    v_max_f32 v89, s54, v89
    v_max_f32 v66, s54, v66
    v_max_f32 v74, s54, v74
    v_max_f32 v82, s54, v82
    v_max_f32 v90, s54, v90
    v_max_f32 v67, s54, v67
    v_max_f32 v75, s54, v75
    v_max_f32 v83, s54, v83
    v_max_f32 v91, s54, v91
    v_pk_fma_f32 v[64:65], v[64:65], s[52:53], v[68:69]
    v_pk_fma_f32 v[72:73], v[72:73], s[52:53], v[76:77]
    v_pk_fma_f32 v[80:81], v[80:81], s[52:53], v[84:85]
    v_pk_fma_f32 v[88:89], v[88:89], s[52:53], v[92:93]
    v_pk_fma_f32 v[66:67], v[66:67], s[52:53], v[70:71]
    v_pk_fma_f32 v[74:75], v[74:75], s[52:53], v[78:79]
    v_pk_fma_f32 v[82:83], v[82:83], s[52:53], v[86:87]
    v_pk_fma_f32 v[90:91], v[90:91], s[52:53], v[94:95]
    v_cvt_pk_bf16_f32 v248, v64, v65
    v_cvt_pk_bf16_f32 v250, v72, v73
    v_cvt_pk_bf16_f32 v252, v80, v81
    v_cvt_pk_bf16_f32 v254, v88, v89
    v_cvt_pk_bf16_f32 v249, v66, v67
    v_cvt_pk_bf16_f32 v251, v74, v75
    v_cvt_pk_bf16_f32 v253, v82, v83
    v_cvt_pk_bf16_f32 v255, v90, v91
    s_mov_b32 s57, 0
L_sl31:
    ds_read_b32 v117, v0 offset:20
    s_waitcnt lgkmcnt(0)
    v_cmp_ne_u32 vcc, 0x1010101, v117
    s_add_u32 s57, s57, 1
    s_nop 0
    s_cbranch_vccz L_sld32
    s_sleep 1
    s_cmp_lt_u32 s57, 262144
    s_cbranch_scc1 L_sl31
L_sld32:
    v_add_u32 v118, 136192, v116
    ds_read_b128 v[208:211], v118 offset:0
    ds_read_b128 v[212:215], v118 offset:1024
    ds_read_b128 v[224:227], v118 offset:2048
    ds_read_b128 v[216:219], v118 offset:3072
    ds_read_b128 v[220:223], v118 offset:4096
    ds_read_b128 v[228:231], v118 offset:5120
    s_lshl_b32 s58, s22, 3
    s_lshl_b32 s59, s27, 1
    s_add_u32 s58, s58, s59
    s_lshl_b32 s58, s58, 5
    s_xor_b32 s59, s23, 1
    s_lshl_b32 s59, s59, 1
    s_add_u32 s58, s58, s59
    s_lshl_b32 s58, s58, 10
    s_add_u32 s59, s58, 32768
    s_mov_b32 s55, 0x358637bd
    s_waitcnt lgkmcnt(0)
    v_mfma_f32_16x16x32_bf16 v[16:19], v[224:227], v[240:243], 0
    v_mfma_f32_16x16x32_bf16 v[8:11], v[208:211], v[240:243], 0
    v_mfma_f32_16x16x32_bf16 v[12:15], v[212:215], v[240:243], 0
    v_mfma_f32_16x16x32_bf16 v[28:31], v[228:231], v[244:247], 0
    v_mfma_f32_16x16x32_bf16 v[20:23], v[216:219], v[244:247], 0
    v_mfma_f32_16x16x32_bf16 v[24:27], v[220:223], v[244:247], 0
    v_mfma_f32_16x16x32_bf16 v[40:43], v[224:227], v[248:251], 0
    v_mfma_f32_16x16x32_bf16 v[32:35], v[208:211], v[248:251], 0
    v_mfma_f32_16x16x32_bf16 v[36:39], v[212:215], v[248:251], 0
    v_mfma_f32_16x16x32_bf16 v[52:55], v[228:231], v[252:255], 0
    v_mfma_f32_16x16x32_bf16 v[44:47], v[216:219], v[252:255], 0
    v_mfma_f32_16x16x32_bf16 v[48:51], v[220:223], v[252:255], 0
    v_add_f32 v16, s55, v16
    v_add_f32 v28, s55, v28
    s_nop 0
    v_add_f32 v40, s55, v40
    s_nop 1
    v_add_f32 v52, s55, v52
    v_rcp_f32 v16, v16
    v_rcp_f32 v28, v28
    v_rcp_f32 v40, v40
    v_rcp_f32 v52, v52
    v_pk_mul_f32 v[8:9], v[8:9], v[16:17] op_sel_hi:[1,0]
    v_pk_mul_f32 v[12:13], v[12:13], v[16:17] op_sel_hi:[1,0]
    v_pk_mul_f32 v[10:11], v[10:11], v[16:17] op_sel_hi:[1,0]
    v_pk_mul_f32 v[14:15], v[14:15], v[16:17] op_sel_hi:[1,0]
    v_cvt_pk_bf16_f32 v192, v8, v9
    v_cvt_pk_bf16_f32 v194, v12, v13
    v_cvt_pk_bf16_f32 v193, v10, v11
    v_cvt_pk_bf16_f32 v195, v14, v15
    buffer_store_dwordx4 v[192:195], v116, s[16:19], s58 offen offset:0 sc1
    v_pk_mul_f32 v[20:21], v[20:21], v[28:29] op_sel_hi:[1,0]
    v_pk_mul_f32 v[24:25], v[24:25], v[28:29] op_sel_hi:[1,0]
    v_pk_mul_f32 v[22:23], v[22:23], v[28:29] op_sel_hi:[1,0]
    v_pk_mul_f32 v[26:27], v[26:27], v[28:29] op_sel_hi:[1,0]
    v_cvt_pk_bf16_f32 v196, v20, v21
    v_cvt_pk_bf16_f32 v198, v24, v25
    v_cvt_pk_bf16_f32 v197, v22, v23
    v_cvt_pk_bf16_f32 v199, v26, v27
    buffer_store_dwordx4 v[196:199], v116, s[16:19], s58 offen offset:1024 sc1
    v_pk_mul_f32 v[32:33], v[32:33], v[40:41] op_sel_hi:[1,0]
    v_pk_mul_f32 v[36:37], v[36:37], v[40:41] op_sel_hi:[1,0]
    v_pk_mul_f32 v[34:35], v[34:35], v[40:41] op_sel_hi:[1,0]
    v_pk_mul_f32 v[38:39], v[38:39], v[40:41] op_sel_hi:[1,0]
    v_cvt_pk_bf16_f32 v200, v32, v33
    v_cvt_pk_bf16_f32 v202, v36, v37
    v_cvt_pk_bf16_f32 v201, v34, v35
    v_cvt_pk_bf16_f32 v203, v38, v39
    buffer_store_dwordx4 v[200:203], v116, s[16:19], s59 offen offset:0 sc1
    v_pk_mul_f32 v[44:45], v[44:45], v[52:53] op_sel_hi:[1,0]
    v_pk_mul_f32 v[48:49], v[48:49], v[52:53] op_sel_hi:[1,0]
    v_pk_mul_f32 v[46:47], v[46:47], v[52:53] op_sel_hi:[1,0]
    v_pk_mul_f32 v[50:51], v[50:51], v[52:53] op_sel_hi:[1,0]
    v_cvt_pk_bf16_f32 v204, v44, v45
    v_cvt_pk_bf16_f32 v206, v48, v49
    v_cvt_pk_bf16_f32 v205, v46, v47
    v_cvt_pk_bf16_f32 v207, v50, v51
    buffer_store_dwordx4 v[204:207], v116, s[16:19], s59 offen offset:1024 sc1
    s_lshl_b32 s58, s22, 2
    s_add_u32 s58, s58, s27
    s_lshl_b32 s58, s58, 4
    s_add_u32 s58, s58, s23
    s_lshl_b32 s58, s58, 7
    s_add_u32 s58, s58, 8650752
    v_lshlrev_b32 v118, 24, v113
    v_mov_b32 v119, s60
    s_mov_b64 exec, 1
    ds_write_b8 v1, v112 offset:160
    s_mov_b64 exec, -1
    s_waitcnt vmcnt(0)
    buffer_store_dword v119, v118, s[16:19], s58 offen sc1
    ds_read_b32 v118, v0 offset:72
    v_and_b32 v119, 1, v113
    v_mov_b32 v120, 0xffff
    v_mov_b32 v121, 0xffff0000
    v_cmp_eq_u32 vcc, 1, v119
    s_nop 1
    v_cndmask_b32 v120, v120, v121, vcc
    v_lshrrev_b32 v119, 1, v113
    v_xor_b32 v119, v119, v113
    v_and_b32 v119, 8, v119
    v_cmp_eq_u32 vcc, 0, v119
    s_nop 1
    v_cndmask_b32 v120, 0, v120, vcc
    v_bfe_u32 v119, v113, 1, 2
    v_cmp_eq_u32 vcc, 0, v119
    s_nop 1
    v_cndmask_b32 v12, 0, v120, vcc
    v_cmp_eq_u32 vcc, 1, v119
    s_nop 1
    v_cndmask_b32 v13, 0, v120, vcc
    v_cmp_eq_u32 vcc, 2, v119
    s_nop 1
    v_cndmask_b32 v14, 0, v120, vcc
    v_cmp_eq_u32 vcc, 3, v119
    s_nop 1
    v_cndmask_b32 v15, 0, v120, vcc
    v_and_b32 v119, 15, v113
    v_lshlrev_b32 v122, 5, v119
    v_bfe_u32 v119, v113, 4, 1
    v_lshl_add_u32 v122, v119, 4, v122
    v_lshrrev_b32 v119, 5, v113
    v_lshl_add_u32 v122, v119, 9, v122
    v_lshrrev_b32 v121, 5, v113
    v_lshlrev_b32 v121, 2, v121
    s_waitcnt lgkmcnt(0)
    v_readfirstlane_b32 s91, v118
    s_nop 0
    s_and_b32 s92, s91, 0x7ff
    s_sub_u32 s92, 0x7ff, s92
    s_cmp_ge_u32 s3, 224
    s_cbranch_scc1 L_moe_done
    v_add_u32 v119, 133632, v121
    s_mov_b32 s57, 0
L_sl33:
    ds_read_b32 v117, v0 offset:68
    s_waitcnt lgkmcnt(0)
    v_cmp_ne_u32 vcc, 0x1, v117
    s_add_u32 s57, s57, 1
    s_nop 0
    s_cbranch_vccz L_sld34
    s_sleep 1
    s_cmp_lt_u32 s57, 262144
    s_cbranch_scc1 L_sl33
L_sld34:
    ds_read_b32 v32, v119 offset:0
    ds_read_b32 v33, v119 offset:8
    ds_read_b32 v34, v119 offset:16
    ds_read_b32 v35, v119 offset:24
    ds_read_b32 v36, v119 offset:32
    ds_read_b32 v37, v119 offset:40
    ds_read_b32 v38, v119 offset:48
    ds_read_b32 v39, v119 offset:56
    s_waitcnt vmcnt(0) lgkmcnt(0)
    v_and_b32 v16, v32, v12
    v_and_b32 v17, v32, v13
    v_and_b32 v18, v32, v14
    v_and_b32 v19, v32, v15
    s_nop 1
    v_mfma_f32_16x16x32_bf16 v[24:27], v[16:19], v[128:131], 0
    v_and_b32 v20, v33, v12
    v_and_b32 v21, v33, v13
    v_and_b32 v22, v33, v14
    v_and_b32 v23, v33, v15
    s_nop 1
    v_mfma_f32_16x16x32_bf16 v[24:27], v[20:23], v[132:135], v[24:27]
    v_and_b32 v16, v34, v12
    v_and_b32 v17, v34, v13
    v_and_b32 v18, v34, v14
    v_and_b32 v19, v34, v15
    s_nop 1
    v_mfma_f32_16x16x32_bf16 v[24:27], v[16:19], v[136:139], v[24:27]
    v_and_b32 v20, v35, v12
    v_and_b32 v21, v35, v13
    v_and_b32 v22, v35, v14
    v_and_b32 v23, v35, v15
    s_nop 1
    v_mfma_f32_16x16x32_bf16 v[24:27], v[20:23], v[140:143], v[24:27]
    v_and_b32 v16, v36, v12
    v_and_b32 v17, v36, v13
    v_and_b32 v18, v36, v14
    v_and_b32 v19, v36, v15
    s_nop 1
    v_mfma_f32_16x16x32_bf16 v[24:27], v[16:19], v[144:147], v[24:27]
    v_and_b32 v20, v37, v12
    v_and_b32 v21, v37, v13
    v_and_b32 v22, v37, v14
    v_and_b32 v23, v37, v15
    s_nop 1
    v_mfma_f32_16x16x32_bf16 v[24:27], v[20:23], v[148:151], v[24:27]
    v_and_b32 v16, v38, v12
    v_and_b32 v17, v38, v13
    v_and_b32 v18, v38, v14
    v_and_b32 v19, v38, v15
    s_nop 1
    v_mfma_f32_16x16x32_bf16 v[24:27], v[16:19], v[152:155], v[24:27]
    v_and_b32 v20, v39, v12
    v_and_b32 v21, v39, v13
    v_and_b32 v22, v39, v14
    v_and_b32 v23, v39, v15
    s_nop 1
    v_mfma_f32_16x16x32_bf16 v[24:27], v[20:23], v[156:159], v[24:27]
    s_nop 7
    v_bfi_b32 v24, v114, s60, v24
    v_bfi_b32 v25, v114, s61, v25
    v_bfi_b32 v26, v114, s62, v26
    v_bfi_b32 v27, v114, s63, v27
    s_lshl_b32 s58, s3, 12
    s_add_u32 s58, s58, s80
    s_add_u32 s58, s58, 9437184
    buffer_store_dwordx4 v[24:27], v122, s[16:19], s58 offen sc1
    s_cmp_lg_u32 s27, 1
    s_cbranch_scc1 L_moe_done
    v_lshrrev_b32 v118, 3, v113
    v_lshlrev_b32 v118, 12, v118
    v_and_b32 v119, 7, v113
    v_lshl_add_u32 v118, v119, 4, v118
    s_lshr_b32 s58, s3, 5
    s_and_b32 s59, s3, 31
    s_lshl_b32 s59, s59, 7
    s_lshl_b32 s95, s58, 17
    s_add_u32 s95, s95, s59
    s_add_u32 s95, s95, 9437184
    s_lshl_b32 s94, s58, 12
    s_add_u32 s94, s94, s59
    s_add_u32 s94, s94, 10420224
    v_cmp_gt_u32 vcc, 8, v113
    s_nop 1
    v_cndmask_b32 v119, v115, v116, vcc
    s_mov_b32 s57, 0
L_sl35:
    ds_read_b32 v117, v0 offset:0
    s_waitcnt lgkmcnt(0)
    v_cmp_ne_u32 vcc, 0x1010101, v117
    s_add_u32 s57, s57, 1
    s_nop 0
    s_cbranch_vccz L_sld36
    s_sleep 1
    s_cmp_lt_u32 s57, 262144
    s_cbranch_scc1 L_sl35
L_sld36:
    s_sleep 6
    s_add_u32 s58, s95, 0
    buffer_load_dwordx4 v[128:131], v118, s[16:19], s58 offen sc1
    s_add_u32 s58, s95, 32768
    buffer_load_dwordx4 v[132:135], v118, s[16:19], s58 offen sc1
    s_add_u32 s58, s95, 65536
    buffer_load_dwordx4 v[136:139], v118, s[16:19], s58 offen sc1
    s_add_u32 s58, s95, 98304
    buffer_load_dwordx4 v[140:143], v118, s[16:19], s58 offen sc1
    s_waitcnt vmcnt(3)
    v_perm_b32 v60, v129, v128, s64
    v_perm_b32 v61, v131, v130, s65
    v_or_b32 v60, v60, v61
    v_cmp_ne_u32 vcc, s60, v60
    s_mov_b32 s57, 0
    s_nop 0
    s_cbranch_vccz L_gk37
L_gt38:
    s_sleep 6
    s_add_u32 s58, s95, 0
    buffer_load_dwordx4 v[128:131], v118, s[16:19], s58 offen sc1
    s_add_u32 s58, s95, 32768
    buffer_load_dwordx4 v[132:135], v118, s[16:19], s58 offen sc1
    s_add_u32 s58, s95, 65536
    buffer_load_dwordx4 v[136:139], v118, s[16:19], s58 offen sc1
    s_add_u32 s58, s95, 98304
    buffer_load_dwordx4 v[140:143], v118, s[16:19], s58 offen sc1
    s_waitcnt vmcnt(0)
    v_perm_b32 v60, v129, v128, s64
    v_perm_b32 v61, v131, v130, s65
    v_or_b32 v60, v60, v61
    v_cmp_ne_u32 vcc, s60, v60
    s_add_u32 s57, s57, 1
    s_nop 0
    s_cbranch_vccz L_gk37
    s_cmp_lt_u32 s57, 32768
    s_cbranch_scc1 L_gt38
L_gk37:
    v_and_b32 v128, 0xffffff00, v128
    v_and_b32 v129, 0xffffff00, v129
    v_and_b32 v130, 0xffffff00, v130
    v_and_b32 v131, 0xffffff00, v131
    s_waitcnt vmcnt(2)
    v_perm_b32 v60, v133, v132, s64
    v_perm_b32 v61, v135, v134, s65
    v_or_b32 v60, v60, v61
    v_cmp_ne_u32 vcc, s60, v60
    s_mov_b32 s57, 0
    s_nop 0
    s_cbranch_vccz L_gk40
L_gt41:
    s_sleep 6
    s_add_u32 s58, s95, 32768
    buffer_load_dwordx4 v[132:135], v118, s[16:19], s58 offen sc1
    s_add_u32 s58, s95, 65536
    buffer_load_dwordx4 v[136:139], v118, s[16:19], s58 offen sc1
    s_add_u32 s58, s95, 98304
    buffer_load_dwordx4 v[140:143], v118, s[16:19], s58 offen sc1
    s_waitcnt vmcnt(0)
    v_perm_b32 v60, v133, v132, s64
    v_perm_b32 v61, v135, v134, s65
    v_or_b32 v60, v60, v61
    v_cmp_ne_u32 vcc, s60, v60
    s_add_u32 s57, s57, 1
    s_nop 0
    s_cbranch_vccz L_gk40
    s_cmp_lt_u32 s57, 32768
    s_cbranch_scc1 L_gt41
L_gk40:
    v_and_b32 v132, 0xffffff00, v132
    v_and_b32 v133, 0xffffff00, v133
    v_and_b32 v134, 0xffffff00, v134
    v_and_b32 v135, 0xffffff00, v135
    v_pk_add_f32 v[128:129], v[128:129], v[132:133]
    v_pk_add_f32 v[130:131], v[130:131], v[134:135]
    s_waitcnt vmcnt(1)
    v_perm_b32 v60, v137, v136, s64
    v_perm_b32 v61, v139, v138, s65
    v_or_b32 v60, v60, v61
    v_cmp_ne_u32 vcc, s60, v60
    s_mov_b32 s57, 0
    s_nop 0
    s_cbranch_vccz L_gk43
L_gt44:
    s_sleep 6
    s_add_u32 s58, s95, 65536
    buffer_load_dwordx4 v[136:139], v118, s[16:19], s58 offen sc1
    s_add_u32 s58, s95, 98304
    buffer_load_dwordx4 v[140:143], v118, s[16:19], s58 offen sc1
    s_waitcnt vmcnt(0)
    v_perm_b32 v60, v137, v136, s64
    v_perm_b32 v61, v139, v138, s65
    v_or_b32 v60, v60, v61
    v_cmp_ne_u32 vcc, s60, v60
    s_add_u32 s57, s57, 1
    s_nop 0
    s_cbranch_vccz L_gk43
    s_cmp_lt_u32 s57, 32768
    s_cbranch_scc1 L_gt44
L_gk43:
    v_and_b32 v136, 0xffffff00, v136
    v_and_b32 v137, 0xffffff00, v137
    v_and_b32 v138, 0xffffff00, v138
    v_and_b32 v139, 0xffffff00, v139
    v_pk_add_f32 v[128:129], v[128:129], v[136:137]
    v_pk_add_f32 v[130:131], v[130:131], v[138:139]
    s_waitcnt vmcnt(0)
    v_perm_b32 v60, v141, v140, s64
    v_perm_b32 v61, v143, v142, s65
    v_or_b32 v60, v60, v61
    v_cmp_ne_u32 vcc, s60, v60
    s_mov_b32 s57, 0
    s_nop 0
    s_cbranch_vccz L_gk46
L_gt47:
    s_sleep 6
    s_add_u32 s58, s95, 98304
    buffer_load_dwordx4 v[140:143], v118, s[16:19], s58 offen sc1
    s_waitcnt vmcnt(0)
    v_perm_b32 v60, v141, v140, s64
    v_perm_b32 v61, v143, v142, s65
    v_or_b32 v60, v60, v61
    v_cmp_ne_u32 vcc, s60, v60
    s_add_u32 s57, s57, 1
    s_nop 0
    s_cbranch_vccz L_gk46
    s_cmp_lt_u32 s57, 32768
    s_cbranch_scc1 L_gt47
L_gk46:
    v_and_b32 v140, 0xffffff00, v140
    v_and_b32 v141, 0xffffff00, v141
    v_and_b32 v142, 0xffffff00, v142
    v_and_b32 v143, 0xffffff00, v143
    v_pk_add_f32 v[128:129], v[128:129], v[140:141]
    v_pk_add_f32 v[130:131], v[130:131], v[142:143]
    s_nop 0
    v_add_f32_dpp v128, v128, v128 row_ror:8 row_mask:0xf bank_mask:0xf
    v_add_f32_dpp v129, v129, v129 row_ror:8 row_mask:0xf bank_mask:0xf
    v_add_f32_dpp v130, v130, v130 row_ror:8 row_mask:0xf bank_mask:0xf
    v_add_f32_dpp v131, v131, v131 row_ror:8 row_mask:0xf bank_mask:0xf
    v_mov_b32 v60, v128
    s_nop 1
    v_permlane16_swap_b32 v128, v60
    v_add_f32 v128, v128, v60
    v_mov_b32 v60, v128
    s_nop 1
    v_permlane32_swap_b32 v128, v60
    v_add_f32 v128, v128, v60
    v_mov_b32 v60, v129
    s_nop 1
    v_permlane16_swap_b32 v129, v60
    v_add_f32 v129, v129, v60
    v_mov_b32 v60, v129
    s_nop 1
    v_permlane32_swap_b32 v129, v60
    v_add_f32 v129, v129, v60
    v_mov_b32 v60, v130
    s_nop 1
    v_permlane16_swap_b32 v130, v60
    v_add_f32 v130, v130, v60
    v_mov_b32 v60, v130
    s_nop 1
    v_permlane32_swap_b32 v130, v60
    v_add_f32 v130, v130, v60
    v_mov_b32 v60, v131
    s_nop 1
    v_permlane16_swap_b32 v131, v60
    v_add_f32 v131, v131, v60
    v_mov_b32 v60, v131
    s_nop 1
    v_permlane32_swap_b32 v131, v60
    v_add_f32 v131, v131, v60
    v_bfi_b32 v128, v114, s60, v128
    v_bfi_b32 v129, v114, s61, v129
    v_bfi_b32 v130, v114, s62, v130
    v_bfi_b32 v131, v114, s63, v131
    buffer_store_dwordx4 v[128:131], v119, s[16:19], s94 offen sc1
L_moe_done:
    s_lshr_b32 s58, s92, 7
    s_cmp_lg_u32 s58, s28
    s_cbranch_scc1 L_helper_end
    s_cmp_lg_u32 s27, 0
    s_cbranch_scc1 L_helper_end
    v_lshrrev_b32 v118, 4, v113
    v_add_u32 v120, 4, v118
    v_min_u32 v120, 6, v120
    v_and_b32 v119, 15, v113
    v_lshlrev_b32 v119, 4, v119
    v_lshl_add_u32 v118, v118, 12, v119
    v_lshl_add_u32 v120, v120, 12, v119
    s_lshl_b32 s95, s29, 8
    s_add_u32 s95, s95, 10420224
    s_waitcnt vmcnt(0)
    s_mov_b32 s57, 0
L_sl49:
    ds_read_b32 v117, v0 offset:0
    s_waitcnt lgkmcnt(0)
    v_cmp_ne_u32 vcc, 0x1010101, v117
    s_add_u32 s57, s57, 1
    s_nop 0
    s_cbranch_vccz L_sld50
    s_sleep 1
    s_cmp_lt_u32 s57, 262144
    s_cbranch_scc1 L_sl49
L_sld50:
    s_sleep 34
    buffer_load_dwordx4 v[40:43], v118, s[16:19], s95 offen sc1
    buffer_load_dwordx4 v[44:47], v120, s[16:19], s95 offen sc1
    s_waitcnt vmcnt(1)
    v_perm_b32 v60, v41, v40, s64
    v_perm_b32 v61, v43, v42, s65
    v_or_b32 v60, v60, v61
    v_cmp_ne_u32 vcc, s60, v60
    s_mov_b32 s57, 0
    s_nop 0
    s_cbranch_vccz L_gk51
L_gt52:
    s_sleep 6
    buffer_load_dwordx4 v[40:43], v118, s[16:19], s95 offen sc1
    buffer_load_dwordx4 v[44:47], v120, s[16:19], s95 offen sc1
    s_waitcnt vmcnt(0)
    v_perm_b32 v60, v41, v40, s64
    v_perm_b32 v61, v43, v42, s65
    v_or_b32 v60, v60, v61
    v_cmp_ne_u32 vcc, s60, v60
    s_add_u32 s57, s57, 1
    s_nop 0
    s_cbranch_vccz L_gk51
    s_cmp_lt_u32 s57, 32768
    s_cbranch_scc1 L_gt52
L_gk51:
    v_and_b32 v40, 0xffffff00, v40
    v_and_b32 v41, 0xffffff00, v41
    v_and_b32 v42, 0xffffff00, v42
    v_and_b32 v43, 0xffffff00, v43
    s_waitcnt vmcnt(0)
    v_perm_b32 v60, v45, v44, s64
    v_perm_b32 v61, v47, v46, s65
    v_or_b32 v60, v60, v61
    v_cmp_ne_u32 vcc, s60, v60
    s_mov_b32 s57, 0
    s_nop 0
    s_cbranch_vccz L_gk54
L_gt55:
    s_sleep 6
    buffer_load_dwordx4 v[44:47], v120, s[16:19], s95 offen sc1
    s_waitcnt vmcnt(0)
    v_perm_b32 v60, v45, v44, s64
    v_perm_b32 v61, v47, v46, s65
    v_or_b32 v60, v60, v61
    v_cmp_ne_u32 vcc, s60, v60
    s_add_u32 s57, s57, 1
    s_nop 0
    s_cbranch_vccz L_gk54
    s_cmp_lt_u32 s57, 32768
    s_cbranch_scc1 L_gt55
L_gk54:
    v_and_b32 v44, 0xffffff00, v44
    v_and_b32 v45, 0xffffff00, v45
    v_and_b32 v46, 0xffffff00, v46
    v_and_b32 v47, 0xffffff00, v47
    v_cmp_gt_u32 vcc, 48, v113
    s_nop 1
    v_cndmask_b32 v44, 0, v44, vcc
    v_cndmask_b32 v45, 0, v45, vcc
    v_cndmask_b32 v46, 0, v46, vcc
    v_cndmask_b32 v47, 0, v47, vcc
    v_pk_add_f32 v[40:41], v[40:41], v[44:45]
    v_pk_add_f32 v[42:43], v[42:43], v[46:47]
    v_mov_b32 v60, v40
    s_nop 1
    v_permlane16_swap_b32 v40, v60
    v_add_f32 v40, v40, v60
    v_mov_b32 v60, v40
    s_nop 1
    v_permlane32_swap_b32 v40, v60
    v_add_f32 v40, v40, v60
    v_mov_b32 v60, v41
    s_nop 1
    v_permlane16_swap_b32 v41, v60
    v_add_f32 v41, v41, v60
    v_mov_b32 v60, v41
    s_nop 1
    v_permlane32_swap_b32 v41, v60
    v_add_f32 v41, v41, v60
    v_mov_b32 v60, v42
    s_nop 1
    v_permlane16_swap_b32 v42, v60
    v_add_f32 v42, v42, v60
    v_mov_b32 v60, v42
    s_nop 1
    v_permlane32_swap_b32 v42, v60
    v_add_f32 v42, v42, v60
    v_mov_b32 v60, v43
    s_nop 1
    v_permlane16_swap_b32 v43, v60
    v_add_f32 v43, v43, v60
    v_mov_b32 v60, v43
    s_nop 1
    v_permlane32_swap_b32 v43, v60
    v_add_f32 v43, v43, v60
    s_and_b32 s58, s91, 0xffff0000
    s_ashr_i32 s59, s58, 31
    s_not_b32 s59, s59
    s_or_b32 s59, s59, 0x80000000
    s_xor_b32 s58, s58, s59
    s_and_b32 s58, s58, 0xffff0000
    v_mov_b32 v60, s58
    v_mul_f32 v60, 0xbfb8aa3b, v60
    v_exp_f32 v60, v60
    s_nop 0
    v_add_f32 v60, 1.0, v60
    v_rcp_f32 v60, v60
    s_nop 0
    v_cvt_pk_bf16_f32 v60, v60, v60
    v_lshlrev_b32 v60, 16, v60
    v_cvt_pk_bf16_f32 v40, v40, v40
    v_lshlrev_b32 v40, 16, v40
    v_mul_f32 v40, v40, v60
    v_cvt_pk_bf16_f32 v40, v40, v40
    v_lshlrev_b32 v40, 16, v40
    v_cvt_pk_bf16_f32 v41, v41, v41
    v_lshlrev_b32 v41, 16, v41
    v_mul_f32 v41, v41, v60
    v_cvt_pk_bf16_f32 v41, v41, v41
    v_lshlrev_b32 v41, 16, v41
    v_cvt_pk_bf16_f32 v42, v42, v42
    v_lshlrev_b32 v42, 16, v42
    v_mul_f32 v42, v42, v60
    v_cvt_pk_bf16_f32 v42, v42, v42
    v_lshlrev_b32 v42, 16, v42
    v_cvt_pk_bf16_f32 v43, v43, v43
    v_lshlrev_b32 v43, 16, v43
    v_mul_f32 v43, v43, v60
    v_cvt_pk_bf16_f32 v43, v43, v43
    v_lshlrev_b32 v43, 16, v43
    v_add_u32 v118, 134912, v119
    ds_write_b128 v118, v[40:43]
    s_mov_b64 exec, 1
    s_waitcnt lgkmcnt(0)
    ds_write_b32 v0, v112 offset:64
    s_mov_b64 exec, -1
L_helper_end:
    s_endpgm
L_s1slow0:
    s_mov_b32 s57, 0
L_s1t6:
    s_sleep 8
    s_mov_b32 s58, s90
    buffer_load_dwordx4 v[8:11], v32, s[16:19], s58 offen sc1
    s_add_u32 s58, s58, s95
    buffer_load_dwordx4 v[12:15], v32, s[16:19], s58 offen sc1
    s_add_u32 s58, s58, s87
    buffer_load_dwordx4 v[16:19], v32, s[16:19], s58 offen sc1
    s_add_u32 s58, s58, s74
    buffer_load_dwordx4 v[20:23], v32, s[16:19], s58 offen sc1
    s_waitcnt vmcnt(0)
    v_perm_b32 v24, v9, v8, s64
    v_perm_b32 v35, v11, v10, s65
    v_or_b32 v24, v24, v35
    v_perm_b32 v25, v13, v12, s64
    v_perm_b32 v35, v15, v14, s65
    v_or_b32 v25, v25, v35
    v_perm_b32 v26, v17, v16, s64
    v_perm_b32 v35, v19, v18, s65
    v_or_b32 v26, v26, v35
    v_perm_b32 v27, v21, v20, s64
    v_perm_b32 v35, v23, v22, s65
    v_or_b32 v27, v27, v35
    v_max3_u32 v33, v24, v25, v26
    v_min3_u32 v34, v24, v25, v26
    v_max_u32 v33, v33, v27
    v_min_u32 v34, v34, v27
    v_cmp_ne_u32 vcc, s60, v33
    v_cmp_ne_u32 s[66:67], s60, v34
    s_nop 0
    s_or_b64 vcc, vcc, s[66:67]
    s_cbranch_scc0 L_s1back0
    s_add_u32 s57, s57, 1
    s_cmp_lt_u32 s57, 32768
    s_cbranch_scc1 L_s1t6
    s_branch L_s1back0
L_s1slow1:
    s_mov_b32 s57, 0
L_s1t7:
    s_sleep 8
    s_mov_b32 s58, s90
    buffer_load_dwordx4 v[8:11], v32, s[16:19], s58 offen sc1
    s_add_u32 s58, s58, s95
    buffer_load_dwordx4 v[12:15], v32, s[16:19], s58 offen sc1
    s_add_u32 s58, s58, s87
    buffer_load_dwordx4 v[16:19], v32, s[16:19], s58 offen sc1
    s_add_u32 s58, s58, s74
    buffer_load_dwordx4 v[20:23], v32, s[16:19], s58 offen sc1
    s_waitcnt vmcnt(0)
    s_mov_b32 s58, 0x05040100
    v_perm_b32 v24, v9, v8, s58
    v_perm_b32 v25, v11, v10, s58
    v_perm_b32 v26, v13, v12, s58
    v_perm_b32 v27, v15, v14, s58
    v_max3_u32 v33, v17, v19, v21
    v_min3_u32 v34, v17, v19, v21
    v_max3_u32 v33, v33, v23, v24
    v_min3_u32 v34, v34, v23, v24
    v_max3_u32 v33, v33, v25, v26
    v_min3_u32 v34, v34, v25, v26
    v_max_u32 v33, v33, v27
    v_min_u32 v34, v34, v27
    v_cmp_ne_u32 vcc, s60, v33
    v_cmp_ne_u32 s[66:67], s60, v34
    s_nop 0
    s_or_b64 vcc, vcc, s[66:67]
    s_cbranch_scc0 L_s1back1
    s_add_u32 s57, s57, 1
    s_cmp_lt_u32 s57, 32768
    s_cbranch_scc1 L_s1t7
    s_branch L_s1back1
L_cs10:
    s_mov_b32 s57, 0
L_cp12:
    ds_read_b32 v7, v0 offset:52
    s_waitcnt lgkmcnt(0)
    v_cmp_ne_u32 vcc, 0x1010101, v7
    s_add_u32 s57, s57, 1
    s_nop 0
    s_cbranch_vccz L_cb11
    s_cmp_lt_u32 s57, 524288
    s_cbranch_scc1 L_cp12
    s_branch L_cb11
L_cs13:
    s_mov_b32 s57, 0
L_cp15:
    ds_read_b32 v7, v0 offset:28
    s_waitcnt lgkmcnt(0)
    v_cmp_ne_u32 vcc, 0x1010101, v7
    s_add_u32 s57, s57, 1
    s_nop 0
    s_cbranch_vccz L_cb14
    s_cmp_lt_u32 s57, 524288
    s_cbranch_scc1 L_cp15
    s_branch L_cb14
L_cs16:
    s_mov_b32 s57, 0
L_cp18:
    ds_read_b32 v7, v0 offset:32
    s_waitcnt lgkmcnt(0)
    v_cmp_ne_u32 vcc, 0x1010101, v7
    s_add_u32 s57, s57, 1
    s_nop 0
    s_cbranch_vccz L_cb17
    s_cmp_lt_u32 s57, 524288
    s_cbranch_scc1 L_cp18
    s_branch L_cb17
L_cs19:
    s_mov_b32 s57, 0
L_cp21:
    ds_read_b32 v7, v0 offset:36
    s_waitcnt lgkmcnt(0)
    v_cmp_ne_u32 vcc, 0x1010101, v7
    s_add_u32 s57, s57, 1
    s_nop 0
    s_cbranch_vccz L_cb20
    s_cmp_lt_u32 s57, 524288
    s_cbranch_scc1 L_cp21
    s_branch L_cb20
L_cs22:
    s_mov_b32 s57, 0
L_cp24:
    ds_read_b32 v7, v0 offset:40
    s_waitcnt lgkmcnt(0)
    v_cmp_ne_u32 vcc, 0x1010101, v7
    s_add_u32 s57, s57, 1
    s_nop 0
    s_cbranch_vccz L_cb23
    s_cmp_lt_u32 s57, 524288
    s_cbranch_scc1 L_cp24
    s_branch L_cb23
L_cs25:
    s_mov_b32 s57, 0
L_cp27:
    ds_read_b32 v7, v0 offset:44
    s_waitcnt lgkmcnt(0)
    v_cmp_ne_u32 vcc, 0x1010101, v7
    s_add_u32 s57, s57, 1
    s_nop 0
    s_cbranch_vccz L_cb26
    s_cmp_lt_u32 s57, 524288
    s_cbranch_scc1 L_cp27
    s_branch L_cb26
L_cs28:
    s_mov_b32 s57, 0
L_cp30:
    ds_read_b32 v7, v0 offset:48
    s_waitcnt lgkmcnt(0)
    v_cmp_ne_u32 vcc, 0x1010101, v7
    s_add_u32 s57, s57, 1
    s_nop 0
    s_cbranch_vccz L_cb29
    s_cmp_lt_u32 s57, 524288
    s_cbranch_scc1 L_cp30
    s_branch L_cb29
L_kwave:
    s_mov_b32 s74, s70
    s_mov_b32 s75, s71
    s_lshr_b32 s36, s27, 1
    s_and_b32 s37, s27, 1
    v_and_b32 v12, 15, v1
    v_lshrrev_b32 v13, 4, v1
    v_mov_b32 v122, 133376
    v_add_u32 v123, s27, v122
    v_mov_b32 v124, 1
    v_lshl_add_u32 v2, v1, 2, v122
    v_mov_b32 v3, 0
    s_mov_b64 exec, 0x3ffff
    ds_write_b32 v2, v3
    ds_write_b32 v2, v3 offset:160
    s_mov_b64 exec, -1
    s_lshl_b32 s58, s36, 13
    v_lshlrev_b32 v14, 7, v12
    v_add_u32 v14, s58, v14
    v_bfe_u32 v15, v12, 1, 3
    v_add_u32 v2, 0, v13
    v_xor_b32 v2, v2, v15
    v_lshl_add_u32 v112, v2, 4, v14
    v_add_u32 v2, 4, v13
    v_xor_b32 v2, v2, v15
    v_lshl_add_u32 v113, v2, 4, v14
    v_bfe_u32 v2, v1, 2, 2
    v_lshlrev_b32 v2, 6, v2
    v_and_b32 v3, 3, v1
    v_lshl_add_u32 v2, v3, 3, v2
    v_and_b32 v3, 1, v13
    v_lshl_add_u32 v10, v3, 5, v2
    s_lshl_b32 s58, s37, 8
    v_add_u32 v4, s58, v10
    v_lshl_add_u32 v114, v13, 11, v4
    v_add_u32 v114, 65536, v114
    s_lshl_b32 s58, s36, 5
    v_xor_b32 v114, s58, v114
    v_xor_b32 v115, 32, v114
    s_mov_b32 s92, s56
    s_mov_b32 s93, s57
    s_mov_b32 s94, 0x200000
    s_mov_b32 s95, 0x20000
    s_mov_b32 s52, s62
    s_mov_b32 s53, s63
    s_mov_b32 s54, 0x700000
    s_mov_b32 s55, 0x20000
    s_mov_b32 s88, s64
    s_mov_b32 s89, s65
    s_mov_b32 s90, 0x700000
    s_mov_b32 s91, 0x20000
    s_lshl_b32 s80, s27, 10
    v_and_b32 v2, 3, v1
    v_bfe_u32 v3, v1, 4, 1
    v_lshlrev_b32 v3, 6, v3
    v_bfe_u32 v4, v1, 2, 2
    v_lshrrev_b32 v5, 5, v1
    v_lshl_add_u32 v4, v5, 2, v4
    v_lshlrev_b32 v6, 1, v5
    v_xor_b32 v2, v2, v6
    v_lshl_add_u32 v7, v2, 4, v3
    v_lshl_add_u32 v126, v4, 11, v7
    v_and_b32 v2, 31, v1
    v_lshlrev_b32 v2, 4, v2
    v_mul_u32_u24 v9, 7168, v5
    v_add_u32 v9, v9, v2
    s_lshl_b32 s81, s27, 14
    s_lshl_b32 s58, s29, 7
    s_add_u32 s81, s81, s58
    s_and_b32 s48, s29, 7
    s_lshl_b32 s58, s28, 1
    s_add_u32 s48, s48, s58
    s_lshl_b32 s48, s48, 2
    s_lshr_b32 s34, s3, 4
    s_and_b32 s87, s3, 15
    s_lshl_b32 s78, s87, 6
    s_lshl_b32 s59, s27, 4
    s_add_u32 s78, s78, s59
    s_mul_i32 s78, s78, 7168
    s_lshl_b32 s59, s34, 9
    s_add_u32 s78, s78, s59
    s_and_b32 s71, s21, 3
    s_cmp_lt_u32 s3, 224
    s_cselect_b32 s78, s78, 0
    s_cselect_b32 s71, s71, -1
    s_cselect_b64 vcc, -1, 0
    v_cndmask_b32 v9, 0, v9, vcc
    s_mov_b32 s32, s68
    s_mov_b32 s33, s69
    s_mov_b32 s34, 0x400000
    s_mov_b32 s35, 0x20000
    s_waitcnt vmcnt(0)
    v_mov_b32 v232, 0x3f803f80
    v_dot2_f32_bf16 v224, v192, v232, 0
    v_dot2_f32_bf16 v226, v192, v192, 0
    v_dot2_f32_bf16 v228, v192, v208, 0
    v_dot2_f32_bf16 v230, v208, v232, 0
    v_dot2_f32_bf16 v225, v193, v232, 0
    v_dot2_f32_bf16 v227, v193, v193, 0
    v_dot2_f32_bf16 v229, v193, v209, 0
    v_dot2_f32_bf16 v231, v209, v232, 0
    v_dot2_f32_bf16 v224, v194, v232, v224
    v_dot2_f32_bf16 v226, v194, v194, v226
    v_dot2_f32_bf16 v228, v194, v210, v228
    v_dot2_f32_bf16 v230, v210, v232, v230
    v_dot2_f32_bf16 v225, v195, v232, v225
    v_dot2_f32_bf16 v227, v195, v195, v227
    v_dot2_f32_bf16 v229, v195, v211, v229
    v_dot2_f32_bf16 v231, v211, v232, v231
    v_dot2_f32_bf16 v224, v196, v232, v224
    v_dot2_f32_bf16 v226, v196, v196, v226
    v_dot2_f32_bf16 v228, v196, v212, v228
    v_dot2_f32_bf16 v230, v212, v232, v230
    v_dot2_f32_bf16 v225, v197, v232, v225
    v_dot2_f32_bf16 v227, v197, v197, v227
    v_dot2_f32_bf16 v229, v197, v213, v229
    v_dot2_f32_bf16 v231, v213, v232, v231
    v_dot2_f32_bf16 v224, v198, v232, v224
    v_dot2_f32_bf16 v226, v198, v198, v226
    v_dot2_f32_bf16 v228, v198, v214, v228
    v_dot2_f32_bf16 v230, v214, v232, v230
    v_dot2_f32_bf16 v225, v199, v232, v225
    v_dot2_f32_bf16 v227, v199, v199, v227
    v_dot2_f32_bf16 v229, v199, v215, v229
    v_dot2_f32_bf16 v231, v215, v232, v231
    v_dot2_f32_bf16 v224, v200, v232, v224
    v_dot2_f32_bf16 v226, v200, v200, v226
    v_dot2_f32_bf16 v228, v200, v216, v228
    v_dot2_f32_bf16 v230, v216, v232, v230
    v_dot2_f32_bf16 v225, v201, v232, v225
    v_dot2_f32_bf16 v227, v201, v201, v227
    v_dot2_f32_bf16 v229, v201, v217, v229
    v_dot2_f32_bf16 v231, v217, v232, v231
    v_dot2_f32_bf16 v224, v202, v232, v224
    v_dot2_f32_bf16 v226, v202, v202, v226
    v_dot2_f32_bf16 v228, v202, v218, v228
    v_dot2_f32_bf16 v230, v218, v232, v230
    v_dot2_f32_bf16 v225, v203, v232, v225
    v_dot2_f32_bf16 v227, v203, v203, v227
    v_dot2_f32_bf16 v229, v203, v219, v229
    v_dot2_f32_bf16 v231, v219, v232, v231
    v_dot2_f32_bf16 v224, v204, v232, v224
    v_dot2_f32_bf16 v226, v204, v204, v226
    v_dot2_f32_bf16 v228, v204, v220, v228
    v_dot2_f32_bf16 v230, v220, v232, v230
    v_dot2_f32_bf16 v225, v205, v232, v225
    v_dot2_f32_bf16 v227, v205, v205, v227
    v_dot2_f32_bf16 v229, v205, v221, v229
    v_dot2_f32_bf16 v231, v221, v232, v231
    v_dot2_f32_bf16 v224, v206, v232, v224
    v_dot2_f32_bf16 v226, v206, v206, v226
    v_dot2_f32_bf16 v228, v206, v222, v228
    v_dot2_f32_bf16 v230, v222, v232, v230
    v_dot2_f32_bf16 v225, v207, v232, v225
    v_dot2_f32_bf16 v227, v207, v207, v227
    v_dot2_f32_bf16 v229, v207, v223, v229
    v_dot2_f32_bf16 v231, v223, v232, v231
    s_nop 2
    v_add_f32 v224, v224, v225
    v_add_f32 v226, v226, v227
    v_add_f32 v228, v228, v229
    v_add_f32 v230, v230, v231
    v_add_f32_dpp v224, v224, v224 row_ror:8 row_mask:0xf bank_mask:0xf
    v_add_f32_dpp v226, v226, v226 row_ror:8 row_mask:0xf bank_mask:0xf
    v_add_f32_dpp v228, v228, v228 row_ror:8 row_mask:0xf bank_mask:0xf
    v_add_f32_dpp v230, v230, v230 row_ror:8 row_mask:0xf bank_mask:0xf
    v_add_f32_dpp v224, v224, v224 row_ror:4 row_mask:0xf bank_mask:0xf
    v_add_f32_dpp v226, v226, v226 row_ror:4 row_mask:0xf bank_mask:0xf
    v_add_f32_dpp v228, v228, v228 row_ror:4 row_mask:0xf bank_mask:0xf
    v_add_f32_dpp v230, v230, v230 row_ror:4 row_mask:0xf bank_mask:0xf
    v_add_f32_dpp v224, v224, v224 row_ror:2 row_mask:0xf bank_mask:0xf
    v_add_f32_dpp v226, v226, v226 row_ror:2 row_mask:0xf bank_mask:0xf
    v_add_f32_dpp v228, v228, v228 row_ror:2 row_mask:0xf bank_mask:0xf
    v_add_f32_dpp v230, v230, v230 row_ror:2 row_mask:0xf bank_mask:0xf
    v_add_f32_dpp v224, v224, v224 row_ror:1 row_mask:0xf bank_mask:0xf
    v_add_f32_dpp v226, v226, v226 row_ror:1 row_mask:0xf bank_mask:0xf
    v_add_f32_dpp v228, v228, v228 row_ror:1 row_mask:0xf bank_mask:0xf
    v_add_f32_dpp v230, v230, v230 row_ror:1 row_mask:0xf bank_mask:0xf
    v_mov_b32 v225, v224
    v_mov_b32 v227, v226
    v_mov_b32 v229, v228
    v_mov_b32 v231, v230
    v_permlane16_swap_b32 v224, v225
    v_permlane16_swap_b32 v226, v227
    v_permlane16_swap_b32 v228, v229
    v_permlane16_swap_b32 v230, v231
    v_add_f32 v224, v224, v225
    v_add_f32 v226, v226, v227
    v_add_f32 v228, v228, v229
    v_add_f32 v230, v230, v231
    v_mul_f32 v224, 0x3a800000, v224
    v_mul_f32 v226, 0x3a800000, v226
    v_cvt_pk_bf16_f32 v236, v224, v224
    v_fma_f32 v226, -v224, v224, v226
    v_lshlrev_b32 v236, 16, v236
    v_max_f32 v226, 0, v226
    v_fma_f32 v228, -v236, v230, v228
    v_cvt_pk_bf16_f32 v226, v226, v226
    v_lshlrev_b32 v226, 16, v226
    v_add_f32 v226, 0x3727c5ac, v226
    v_cvt_pk_bf16_f32 v226, v226, v226
    v_lshlrev_b32 v226, 16, v226
    v_sqrt_f32 v226, v226
    v_lshrrev_b32 v233, 5, v1
    v_cvt_pk_bf16_f32 v226, v226, v226
    v_lshlrev_b32 v237, 16, v226
    v_rcp_f32 v226, v237
    v_add_u32 v234, s85, v233
    v_sub_u32 v234, 0x7ff, v234
    v_mul_f32 v228, v228, v226
    s_lshl_b32 s58, s27, 4
    s_add_u32 s58, s58, 133472
    v_lshl_add_u32 v233, v233, 3, s58
    v_cvt_pk_bf16_f32 v228, v228, v228
    v_lshlrev_b32 v228, 16, v228
    s_mov_b32 exec_lo, 1
    s_mov_b32 exec_hi, 1
    ds_write_b64 v233, v[236:237]
    s_mov_b64 exec, -1
    v_ashrrev_i32 v233, 31, v228
    v_or_b32 v233, 0x80000000, v233
    v_xor_b32 v233, v233, v228
    v_and_b32 v233, 0xffff0000, v233
    v_or_b32 v233, v233, v234
    v_mov_b32 v234, v233
    s_nop 1
    v_permlane32_swap_b32 v233, v234
    v_max_u32 v233, v233, v234
    s_lshl_b32 s58, s27, 2
    s_add_u32 s58, s58, 133456
    v_mov_b32 v234, s58
    s_mov_b64 exec, 1
    ds_write_b32 v234, v233
    s_mov_b64 exec, -1
    s_cmp_lg_u32 s27, 0
    s_cbranch_scc1 L_tagdone
    s_load_dword s60, s[74:75], 0
    s_mov_b32 s57, 0
L_tagspin:
    s_waitcnt lgkmcnt(0)
    s_cmp_lg_u32 s60, 0
    s_cbranch_scc1 L_tagok
    s_sleep 8
    s_load_dword s60, s[74:75], 0 glc
    s_add_u32 s57, s57, 1
    s_cmp_lt_u32 s57, 32768
    s_cbranch_scc1 L_tagspin
    s_waitcnt lgkmcnt(0)
L_tagok:
    v_mov_b32 v2, s60
    s_mov_b64 exec, 1
    ds_write_b32 v122, v2 offset:76
    s_mov_b64 exec, -1
L_tagdone:
    s_setprio 0
    s_waitcnt lgkmcnt(0)
    s_barrier
    ds_read_b128 v[16:19], v112 offset:0
    ds_read_b128 v[20:23], v113 offset:0
    ds_read_b128 v[24:27], v112 offset:2048
    ds_read_b128 v[28:31], v113 offset:2048
    ds_read_b128 v[32:35], v112 offset:4096
    ds_read_b128 v[36:39], v113 offset:4096
    ds_read_b128 v[40:43], v112 offset:6144
    ds_read_b128 v[44:47], v113 offset:6144
    ds_read_b64_tr_b16 v[80:81], v114 offset:0
    ds_read_b64_tr_b16 v[82:83], v114 offset:1024
    ds_read_b64_tr_b16 v[84:85], v114 offset:8192
    ds_read_b64_tr_b16 v[86:87], v114 offset:9216
    ds_read_b64_tr_b16 v[88:89], v115 offset:0
    ds_read_b64_tr_b16 v[90:91], v115 offset:1024
    ds_read_b64_tr_b16 v[92:93], v115 offset:8192
    ds_read_b64_tr_b16 v[94:95], v115 offset:9216
    s_waitcnt lgkmcnt(4)
    v_mfma_f32_16x16x32_bf16 v[128:131], v[16:19], v[80:83], 0
    ds_read_b64_tr_b16 v[96:97], v114 offset:512
    v_mfma_f32_16x16x32_bf16 v[128:131], v[20:23], v[84:87], v[128:131]
    ds_read_b64_tr_b16 v[98:99], v114 offset:1536
    v_mfma_f32_16x16x32_bf16 v[144:147], v[28:31], v[84:87], 0
    ds_read_b64_tr_b16 v[100:101], v114 offset:8704
    v_mfma_f32_16x16x32_bf16 v[144:147], v[24:27], v[80:83], v[144:147]
    v_mfma_f32_16x16x32_bf16 v[160:163], v[32:35], v[80:83], 0
    ds_read_b64_tr_b16 v[102:103], v114 offset:9728
    v_mfma_f32_16x16x32_bf16 v[160:163], v[36:39], v[84:87], v[160:163]
    ds_read_b64_tr_b16 v[104:105], v115 offset:512
    v_mfma_f32_16x16x32_bf16 v[176:179], v[44:47], v[84:87], 0
    ds_read_b64_tr_b16 v[106:107], v115 offset:1536
    v_mfma_f32_16x16x32_bf16 v[176:179], v[40:43], v[80:83], v[176:179]
    s_waitcnt lgkmcnt(6)
    v_mfma_f32_16x16x32_bf16 v[132:135], v[16:19], v[88:91], 0
    ds_read_b64_tr_b16 v[108:109], v115 offset:8704
    v_mfma_f32_16x16x32_bf16 v[132:135], v[20:23], v[92:95], v[132:135]
    ds_read_b64_tr_b16 v[110:111], v115 offset:9728
    v_mfma_f32_16x16x32_bf16 v[148:151], v[28:31], v[92:95], 0
    v_mfma_f32_16x16x32_bf16 v[148:151], v[24:27], v[88:91], v[148:151]
    s_waitcnt lgkmcnt(0)
    s_barrier
    v_mfma_f32_16x16x32_bf16 v[164:167], v[32:35], v[88:91], 0
    ds_read_b128 v[48:51], v112 offset:16384
    v_mfma_f32_16x16x32_bf16 v[164:167], v[36:39], v[92:95], v[164:167]
    ds_read_b128 v[52:55], v113 offset:16384
    v_mfma_f32_16x16x32_bf16 v[180:183], v[44:47], v[92:95], 0
    ds_read_b128 v[56:59], v112 offset:18432
    v_mfma_f32_16x16x32_bf16 v[180:183], v[40:43], v[88:91], v[180:183]
    ds_read_b128 v[60:63], v113 offset:18432
    v_mfma_f32_16x16x32_bf16 v[136:139], v[16:19], v[96:99], 0
    v_mfma_f32_16x16x32_bf16 v[136:139], v[20:23], v[100:103], v[136:139]
    ds_read_b128 v[64:67], v112 offset:20480
    v_mfma_f32_16x16x32_bf16 v[152:155], v[28:31], v[100:103], 0
    ds_read_b128 v[68:71], v113 offset:20480
    v_mfma_f32_16x16x32_bf16 v[152:155], v[24:27], v[96:99], v[152:155]
    ds_read_b128 v[72:75], v112 offset:22528
    v_mfma_f32_16x16x32_bf16 v[168:171], v[32:35], v[96:99], 0
    ds_read_b128 v[76:79], v113 offset:22528
    v_mfma_f32_16x16x32_bf16 v[168:171], v[36:39], v[100:103], v[168:171]
    v_mfma_f32_16x16x32_bf16 v[184:187], v[44:47], v[100:103], 0
    ds_read_b64_tr_b16 v[80:81], v114 offset:16384
    v_mfma_f32_16x16x32_bf16 v[184:187], v[40:43], v[96:99], v[184:187]
    ds_read_b64_tr_b16 v[82:83], v114 offset:17408
    v_mfma_f32_16x16x32_bf16 v[140:143], v[16:19], v[104:107], 0
    ds_read_b64_tr_b16 v[84:85], v114 offset:24576
    v_mfma_f32_16x16x32_bf16 v[140:143], v[20:23], v[108:111], v[140:143]
    ds_read_b64_tr_b16 v[86:87], v114 offset:25600
    v_mfma_f32_16x16x32_bf16 v[156:159], v[28:31], v[108:111], 0
    v_mfma_f32_16x16x32_bf16 v[156:159], v[24:27], v[104:107], v[156:159]
    ds_read_b64_tr_b16 v[88:89], v115 offset:16384
    v_mfma_f32_16x16x32_bf16 v[172:175], v[32:35], v[104:107], 0
    ds_read_b64_tr_b16 v[90:91], v115 offset:17408
    v_mfma_f32_16x16x32_bf16 v[172:175], v[36:39], v[108:111], v[172:175]
    ds_read_b64_tr_b16 v[92:93], v115 offset:24576
    v_mfma_f32_16x16x32_bf16 v[188:191], v[44:47], v[108:111], 0
    ds_read_b64_tr_b16 v[94:95], v115 offset:25600
    v_mfma_f32_16x16x32_bf16 v[188:191], v[40:43], v[104:107], v[188:191]
    s_waitcnt lgkmcnt(4)
    v_mfma_f32_16x16x32_bf16 v[128:131], v[48:51], v[80:83], v[128:131]
    ds_read_b64_tr_b16 v[96:97], v114 offset:16896
    v_mfma_f32_16x16x32_bf16 v[128:131], v[52:55], v[84:87], v[128:131]
    ds_read_b64_tr_b16 v[98:99], v114 offset:17920
    v_mfma_f32_16x16x32_bf16 v[144:147], v[60:63], v[84:87], v[144:147]
    ds_read_b64_tr_b16 v[100:101], v114 offset:25088
    v_mfma_f32_16x16x32_bf16 v[144:147], v[56:59], v[80:83], v[144:147]
    v_mfma_f32_16x16x32_bf16 v[160:163], v[64:67], v[80:83], v[160:163]
    ds_read_b64_tr_b16 v[102:103], v114 offset:26112
    v_mfma_f32_16x16x32_bf16 v[160:163], v[68:71], v[84:87], v[160:163]
    ds_read_b64_tr_b16 v[104:105], v115 offset:16896
    v_mfma_f32_16x16x32_bf16 v[176:179], v[76:79], v[84:87], v[176:179]
    ds_read_b64_tr_b16 v[106:107], v115 offset:17920
    v_mfma_f32_16x16x32_bf16 v[176:179], v[72:75], v[80:83], v[176:179]
    s_waitcnt lgkmcnt(6)
    v_mfma_f32_16x16x32_bf16 v[132:135], v[48:51], v[88:91], v[132:135]
    ds_read_b64_tr_b16 v[108:109], v115 offset:25088
    v_mfma_f32_16x16x32_bf16 v[132:135], v[52:55], v[92:95], v[132:135]
    ds_read_b64_tr_b16 v[110:111], v115 offset:26112
    v_mfma_f32_16x16x32_bf16 v[148:151], v[60:63], v[92:95], v[148:151]
    v_mfma_f32_16x16x32_bf16 v[148:151], v[56:59], v[88:91], v[148:151]
    s_waitcnt lgkmcnt(0)
    s_barrier
    v_mfma_f32_16x16x32_bf16 v[164:167], v[64:67], v[88:91], v[164:167]
    ds_read_b128 v[16:19], v112 offset:32768
    v_mfma_f32_16x16x32_bf16 v[164:167], v[68:71], v[92:95], v[164:167]
    ds_read_b128 v[20:23], v113 offset:32768
    v_mfma_f32_16x16x32_bf16 v[180:183], v[76:79], v[92:95], v[180:183]
    ds_read_b128 v[24:27], v112 offset:34816
    v_mfma_f32_16x16x32_bf16 v[180:183], v[72:75], v[88:91], v[180:183]
    ds_read_b128 v[28:31], v113 offset:34816
    v_mfma_f32_16x16x32_bf16 v[136:139], v[48:51], v[96:99], v[136:139]
    v_mfma_f32_16x16x32_bf16 v[136:139], v[52:55], v[100:103], v[136:139]
    ds_read_b128 v[32:35], v112 offset:36864
    v_mfma_f32_16x16x32_bf16 v[152:155], v[60:63], v[100:103], v[152:155]
    ds_read_b128 v[36:39], v113 offset:36864
    v_mfma_f32_16x16x32_bf16 v[152:155], v[56:59], v[96:99], v[152:155]
    ds_read_b128 v[40:43], v112 offset:38912
    v_mfma_f32_16x16x32_bf16 v[168:171], v[64:67], v[96:99], v[168:171]
    ds_read_b128 v[44:47], v113 offset:38912
    v_mfma_f32_16x16x32_bf16 v[168:171], v[68:71], v[100:103], v[168:171]
    v_mfma_f32_16x16x32_bf16 v[184:187], v[76:79], v[100:103], v[184:187]
    ds_read_b64_tr_b16 v[80:81], v114 offset:32768
    v_mfma_f32_16x16x32_bf16 v[184:187], v[72:75], v[96:99], v[184:187]
    ds_read_b64_tr_b16 v[82:83], v114 offset:33792
    v_mfma_f32_16x16x32_bf16 v[140:143], v[48:51], v[104:107], v[140:143]
    ds_read_b64_tr_b16 v[84:85], v114 offset:40960
    v_mfma_f32_16x16x32_bf16 v[140:143], v[52:55], v[108:111], v[140:143]
    ds_read_b64_tr_b16 v[86:87], v114 offset:41984
    v_mfma_f32_16x16x32_bf16 v[156:159], v[60:63], v[108:111], v[156:159]
    v_mfma_f32_16x16x32_bf16 v[156:159], v[56:59], v[104:107], v[156:159]
    ds_read_b64_tr_b16 v[88:89], v115 offset:32768
    v_mfma_f32_16x16x32_bf16 v[172:175], v[64:67], v[104:107], v[172:175]
    ds_read_b64_tr_b16 v[90:91], v115 offset:33792
    v_mfma_f32_16x16x32_bf16 v[172:175], v[68:71], v[108:111], v[172:175]
    ds_read_b64_tr_b16 v[92:93], v115 offset:40960
    v_mfma_f32_16x16x32_bf16 v[188:191], v[76:79], v[108:111], v[188:191]
    ds_read_b64_tr_b16 v[94:95], v115 offset:41984
    v_mfma_f32_16x16x32_bf16 v[188:191], v[72:75], v[104:107], v[188:191]
    s_waitcnt lgkmcnt(4)
    v_mfma_f32_16x16x32_bf16 v[128:131], v[16:19], v[80:83], v[128:131]
    ds_read_b64_tr_b16 v[96:97], v114 offset:33280
    v_mfma_f32_16x16x32_bf16 v[128:131], v[20:23], v[84:87], v[128:131]
    ds_read_b64_tr_b16 v[98:99], v114 offset:34304
    v_mfma_f32_16x16x32_bf16 v[144:147], v[28:31], v[84:87], v[144:147]
    ds_read_b64_tr_b16 v[100:101], v114 offset:41472
    v_mfma_f32_16x16x32_bf16 v[144:147], v[24:27], v[80:83], v[144:147]
    v_mfma_f32_16x16x32_bf16 v[160:163], v[32:35], v[80:83], v[160:163]
    ds_read_b64_tr_b16 v[102:103], v114 offset:42496
    v_mfma_f32_16x16x32_bf16 v[160:163], v[36:39], v[84:87], v[160:163]
    ds_read_b64_tr_b16 v[104:105], v115 offset:33280
    v_mfma_f32_16x16x32_bf16 v[176:179], v[44:47], v[84:87], v[176:179]
    ds_read_b64_tr_b16 v[106:107], v115 offset:34304
    v_mfma_f32_16x16x32_bf16 v[176:179], v[40:43], v[80:83], v[176:179]
    s_waitcnt lgkmcnt(6)
    v_mfma_f32_16x16x32_bf16 v[132:135], v[16:19], v[88:91], v[132:135]
    ds_read_b64_tr_b16 v[108:109], v115 offset:41472
    v_mfma_f32_16x16x32_bf16 v[132:135], v[20:23], v[92:95], v[132:135]
    ds_read_b64_tr_b16 v[110:111], v115 offset:42496
    v_mfma_f32_16x16x32_bf16 v[148:151], v[28:31], v[92:95], v[148:151]
    v_mfma_f32_16x16x32_bf16 v[148:151], v[24:27], v[88:91], v[148:151]
    s_waitcnt lgkmcnt(0)
    s_barrier
    v_mfma_f32_16x16x32_bf16 v[164:167], v[32:35], v[88:91], v[164:167]
    ds_read_b128 v[48:51], v112 offset:49152
    v_mfma_f32_16x16x32_bf16 v[164:167], v[36:39], v[92:95], v[164:167]
    ds_read_b128 v[52:55], v113 offset:49152
    v_mfma_f32_16x16x32_bf16 v[180:183], v[44:47], v[92:95], v[180:183]
    ds_read_b128 v[56:59], v112 offset:51200
    v_mfma_f32_16x16x32_bf16 v[180:183], v[40:43], v[88:91], v[180:183]
    ds_read_b128 v[60:63], v113 offset:51200
    v_mfma_f32_16x16x32_bf16 v[136:139], v[16:19], v[96:99], v[136:139]
    v_mfma_f32_16x16x32_bf16 v[136:139], v[20:23], v[100:103], v[136:139]
    ds_read_b128 v[64:67], v112 offset:53248
    v_mfma_f32_16x16x32_bf16 v[152:155], v[28:31], v[100:103], v[152:155]
    ds_read_b128 v[68:71], v113 offset:53248
    v_mfma_f32_16x16x32_bf16 v[152:155], v[24:27], v[96:99], v[152:155]
    ds_read_b128 v[72:75], v112 offset:55296
    v_mfma_f32_16x16x32_bf16 v[168:171], v[32:35], v[96:99], v[168:171]
    ds_read_b128 v[76:79], v113 offset:55296
    v_mfma_f32_16x16x32_bf16 v[168:171], v[36:39], v[100:103], v[168:171]
    v_mfma_f32_16x16x32_bf16 v[184:187], v[44:47], v[100:103], v[184:187]
    ds_read_b64_tr_b16 v[80:81], v114 offset:49152
    v_mfma_f32_16x16x32_bf16 v[184:187], v[40:43], v[96:99], v[184:187]
    ds_read_b64_tr_b16 v[82:83], v114 offset:50176
    v_mfma_f32_16x16x32_bf16 v[140:143], v[16:19], v[104:107], v[140:143]
    ds_read_b64_tr_b16 v[84:85], v114 offset:57344
    v_mfma_f32_16x16x32_bf16 v[140:143], v[20:23], v[108:111], v[140:143]
    ds_read_b64_tr_b16 v[86:87], v114 offset:58368
    v_mfma_f32_16x16x32_bf16 v[156:159], v[28:31], v[108:111], v[156:159]
    v_mfma_f32_16x16x32_bf16 v[156:159], v[24:27], v[104:107], v[156:159]
    ds_read_b64_tr_b16 v[88:89], v115 offset:49152
    v_mfma_f32_16x16x32_bf16 v[172:175], v[32:35], v[104:107], v[172:175]
    ds_read_b64_tr_b16 v[90:91], v115 offset:50176
    v_mfma_f32_16x16x32_bf16 v[172:175], v[36:39], v[108:111], v[172:175]
    ds_read_b64_tr_b16 v[92:93], v115 offset:57344
    v_mfma_f32_16x16x32_bf16 v[188:191], v[44:47], v[108:111], v[188:191]
    ds_read_b64_tr_b16 v[94:95], v115 offset:58368
    v_mfma_f32_16x16x32_bf16 v[188:191], v[40:43], v[104:107], v[188:191]
    s_waitcnt lgkmcnt(4)
    v_mfma_f32_16x16x32_bf16 v[128:131], v[48:51], v[80:83], v[128:131]
    ds_read_b64_tr_b16 v[96:97], v114 offset:49664
    v_mfma_f32_16x16x32_bf16 v[128:131], v[52:55], v[84:87], v[128:131]
    ds_read_b64_tr_b16 v[98:99], v114 offset:50688
    v_mfma_f32_16x16x32_bf16 v[144:147], v[60:63], v[84:87], v[144:147]
    ds_read_b64_tr_b16 v[100:101], v114 offset:57856
    v_mfma_f32_16x16x32_bf16 v[144:147], v[56:59], v[80:83], v[144:147]
    v_mfma_f32_16x16x32_bf16 v[160:163], v[64:67], v[80:83], v[160:163]
    ds_read_b64_tr_b16 v[102:103], v114 offset:58880
    v_mfma_f32_16x16x32_bf16 v[160:163], v[68:71], v[84:87], v[160:163]
    ds_read_b64_tr_b16 v[104:105], v115 offset:49664
    v_mfma_f32_16x16x32_bf16 v[176:179], v[76:79], v[84:87], v[176:179]
    ds_read_b64_tr_b16 v[106:107], v115 offset:50688
    v_mfma_f32_16x16x32_bf16 v[176:179], v[72:75], v[80:83], v[176:179]
    s_waitcnt lgkmcnt(6)
    v_mfma_f32_16x16x32_bf16 v[132:135], v[48:51], v[88:91], v[132:135]
    ds_read_b64_tr_b16 v[108:109], v115 offset:57856
    v_mfma_f32_16x16x32_bf16 v[132:135], v[52:55], v[92:95], v[132:135]
    ds_read_b64_tr_b16 v[110:111], v115 offset:58880
    v_mfma_f32_16x16x32_bf16 v[148:151], v[60:63], v[92:95], v[148:151]
    v_mfma_f32_16x16x32_bf16 v[148:151], v[56:59], v[88:91], v[148:151]
    s_waitcnt lgkmcnt(0)
    s_barrier
    v_mfma_f32_16x16x32_bf16 v[164:167], v[64:67], v[88:91], v[164:167]
    ds_read_b128 v[16:19], v112 offset:0
    s_cmp_eq_u32 s71, 0
    s_cbranch_scc0 L_run57
    buffer_load_dwordx4 v[192:195], v9, s[52:55], s78 offen nt
    buffer_load_dwordx4 v[196:199], v9, s[88:91], s78 offen nt
    s_add_u32 s78, s78, 14336
    buffer_load_dwordx4 v[200:203], v9, s[52:55], s78 offen nt
    buffer_load_dwordx4 v[204:207], v9, s[88:91], s78 offen nt
    s_add_u32 s78, s78, 14336
    buffer_load_dwordx4 v[208:211], v9, s[52:55], s78 offen nt
    buffer_load_dwordx4 v[212:215], v9, s[88:91], s78 offen nt
    s_add_u32 s78, s78, 14336
    buffer_load_dwordx4 v[216:219], v9, s[52:55], s78 offen nt
    buffer_load_dwordx4 v[220:223], v9, s[88:91], s78 offen nt
L_run57:
    v_mfma_f32_16x16x32_bf16 v[164:167], v[68:71], v[92:95], v[164:167]
    ds_read_b128 v[20:23], v113 offset:0
    v_mfma_f32_16x16x32_bf16 v[180:183], v[76:79], v[92:95], v[180:183]
    ds_read_b128 v[24:27], v112 offset:2048
    v_mfma_f32_16x16x32_bf16 v[180:183], v[72:75], v[88:91], v[180:183]
    ds_read_b128 v[28:31], v113 offset:2048
    v_mfma_f32_16x16x32_bf16 v[136:139], v[48:51], v[96:99], v[136:139]
    v_mfma_f32_16x16x32_bf16 v[136:139], v[52:55], v[100:103], v[136:139]
    ds_read_b128 v[32:35], v112 offset:4096
    v_mfma_f32_16x16x32_bf16 v[152:155], v[60:63], v[100:103], v[152:155]
    ds_read_b128 v[36:39], v113 offset:4096
    v_mfma_f32_16x16x32_bf16 v[152:155], v[56:59], v[96:99], v[152:155]
    ds_read_b128 v[40:43], v112 offset:6144
    v_mfma_f32_16x16x32_bf16 v[168:171], v[64:67], v[96:99], v[168:171]
    ds_read_b128 v[44:47], v113 offset:6144
    v_mfma_f32_16x16x32_bf16 v[168:171], v[68:71], v[100:103], v[168:171]
    v_mfma_f32_16x16x32_bf16 v[184:187], v[76:79], v[100:103], v[184:187]
    ds_read_b64_tr_b16 v[80:81], v114 offset:0
    v_mfma_f32_16x16x32_bf16 v[184:187], v[72:75], v[96:99], v[184:187]
    ds_read_b64_tr_b16 v[82:83], v114 offset:1024
    v_mfma_f32_16x16x32_bf16 v[140:143], v[48:51], v[104:107], v[140:143]
    ds_read_b64_tr_b16 v[84:85], v114 offset:8192
    v_mfma_f32_16x16x32_bf16 v[140:143], v[52:55], v[108:111], v[140:143]
    ds_read_b64_tr_b16 v[86:87], v114 offset:9216
    v_mfma_f32_16x16x32_bf16 v[156:159], v[60:63], v[108:111], v[156:159]
    v_mfma_f32_16x16x32_bf16 v[156:159], v[56:59], v[104:107], v[156:159]
    ds_read_b64_tr_b16 v[88:89], v115 offset:0
    v_mfma_f32_16x16x32_bf16 v[172:175], v[64:67], v[104:107], v[172:175]
    ds_read_b64_tr_b16 v[90:91], v115 offset:1024
    v_mfma_f32_16x16x32_bf16 v[172:175], v[68:71], v[108:111], v[172:175]
    ds_read_b64_tr_b16 v[92:93], v115 offset:8192
    v_mfma_f32_16x16x32_bf16 v[188:191], v[76:79], v[108:111], v[188:191]
    ds_read_b64_tr_b16 v[94:95], v115 offset:9216
    v_mfma_f32_16x16x32_bf16 v[188:191], v[72:75], v[104:107], v[188:191]
    s_waitcnt lgkmcnt(4)
    v_mfma_f32_16x16x32_bf16 v[128:131], v[16:19], v[80:83], v[128:131]
    ds_read_b64_tr_b16 v[96:97], v114 offset:512
    v_mfma_f32_16x16x32_bf16 v[128:131], v[20:23], v[84:87], v[128:131]
    ds_read_b64_tr_b16 v[98:99], v114 offset:1536
    v_mfma_f32_16x16x32_bf16 v[144:147], v[28:31], v[84:87], v[144:147]
    ds_read_b64_tr_b16 v[100:101], v114 offset:8704
    v_mfma_f32_16x16x32_bf16 v[144:147], v[24:27], v[80:83], v[144:147]
    v_mfma_f32_16x16x32_bf16 v[160:163], v[32:35], v[80:83], v[160:163]
    ds_read_b64_tr_b16 v[102:103], v114 offset:9728
    v_mfma_f32_16x16x32_bf16 v[160:163], v[36:39], v[84:87], v[160:163]
    ds_read_b64_tr_b16 v[104:105], v115 offset:512
    v_mfma_f32_16x16x32_bf16 v[176:179], v[44:47], v[84:87], v[176:179]
    ds_read_b64_tr_b16 v[106:107], v115 offset:1536
    v_mfma_f32_16x16x32_bf16 v[176:179], v[40:43], v[80:83], v[176:179]
    s_waitcnt lgkmcnt(6)
    v_mfma_f32_16x16x32_bf16 v[132:135], v[16:19], v[88:91], v[132:135]
    ds_read_b64_tr_b16 v[108:109], v115 offset:8704
    v_mfma_f32_16x16x32_bf16 v[132:135], v[20:23], v[92:95], v[132:135]
    ds_read_b64_tr_b16 v[110:111], v115 offset:9728
    v_mfma_f32_16x16x32_bf16 v[148:151], v[28:31], v[92:95], v[148:151]
    v_mfma_f32_16x16x32_bf16 v[148:151], v[24:27], v[88:91], v[148:151]
    s_waitcnt lgkmcnt(0)
    s_barrier
    v_mfma_f32_16x16x32_bf16 v[164:167], v[32:35], v[88:91], v[164:167]
    ds_read_b128 v[48:51], v112 offset:16384
    v_mfma_f32_16x16x32_bf16 v[164:167], v[36:39], v[92:95], v[164:167]
    ds_read_b128 v[52:55], v113 offset:16384
    v_mfma_f32_16x16x32_bf16 v[180:183], v[44:47], v[92:95], v[180:183]
    ds_read_b128 v[56:59], v112 offset:18432
    v_mfma_f32_16x16x32_bf16 v[180:183], v[40:43], v[88:91], v[180:183]
    ds_read_b128 v[60:63], v113 offset:18432
    v_mfma_f32_16x16x32_bf16 v[136:139], v[16:19], v[96:99], v[136:139]
    v_mfma_f32_16x16x32_bf16 v[136:139], v[20:23], v[100:103], v[136:139]
    ds_read_b128 v[64:67], v112 offset:20480
    v_mfma_f32_16x16x32_bf16 v[152:155], v[28:31], v[100:103], v[152:155]
    ds_read_b128 v[68:71], v113 offset:20480
    v_mfma_f32_16x16x32_bf16 v[152:155], v[24:27], v[96:99], v[152:155]
    ds_read_b128 v[72:75], v112 offset:22528
    v_mfma_f32_16x16x32_bf16 v[168:171], v[32:35], v[96:99], v[168:171]
    ds_read_b128 v[76:79], v113 offset:22528
    v_mfma_f32_16x16x32_bf16 v[168:171], v[36:39], v[100:103], v[168:171]
    v_mfma_f32_16x16x32_bf16 v[184:187], v[44:47], v[100:103], v[184:187]
    ds_read_b64_tr_b16 v[80:81], v114 offset:16384
    v_mfma_f32_16x16x32_bf16 v[184:187], v[40:43], v[96:99], v[184:187]
    ds_read_b64_tr_b16 v[82:83], v114 offset:17408
    v_mfma_f32_16x16x32_bf16 v[140:143], v[16:19], v[104:107], v[140:143]
    ds_read_b64_tr_b16 v[84:85], v114 offset:24576
    v_mfma_f32_16x16x32_bf16 v[140:143], v[20:23], v[108:111], v[140:143]
    ds_read_b64_tr_b16 v[86:87], v114 offset:25600
    v_mfma_f32_16x16x32_bf16 v[156:159], v[28:31], v[108:111], v[156:159]
    v_mfma_f32_16x16x32_bf16 v[156:159], v[24:27], v[104:107], v[156:159]
    ds_read_b64_tr_b16 v[88:89], v115 offset:16384
    v_mfma_f32_16x16x32_bf16 v[172:175], v[32:35], v[104:107], v[172:175]
    ds_read_b64_tr_b16 v[90:91], v115 offset:17408
    v_mfma_f32_16x16x32_bf16 v[172:175], v[36:39], v[108:111], v[172:175]
    ds_read_b64_tr_b16 v[92:93], v115 offset:24576
    v_mfma_f32_16x16x32_bf16 v[188:191], v[44:47], v[108:111], v[188:191]
    ds_read_b64_tr_b16 v[94:95], v115 offset:25600
    v_mfma_f32_16x16x32_bf16 v[188:191], v[40:43], v[104:107], v[188:191]
    s_waitcnt lgkmcnt(4)
    v_mfma_f32_16x16x32_bf16 v[128:131], v[48:51], v[80:83], v[128:131]
    ds_read_b64_tr_b16 v[96:97], v114 offset:16896
    v_mfma_f32_16x16x32_bf16 v[128:131], v[52:55], v[84:87], v[128:131]
    ds_read_b64_tr_b16 v[98:99], v114 offset:17920
    v_mfma_f32_16x16x32_bf16 v[144:147], v[60:63], v[84:87], v[144:147]
    ds_read_b64_tr_b16 v[100:101], v114 offset:25088
    v_mfma_f32_16x16x32_bf16 v[144:147], v[56:59], v[80:83], v[144:147]
    v_mfma_f32_16x16x32_bf16 v[160:163], v[64:67], v[80:83], v[160:163]
    ds_read_b64_tr_b16 v[102:103], v114 offset:26112
    v_mfma_f32_16x16x32_bf16 v[160:163], v[68:71], v[84:87], v[160:163]
    ds_read_b64_tr_b16 v[104:105], v115 offset:16896
    v_mfma_f32_16x16x32_bf16 v[176:179], v[76:79], v[84:87], v[176:179]
    ds_read_b64_tr_b16 v[106:107], v115 offset:17920
    v_mfma_f32_16x16x32_bf16 v[176:179], v[72:75], v[80:83], v[176:179]
    s_waitcnt lgkmcnt(6)
    v_mfma_f32_16x16x32_bf16 v[132:135], v[48:51], v[88:91], v[132:135]
    ds_read_b64_tr_b16 v[108:109], v115 offset:25088
    v_mfma_f32_16x16x32_bf16 v[132:135], v[52:55], v[92:95], v[132:135]
    ds_read_b64_tr_b16 v[110:111], v115 offset:26112
    v_mfma_f32_16x16x32_bf16 v[148:151], v[60:63], v[92:95], v[148:151]
    v_mfma_f32_16x16x32_bf16 v[148:151], v[56:59], v[88:91], v[148:151]
    s_waitcnt lgkmcnt(0)
    s_barrier
    v_mfma_f32_16x16x32_bf16 v[164:167], v[64:67], v[88:91], v[164:167]
    ds_read_b128 v[16:19], v112 offset:32768
    s_cmp_eq_u32 s71, 1
    s_cbranch_scc0 L_run58
    buffer_load_dwordx4 v[192:195], v9, s[52:55], s78 offen nt
    buffer_load_dwordx4 v[196:199], v9, s[88:91], s78 offen nt
    s_add_u32 s78, s78, 14336
    buffer_load_dwordx4 v[200:203], v9, s[52:55], s78 offen nt
    buffer_load_dwordx4 v[204:207], v9, s[88:91], s78 offen nt
    s_add_u32 s78, s78, 14336
    buffer_load_dwordx4 v[208:211], v9, s[52:55], s78 offen nt
    buffer_load_dwordx4 v[212:215], v9, s[88:91], s78 offen nt
    s_add_u32 s78, s78, 14336
    buffer_load_dwordx4 v[216:219], v9, s[52:55], s78 offen nt
    buffer_load_dwordx4 v[220:223], v9, s[88:91], s78 offen nt
L_run58:
    v_mfma_f32_16x16x32_bf16 v[164:167], v[68:71], v[92:95], v[164:167]
    ds_read_b128 v[20:23], v113 offset:32768
    v_mfma_f32_16x16x32_bf16 v[180:183], v[76:79], v[92:95], v[180:183]
    ds_read_b128 v[24:27], v112 offset:34816
    v_mfma_f32_16x16x32_bf16 v[180:183], v[72:75], v[88:91], v[180:183]
    ds_read_b128 v[28:31], v113 offset:34816
    v_mfma_f32_16x16x32_bf16 v[136:139], v[48:51], v[96:99], v[136:139]
    v_mfma_f32_16x16x32_bf16 v[136:139], v[52:55], v[100:103], v[136:139]
    ds_read_b128 v[32:35], v112 offset:36864
    v_mfma_f32_16x16x32_bf16 v[152:155], v[60:63], v[100:103], v[152:155]
    ds_read_b128 v[36:39], v113 offset:36864
    v_mfma_f32_16x16x32_bf16 v[152:155], v[56:59], v[96:99], v[152:155]
    ds_read_b128 v[40:43], v112 offset:38912
    v_mfma_f32_16x16x32_bf16 v[168:171], v[64:67], v[96:99], v[168:171]
    ds_read_b128 v[44:47], v113 offset:38912
    v_mfma_f32_16x16x32_bf16 v[168:171], v[68:71], v[100:103], v[168:171]
    v_mfma_f32_16x16x32_bf16 v[184:187], v[76:79], v[100:103], v[184:187]
    ds_read_b64_tr_b16 v[80:81], v114 offset:32768
    v_mfma_f32_16x16x32_bf16 v[184:187], v[72:75], v[96:99], v[184:187]
    ds_read_b64_tr_b16 v[82:83], v114 offset:33792
    v_mfma_f32_16x16x32_bf16 v[140:143], v[48:51], v[104:107], v[140:143]
    ds_read_b64_tr_b16 v[84:85], v114 offset:40960
    v_mfma_f32_16x16x32_bf16 v[140:143], v[52:55], v[108:111], v[140:143]
    ds_read_b64_tr_b16 v[86:87], v114 offset:41984
    v_mfma_f32_16x16x32_bf16 v[156:159], v[60:63], v[108:111], v[156:159]
    v_mfma_f32_16x16x32_bf16 v[156:159], v[56:59], v[104:107], v[156:159]
    ds_read_b64_tr_b16 v[88:89], v115 offset:32768
    v_mfma_f32_16x16x32_bf16 v[172:175], v[64:67], v[104:107], v[172:175]
    ds_read_b64_tr_b16 v[90:91], v115 offset:33792
    v_mfma_f32_16x16x32_bf16 v[172:175], v[68:71], v[108:111], v[172:175]
    ds_read_b64_tr_b16 v[92:93], v115 offset:40960
    v_mfma_f32_16x16x32_bf16 v[188:191], v[76:79], v[108:111], v[188:191]
    ds_read_b64_tr_b16 v[94:95], v115 offset:41984
    v_mfma_f32_16x16x32_bf16 v[188:191], v[72:75], v[104:107], v[188:191]
    s_waitcnt lgkmcnt(4)
    v_mfma_f32_16x16x32_bf16 v[128:131], v[16:19], v[80:83], v[128:131]
    ds_read_b64_tr_b16 v[96:97], v114 offset:33280
    v_mfma_f32_16x16x32_bf16 v[128:131], v[20:23], v[84:87], v[128:131]
    ds_read_b64_tr_b16 v[98:99], v114 offset:34304
    v_mfma_f32_16x16x32_bf16 v[144:147], v[28:31], v[84:87], v[144:147]
    ds_read_b64_tr_b16 v[100:101], v114 offset:41472
    v_mfma_f32_16x16x32_bf16 v[144:147], v[24:27], v[80:83], v[144:147]
    v_mfma_f32_16x16x32_bf16 v[160:163], v[32:35], v[80:83], v[160:163]
    ds_read_b64_tr_b16 v[102:103], v114 offset:42496
    v_mfma_f32_16x16x32_bf16 v[160:163], v[36:39], v[84:87], v[160:163]
    ds_read_b64_tr_b16 v[104:105], v115 offset:33280
    v_mfma_f32_16x16x32_bf16 v[176:179], v[44:47], v[84:87], v[176:179]
    ds_read_b64_tr_b16 v[106:107], v115 offset:34304
    v_mfma_f32_16x16x32_bf16 v[176:179], v[40:43], v[80:83], v[176:179]
    s_waitcnt lgkmcnt(6)
    v_mfma_f32_16x16x32_bf16 v[132:135], v[16:19], v[88:91], v[132:135]
    ds_read_b64_tr_b16 v[108:109], v115 offset:41472
    v_mfma_f32_16x16x32_bf16 v[132:135], v[20:23], v[92:95], v[132:135]
    ds_read_b64_tr_b16 v[110:111], v115 offset:42496
    v_mfma_f32_16x16x32_bf16 v[148:151], v[28:31], v[92:95], v[148:151]
    v_mfma_f32_16x16x32_bf16 v[148:151], v[24:27], v[88:91], v[148:151]
    s_waitcnt lgkmcnt(0)
    s_barrier
    v_mfma_f32_16x16x32_bf16 v[164:167], v[32:35], v[88:91], v[164:167]
    ds_read_b128 v[48:51], v112 offset:49152
    v_mfma_f32_16x16x32_bf16 v[164:167], v[36:39], v[92:95], v[164:167]
    ds_read_b128 v[52:55], v113 offset:49152
    v_mfma_f32_16x16x32_bf16 v[180:183], v[44:47], v[92:95], v[180:183]
    ds_read_b128 v[56:59], v112 offset:51200
    v_mfma_f32_16x16x32_bf16 v[180:183], v[40:43], v[88:91], v[180:183]
    ds_read_b128 v[60:63], v113 offset:51200
    v_mfma_f32_16x16x32_bf16 v[136:139], v[16:19], v[96:99], v[136:139]
    v_mfma_f32_16x16x32_bf16 v[136:139], v[20:23], v[100:103], v[136:139]
    ds_read_b128 v[64:67], v112 offset:53248
    v_mfma_f32_16x16x32_bf16 v[152:155], v[28:31], v[100:103], v[152:155]
    ds_read_b128 v[68:71], v113 offset:53248
    v_mfma_f32_16x16x32_bf16 v[152:155], v[24:27], v[96:99], v[152:155]
    ds_read_b128 v[72:75], v112 offset:55296
    v_mfma_f32_16x16x32_bf16 v[168:171], v[32:35], v[96:99], v[168:171]
    ds_read_b128 v[76:79], v113 offset:55296
    v_mfma_f32_16x16x32_bf16 v[168:171], v[36:39], v[100:103], v[168:171]
    v_mfma_f32_16x16x32_bf16 v[184:187], v[44:47], v[100:103], v[184:187]
    ds_read_b64_tr_b16 v[80:81], v114 offset:49152
    v_mfma_f32_16x16x32_bf16 v[184:187], v[40:43], v[96:99], v[184:187]
    ds_read_b64_tr_b16 v[82:83], v114 offset:50176
    v_mfma_f32_16x16x32_bf16 v[140:143], v[16:19], v[104:107], v[140:143]
    ds_read_b64_tr_b16 v[84:85], v114 offset:57344
    v_mfma_f32_16x16x32_bf16 v[140:143], v[20:23], v[108:111], v[140:143]
    ds_read_b64_tr_b16 v[86:87], v114 offset:58368
    v_mfma_f32_16x16x32_bf16 v[156:159], v[28:31], v[108:111], v[156:159]
    v_mfma_f32_16x16x32_bf16 v[156:159], v[24:27], v[104:107], v[156:159]
    ds_read_b64_tr_b16 v[88:89], v115 offset:49152
    v_mfma_f32_16x16x32_bf16 v[172:175], v[32:35], v[104:107], v[172:175]
    ds_read_b64_tr_b16 v[90:91], v115 offset:50176
    v_mfma_f32_16x16x32_bf16 v[172:175], v[36:39], v[108:111], v[172:175]
    ds_read_b64_tr_b16 v[92:93], v115 offset:57344
    v_mfma_f32_16x16x32_bf16 v[188:191], v[44:47], v[108:111], v[188:191]
    ds_read_b64_tr_b16 v[94:95], v115 offset:58368
    v_mfma_f32_16x16x32_bf16 v[188:191], v[40:43], v[104:107], v[188:191]
    s_waitcnt lgkmcnt(4)
    v_mfma_f32_16x16x32_bf16 v[128:131], v[48:51], v[80:83], v[128:131]
    ds_read_b64_tr_b16 v[96:97], v114 offset:49664
    v_mfma_f32_16x16x32_bf16 v[128:131], v[52:55], v[84:87], v[128:131]
    ds_read_b64_tr_b16 v[98:99], v114 offset:50688
    v_mfma_f32_16x16x32_bf16 v[144:147], v[60:63], v[84:87], v[144:147]
    ds_read_b64_tr_b16 v[100:101], v114 offset:57856
    v_mfma_f32_16x16x32_bf16 v[144:147], v[56:59], v[80:83], v[144:147]
    v_mfma_f32_16x16x32_bf16 v[160:163], v[64:67], v[80:83], v[160:163]
    ds_read_b64_tr_b16 v[102:103], v114 offset:58880
    v_mfma_f32_16x16x32_bf16 v[160:163], v[68:71], v[84:87], v[160:163]
    ds_read_b64_tr_b16 v[104:105], v115 offset:49664
    v_mfma_f32_16x16x32_bf16 v[176:179], v[76:79], v[84:87], v[176:179]
    ds_read_b64_tr_b16 v[106:107], v115 offset:50688
    v_mfma_f32_16x16x32_bf16 v[176:179], v[72:75], v[80:83], v[176:179]
    s_waitcnt lgkmcnt(6)
    v_mfma_f32_16x16x32_bf16 v[132:135], v[48:51], v[88:91], v[132:135]
    ds_read_b64_tr_b16 v[108:109], v115 offset:57856
    v_mfma_f32_16x16x32_bf16 v[132:135], v[52:55], v[92:95], v[132:135]
    ds_read_b64_tr_b16 v[110:111], v115 offset:58880
    v_mfma_f32_16x16x32_bf16 v[148:151], v[60:63], v[92:95], v[148:151]
    v_mfma_f32_16x16x32_bf16 v[148:151], v[56:59], v[88:91], v[148:151]
    s_waitcnt lgkmcnt(0)
    s_barrier
    v_mfma_f32_16x16x32_bf16 v[164:167], v[64:67], v[88:91], v[164:167]
    ds_read_b128 v[16:19], v112 offset:0
    s_cmp_eq_u32 s71, 2
    s_cbranch_scc0 L_run59
    buffer_load_dwordx4 v[192:195], v9, s[52:55], s78 offen nt
    buffer_load_dwordx4 v[196:199], v9, s[88:91], s78 offen nt
    s_add_u32 s78, s78, 14336
    buffer_load_dwordx4 v[200:203], v9, s[52:55], s78 offen nt
    buffer_load_dwordx4 v[204:207], v9, s[88:91], s78 offen nt
    s_add_u32 s78, s78, 14336
    buffer_load_dwordx4 v[208:211], v9, s[52:55], s78 offen nt
    buffer_load_dwordx4 v[212:215], v9, s[88:91], s78 offen nt
    s_add_u32 s78, s78, 14336
    buffer_load_dwordx4 v[216:219], v9, s[52:55], s78 offen nt
    buffer_load_dwordx4 v[220:223], v9, s[88:91], s78 offen nt
L_run59:
    v_mfma_f32_16x16x32_bf16 v[164:167], v[68:71], v[92:95], v[164:167]
    ds_read_b128 v[20:23], v113 offset:0
    v_mfma_f32_16x16x32_bf16 v[180:183], v[76:79], v[92:95], v[180:183]
    ds_read_b128 v[24:27], v112 offset:2048
    v_mfma_f32_16x16x32_bf16 v[180:183], v[72:75], v[88:91], v[180:183]
    ds_read_b128 v[28:31], v113 offset:2048
    v_mfma_f32_16x16x32_bf16 v[136:139], v[48:51], v[96:99], v[136:139]
    v_mfma_f32_16x16x32_bf16 v[136:139], v[52:55], v[100:103], v[136:139]
    ds_read_b128 v[32:35], v112 offset:4096
    v_mfma_f32_16x16x32_bf16 v[152:155], v[60:63], v[100:103], v[152:155]
    ds_read_b128 v[36:39], v113 offset:4096
    v_mfma_f32_16x16x32_bf16 v[152:155], v[56:59], v[96:99], v[152:155]
    ds_read_b128 v[40:43], v112 offset:6144
    v_mfma_f32_16x16x32_bf16 v[168:171], v[64:67], v[96:99], v[168:171]
    ds_read_b128 v[44:47], v113 offset:6144
    v_mfma_f32_16x16x32_bf16 v[168:171], v[68:71], v[100:103], v[168:171]
    v_mfma_f32_16x16x32_bf16 v[184:187], v[76:79], v[100:103], v[184:187]
    ds_read_b64_tr_b16 v[80:81], v114 offset:0
    v_mfma_f32_16x16x32_bf16 v[184:187], v[72:75], v[96:99], v[184:187]
    ds_read_b64_tr_b16 v[82:83], v114 offset:1024
    v_mfma_f32_16x16x32_bf16 v[140:143], v[48:51], v[104:107], v[140:143]
    ds_read_b64_tr_b16 v[84:85], v114 offset:8192
    v_mfma_f32_16x16x32_bf16 v[140:143], v[52:55], v[108:111], v[140:143]
    ds_read_b64_tr_b16 v[86:87], v114 offset:9216
    v_mfma_f32_16x16x32_bf16 v[156:159], v[60:63], v[108:111], v[156:159]
    v_mfma_f32_16x16x32_bf16 v[156:159], v[56:59], v[104:107], v[156:159]
    ds_read_b64_tr_b16 v[88:89], v115 offset:0
    v_mfma_f32_16x16x32_bf16 v[172:175], v[64:67], v[104:107], v[172:175]
    ds_read_b64_tr_b16 v[90:91], v115 offset:1024
    v_mfma_f32_16x16x32_bf16 v[172:175], v[68:71], v[108:111], v[172:175]
    ds_read_b64_tr_b16 v[92:93], v115 offset:8192
    v_mfma_f32_16x16x32_bf16 v[188:191], v[76:79], v[108:111], v[188:191]
    ds_read_b64_tr_b16 v[94:95], v115 offset:9216
    v_mfma_f32_16x16x32_bf16 v[188:191], v[72:75], v[104:107], v[188:191]
    s_waitcnt lgkmcnt(4)
    v_mfma_f32_16x16x32_bf16 v[128:131], v[16:19], v[80:83], v[128:131]
    ds_read_b64_tr_b16 v[96:97], v114 offset:512
    v_mfma_f32_16x16x32_bf16 v[128:131], v[20:23], v[84:87], v[128:131]
    ds_read_b64_tr_b16 v[98:99], v114 offset:1536
    v_mfma_f32_16x16x32_bf16 v[144:147], v[28:31], v[84:87], v[144:147]
    ds_read_b64_tr_b16 v[100:101], v114 offset:8704
    v_mfma_f32_16x16x32_bf16 v[144:147], v[24:27], v[80:83], v[144:147]
    v_mfma_f32_16x16x32_bf16 v[160:163], v[32:35], v[80:83], v[160:163]
    ds_read_b64_tr_b16 v[102:103], v114 offset:9728
    v_mfma_f32_16x16x32_bf16 v[160:163], v[36:39], v[84:87], v[160:163]
    ds_read_b64_tr_b16 v[104:105], v115 offset:512
    v_mfma_f32_16x16x32_bf16 v[176:179], v[44:47], v[84:87], v[176:179]
    ds_read_b64_tr_b16 v[106:107], v115 offset:1536
    v_mfma_f32_16x16x32_bf16 v[176:179], v[40:43], v[80:83], v[176:179]
    s_waitcnt lgkmcnt(6)
    v_mfma_f32_16x16x32_bf16 v[132:135], v[16:19], v[88:91], v[132:135]
    ds_read_b64_tr_b16 v[108:109], v115 offset:8704
    v_mfma_f32_16x16x32_bf16 v[132:135], v[20:23], v[92:95], v[132:135]
    ds_read_b64_tr_b16 v[110:111], v115 offset:9728
    v_mfma_f32_16x16x32_bf16 v[148:151], v[28:31], v[92:95], v[148:151]
    v_mfma_f32_16x16x32_bf16 v[148:151], v[24:27], v[88:91], v[148:151]
    s_waitcnt lgkmcnt(0)
    s_barrier
    v_mfma_f32_16x16x32_bf16 v[164:167], v[32:35], v[88:91], v[164:167]
    ds_read_b128 v[48:51], v112 offset:16384
    v_mfma_f32_16x16x32_bf16 v[164:167], v[36:39], v[92:95], v[164:167]
    ds_read_b128 v[52:55], v113 offset:16384
    v_mfma_f32_16x16x32_bf16 v[180:183], v[44:47], v[92:95], v[180:183]
    ds_read_b128 v[56:59], v112 offset:18432
    v_mfma_f32_16x16x32_bf16 v[180:183], v[40:43], v[88:91], v[180:183]
    ds_read_b128 v[60:63], v113 offset:18432
    v_mfma_f32_16x16x32_bf16 v[136:139], v[16:19], v[96:99], v[136:139]
    v_mfma_f32_16x16x32_bf16 v[136:139], v[20:23], v[100:103], v[136:139]
    ds_read_b128 v[64:67], v112 offset:20480
    v_mfma_f32_16x16x32_bf16 v[152:155], v[28:31], v[100:103], v[152:155]
    ds_read_b128 v[68:71], v113 offset:20480
    v_mfma_f32_16x16x32_bf16 v[152:155], v[24:27], v[96:99], v[152:155]
    ds_read_b128 v[72:75], v112 offset:22528
    v_mfma_f32_16x16x32_bf16 v[168:171], v[32:35], v[96:99], v[168:171]
    ds_read_b128 v[76:79], v113 offset:22528
    v_mfma_f32_16x16x32_bf16 v[168:171], v[36:39], v[100:103], v[168:171]
    v_mfma_f32_16x16x32_bf16 v[184:187], v[44:47], v[100:103], v[184:187]
    ds_read_b64_tr_b16 v[80:81], v114 offset:16384
    v_mfma_f32_16x16x32_bf16 v[184:187], v[40:43], v[96:99], v[184:187]
    ds_read_b64_tr_b16 v[82:83], v114 offset:17408
    v_mfma_f32_16x16x32_bf16 v[140:143], v[16:19], v[104:107], v[140:143]
    ds_read_b64_tr_b16 v[84:85], v114 offset:24576
    v_mfma_f32_16x16x32_bf16 v[140:143], v[20:23], v[108:111], v[140:143]
    ds_read_b64_tr_b16 v[86:87], v114 offset:25600
    v_mfma_f32_16x16x32_bf16 v[156:159], v[28:31], v[108:111], v[156:159]
    v_mfma_f32_16x16x32_bf16 v[156:159], v[24:27], v[104:107], v[156:159]
    ds_read_b64_tr_b16 v[88:89], v115 offset:16384
    v_mfma_f32_16x16x32_bf16 v[172:175], v[32:35], v[104:107], v[172:175]
    ds_read_b64_tr_b16 v[90:91], v115 offset:17408
    v_mfma_f32_16x16x32_bf16 v[172:175], v[36:39], v[108:111], v[172:175]
    ds_read_b64_tr_b16 v[92:93], v115 offset:24576
    v_mfma_f32_16x16x32_bf16 v[188:191], v[44:47], v[108:111], v[188:191]
    ds_read_b64_tr_b16 v[94:95], v115 offset:25600
    v_mfma_f32_16x16x32_bf16 v[188:191], v[40:43], v[104:107], v[188:191]
    s_waitcnt lgkmcnt(4)
    v_mfma_f32_16x16x32_bf16 v[128:131], v[48:51], v[80:83], v[128:131]
    ds_read_b64_tr_b16 v[96:97], v114 offset:16896
    v_mfma_f32_16x16x32_bf16 v[128:131], v[52:55], v[84:87], v[128:131]
    ds_read_b64_tr_b16 v[98:99], v114 offset:17920
    v_mfma_f32_16x16x32_bf16 v[144:147], v[60:63], v[84:87], v[144:147]
    ds_read_b64_tr_b16 v[100:101], v114 offset:25088
    v_mfma_f32_16x16x32_bf16 v[144:147], v[56:59], v[80:83], v[144:147]
    v_mfma_f32_16x16x32_bf16 v[160:163], v[64:67], v[80:83], v[160:163]
    ds_read_b64_tr_b16 v[102:103], v114 offset:26112
    v_mfma_f32_16x16x32_bf16 v[160:163], v[68:71], v[84:87], v[160:163]
    ds_read_b64_tr_b16 v[104:105], v115 offset:16896
    v_mfma_f32_16x16x32_bf16 v[176:179], v[76:79], v[84:87], v[176:179]
    ds_read_b64_tr_b16 v[106:107], v115 offset:17920
    v_mfma_f32_16x16x32_bf16 v[176:179], v[72:75], v[80:83], v[176:179]
    s_waitcnt lgkmcnt(6)
    v_mfma_f32_16x16x32_bf16 v[132:135], v[48:51], v[88:91], v[132:135]
    ds_read_b64_tr_b16 v[108:109], v115 offset:25088
    v_mfma_f32_16x16x32_bf16 v[132:135], v[52:55], v[92:95], v[132:135]
    ds_read_b64_tr_b16 v[110:111], v115 offset:26112
    v_mfma_f32_16x16x32_bf16 v[148:151], v[60:63], v[92:95], v[148:151]
    v_mfma_f32_16x16x32_bf16 v[148:151], v[56:59], v[88:91], v[148:151]
    s_waitcnt lgkmcnt(0)
    s_barrier
    v_mfma_f32_16x16x32_bf16 v[164:167], v[64:67], v[88:91], v[164:167]
    ds_read_b128 v[16:19], v112 offset:32768
    s_cmp_eq_u32 s71, 3
    s_cbranch_scc0 L_run60
    buffer_load_dwordx4 v[192:195], v9, s[52:55], s78 offen nt
    buffer_load_dwordx4 v[196:199], v9, s[88:91], s78 offen nt
    s_add_u32 s78, s78, 14336
    buffer_load_dwordx4 v[200:203], v9, s[52:55], s78 offen nt
    buffer_load_dwordx4 v[204:207], v9, s[88:91], s78 offen nt
    s_add_u32 s78, s78, 14336
    buffer_load_dwordx4 v[208:211], v9, s[52:55], s78 offen nt
    buffer_load_dwordx4 v[212:215], v9, s[88:91], s78 offen nt
    s_add_u32 s78, s78, 14336
    buffer_load_dwordx4 v[216:219], v9, s[52:55], s78 offen nt
    buffer_load_dwordx4 v[220:223], v9, s[88:91], s78 offen nt
L_run60:
    v_mfma_f32_16x16x32_bf16 v[164:167], v[68:71], v[92:95], v[164:167]
    ds_read_b128 v[20:23], v113 offset:32768
    v_mfma_f32_16x16x32_bf16 v[180:183], v[76:79], v[92:95], v[180:183]
    ds_read_b128 v[24:27], v112 offset:34816
    v_mfma_f32_16x16x32_bf16 v[180:183], v[72:75], v[88:91], v[180:183]
    ds_read_b128 v[28:31], v113 offset:34816
    v_mfma_f32_16x16x32_bf16 v[136:139], v[48:51], v[96:99], v[136:139]
    v_mfma_f32_16x16x32_bf16 v[136:139], v[52:55], v[100:103], v[136:139]
    ds_read_b128 v[32:35], v112 offset:36864
    v_mfma_f32_16x16x32_bf16 v[152:155], v[60:63], v[100:103], v[152:155]
    ds_read_b128 v[36:39], v113 offset:36864
    v_mfma_f32_16x16x32_bf16 v[152:155], v[56:59], v[96:99], v[152:155]
    ds_read_b128 v[40:43], v112 offset:38912
    v_mfma_f32_16x16x32_bf16 v[168:171], v[64:67], v[96:99], v[168:171]
    ds_read_b128 v[44:47], v113 offset:38912
    v_mfma_f32_16x16x32_bf16 v[168:171], v[68:71], v[100:103], v[168:171]
    v_mfma_f32_16x16x32_bf16 v[184:187], v[76:79], v[100:103], v[184:187]
    ds_read_b64_tr_b16 v[80:81], v114 offset:32768
    v_mfma_f32_16x16x32_bf16 v[184:187], v[72:75], v[96:99], v[184:187]
    ds_read_b64_tr_b16 v[82:83], v114 offset:33792
    v_mfma_f32_16x16x32_bf16 v[140:143], v[48:51], v[104:107], v[140:143]
    ds_read_b64_tr_b16 v[84:85], v114 offset:40960
    v_mfma_f32_16x16x32_bf16 v[140:143], v[52:55], v[108:111], v[140:143]
    ds_read_b64_tr_b16 v[86:87], v114 offset:41984
    v_mfma_f32_16x16x32_bf16 v[156:159], v[60:63], v[108:111], v[156:159]
    v_mfma_f32_16x16x32_bf16 v[156:159], v[56:59], v[104:107], v[156:159]
    ds_read_b64_tr_b16 v[88:89], v115 offset:32768
    v_mfma_f32_16x16x32_bf16 v[172:175], v[64:67], v[104:107], v[172:175]
    ds_read_b64_tr_b16 v[90:91], v115 offset:33792
    v_mfma_f32_16x16x32_bf16 v[172:175], v[68:71], v[108:111], v[172:175]
    ds_read_b64_tr_b16 v[92:93], v115 offset:40960
    v_mfma_f32_16x16x32_bf16 v[188:191], v[76:79], v[108:111], v[188:191]
    ds_read_b64_tr_b16 v[94:95], v115 offset:41984
    v_mfma_f32_16x16x32_bf16 v[188:191], v[72:75], v[104:107], v[188:191]
    s_waitcnt lgkmcnt(4)
    v_mfma_f32_16x16x32_bf16 v[128:131], v[16:19], v[80:83], v[128:131]
    ds_read_b64_tr_b16 v[96:97], v114 offset:33280
    v_mfma_f32_16x16x32_bf16 v[128:131], v[20:23], v[84:87], v[128:131]
    ds_read_b64_tr_b16 v[98:99], v114 offset:34304
    v_mfma_f32_16x16x32_bf16 v[144:147], v[28:31], v[84:87], v[144:147]
    ds_read_b64_tr_b16 v[100:101], v114 offset:41472
    v_mfma_f32_16x16x32_bf16 v[144:147], v[24:27], v[80:83], v[144:147]
    v_mfma_f32_16x16x32_bf16 v[160:163], v[32:35], v[80:83], v[160:163]
    ds_read_b64_tr_b16 v[102:103], v114 offset:42496
    v_mfma_f32_16x16x32_bf16 v[160:163], v[36:39], v[84:87], v[160:163]
    ds_read_b64_tr_b16 v[104:105], v115 offset:33280
    v_mfma_f32_16x16x32_bf16 v[176:179], v[44:47], v[84:87], v[176:179]
    ds_read_b64_tr_b16 v[106:107], v115 offset:34304
    v_mfma_f32_16x16x32_bf16 v[176:179], v[40:43], v[80:83], v[176:179]
    s_waitcnt lgkmcnt(6)
    v_mfma_f32_16x16x32_bf16 v[132:135], v[16:19], v[88:91], v[132:135]
    ds_read_b64_tr_b16 v[108:109], v115 offset:41472
    v_mfma_f32_16x16x32_bf16 v[132:135], v[20:23], v[92:95], v[132:135]
    ds_read_b64_tr_b16 v[110:111], v115 offset:42496
    v_mfma_f32_16x16x32_bf16 v[148:151], v[28:31], v[92:95], v[148:151]
    v_mfma_f32_16x16x32_bf16 v[148:151], v[24:27], v[88:91], v[148:151]
    s_waitcnt lgkmcnt(0)
    s_barrier
    v_mfma_f32_16x16x32_bf16 v[164:167], v[32:35], v[88:91], v[164:167]
    ds_read_b128 v[48:51], v112 offset:49152
    v_mfma_f32_16x16x32_bf16 v[164:167], v[36:39], v[92:95], v[164:167]
    ds_read_b128 v[52:55], v113 offset:49152
    v_mfma_f32_16x16x32_bf16 v[180:183], v[44:47], v[92:95], v[180:183]
    ds_read_b128 v[56:59], v112 offset:51200
    v_mfma_f32_16x16x32_bf16 v[180:183], v[40:43], v[88:91], v[180:183]
    ds_read_b128 v[60:63], v113 offset:51200
    v_mfma_f32_16x16x32_bf16 v[136:139], v[16:19], v[96:99], v[136:139]
    v_mfma_f32_16x16x32_bf16 v[136:139], v[20:23], v[100:103], v[136:139]
    ds_read_b128 v[64:67], v112 offset:53248
    v_mfma_f32_16x16x32_bf16 v[152:155], v[28:31], v[100:103], v[152:155]
    ds_read_b128 v[68:71], v113 offset:53248
    v_mfma_f32_16x16x32_bf16 v[152:155], v[24:27], v[96:99], v[152:155]
    ds_read_b128 v[72:75], v112 offset:55296
    v_mfma_f32_16x16x32_bf16 v[168:171], v[32:35], v[96:99], v[168:171]
    ds_read_b128 v[76:79], v113 offset:55296
    v_mfma_f32_16x16x32_bf16 v[168:171], v[36:39], v[100:103], v[168:171]
    v_mfma_f32_16x16x32_bf16 v[184:187], v[44:47], v[100:103], v[184:187]
    ds_read_b64_tr_b16 v[80:81], v114 offset:49152
    v_mfma_f32_16x16x32_bf16 v[184:187], v[40:43], v[96:99], v[184:187]
    ds_read_b64_tr_b16 v[82:83], v114 offset:50176
    v_mfma_f32_16x16x32_bf16 v[140:143], v[16:19], v[104:107], v[140:143]
    ds_read_b64_tr_b16 v[84:85], v114 offset:57344
    v_mfma_f32_16x16x32_bf16 v[140:143], v[20:23], v[108:111], v[140:143]
    ds_read_b64_tr_b16 v[86:87], v114 offset:58368
    v_mfma_f32_16x16x32_bf16 v[156:159], v[28:31], v[108:111], v[156:159]
    v_mfma_f32_16x16x32_bf16 v[156:159], v[24:27], v[104:107], v[156:159]
    ds_read_b64_tr_b16 v[88:89], v115 offset:49152
    v_mfma_f32_16x16x32_bf16 v[172:175], v[32:35], v[104:107], v[172:175]
    ds_read_b64_tr_b16 v[90:91], v115 offset:50176
    v_mfma_f32_16x16x32_bf16 v[172:175], v[36:39], v[108:111], v[172:175]
    ds_read_b64_tr_b16 v[92:93], v115 offset:57344
    v_mfma_f32_16x16x32_bf16 v[188:191], v[44:47], v[108:111], v[188:191]
    ds_read_b64_tr_b16 v[94:95], v115 offset:58368
    v_mfma_f32_16x16x32_bf16 v[188:191], v[40:43], v[104:107], v[188:191]
    s_waitcnt lgkmcnt(4)
    v_mfma_f32_16x16x32_bf16 v[128:131], v[48:51], v[80:83], v[128:131]
    ds_read_b64_tr_b16 v[96:97], v114 offset:49664
    v_mfma_f32_16x16x32_bf16 v[128:131], v[52:55], v[84:87], v[128:131]
    ds_read_b64_tr_b16 v[98:99], v114 offset:50688
    v_mfma_f32_16x16x32_bf16 v[144:147], v[60:63], v[84:87], v[144:147]
    ds_read_b64_tr_b16 v[100:101], v114 offset:57856
    v_mfma_f32_16x16x32_bf16 v[144:147], v[56:59], v[80:83], v[144:147]
    v_mfma_f32_16x16x32_bf16 v[160:163], v[64:67], v[80:83], v[160:163]
    ds_read_b64_tr_b16 v[102:103], v114 offset:58880
    v_mfma_f32_16x16x32_bf16 v[160:163], v[68:71], v[84:87], v[160:163]
    ds_read_b64_tr_b16 v[104:105], v115 offset:49664
    v_mfma_f32_16x16x32_bf16 v[176:179], v[76:79], v[84:87], v[176:179]
    ds_read_b64_tr_b16 v[106:107], v115 offset:50688
    v_mfma_f32_16x16x32_bf16 v[176:179], v[72:75], v[80:83], v[176:179]
    s_waitcnt lgkmcnt(6)
    v_mfma_f32_16x16x32_bf16 v[132:135], v[48:51], v[88:91], v[132:135]
    ds_read_b64_tr_b16 v[108:109], v115 offset:57856
    v_mfma_f32_16x16x32_bf16 v[132:135], v[52:55], v[92:95], v[132:135]
    ds_read_b64_tr_b16 v[110:111], v115 offset:58880
    v_mfma_f32_16x16x32_bf16 v[148:151], v[60:63], v[92:95], v[148:151]
    v_mfma_f32_16x16x32_bf16 v[148:151], v[56:59], v[88:91], v[148:151]
    s_waitcnt lgkmcnt(0)
    s_barrier
    v_mfma_f32_16x16x32_bf16 v[164:167], v[64:67], v[88:91], v[164:167]
    ds_read_b128 v[16:19], v112 offset:0
    v_mfma_f32_16x16x32_bf16 v[164:167], v[68:71], v[92:95], v[164:167]
    ds_read_b128 v[20:23], v113 offset:0
    v_mfma_f32_16x16x32_bf16 v[180:183], v[76:79], v[92:95], v[180:183]
    ds_read_b128 v[24:27], v112 offset:2048
    v_mfma_f32_16x16x32_bf16 v[180:183], v[72:75], v[88:91], v[180:183]
    ds_read_b128 v[28:31], v113 offset:2048
    v_mfma_f32_16x16x32_bf16 v[136:139], v[48:51], v[96:99], v[136:139]
    v_mfma_f32_16x16x32_bf16 v[136:139], v[52:55], v[100:103], v[136:139]
    ds_read_b128 v[32:35], v112 offset:4096
    v_mfma_f32_16x16x32_bf16 v[152:155], v[60:63], v[100:103], v[152:155]
    ds_read_b128 v[36:39], v113 offset:4096
    v_mfma_f32_16x16x32_bf16 v[152:155], v[56:59], v[96:99], v[152:155]
    ds_read_b128 v[40:43], v112 offset:6144
    v_mfma_f32_16x16x32_bf16 v[168:171], v[64:67], v[96:99], v[168:171]
    ds_read_b128 v[44:47], v113 offset:6144
    v_mfma_f32_16x16x32_bf16 v[168:171], v[68:71], v[100:103], v[168:171]
    v_mfma_f32_16x16x32_bf16 v[184:187], v[76:79], v[100:103], v[184:187]
    ds_read_b64_tr_b16 v[80:81], v114 offset:0
    v_mfma_f32_16x16x32_bf16 v[184:187], v[72:75], v[96:99], v[184:187]
    ds_read_b64_tr_b16 v[82:83], v114 offset:1024
    v_mfma_f32_16x16x32_bf16 v[140:143], v[48:51], v[104:107], v[140:143]
    ds_read_b64_tr_b16 v[84:85], v114 offset:8192
    v_mfma_f32_16x16x32_bf16 v[140:143], v[52:55], v[108:111], v[140:143]
    ds_read_b64_tr_b16 v[86:87], v114 offset:9216
    v_mfma_f32_16x16x32_bf16 v[156:159], v[60:63], v[108:111], v[156:159]
    v_mfma_f32_16x16x32_bf16 v[156:159], v[56:59], v[104:107], v[156:159]
    ds_read_b64_tr_b16 v[88:89], v115 offset:0
    v_mfma_f32_16x16x32_bf16 v[172:175], v[64:67], v[104:107], v[172:175]
    ds_read_b64_tr_b16 v[90:91], v115 offset:1024
    v_mfma_f32_16x16x32_bf16 v[172:175], v[68:71], v[108:111], v[172:175]
    ds_read_b64_tr_b16 v[92:93], v115 offset:8192
    v_mfma_f32_16x16x32_bf16 v[188:191], v[76:79], v[108:111], v[188:191]
    ds_read_b64_tr_b16 v[94:95], v115 offset:9216
    v_mfma_f32_16x16x32_bf16 v[188:191], v[72:75], v[104:107], v[188:191]
    s_waitcnt lgkmcnt(4)
    v_mfma_f32_16x16x32_bf16 v[128:131], v[16:19], v[80:83], v[128:131]
    ds_read_b64_tr_b16 v[96:97], v114 offset:512
    v_mfma_f32_16x16x32_bf16 v[128:131], v[20:23], v[84:87], v[128:131]
    ds_read_b64_tr_b16 v[98:99], v114 offset:1536
    v_mfma_f32_16x16x32_bf16 v[144:147], v[28:31], v[84:87], v[144:147]
    ds_read_b64_tr_b16 v[100:101], v114 offset:8704
    v_mfma_f32_16x16x32_bf16 v[144:147], v[24:27], v[80:83], v[144:147]
    v_mfma_f32_16x16x32_bf16 v[160:163], v[32:35], v[80:83], v[160:163]
    ds_read_b64_tr_b16 v[102:103], v114 offset:9728
    v_mfma_f32_16x16x32_bf16 v[160:163], v[36:39], v[84:87], v[160:163]
    ds_read_b64_tr_b16 v[104:105], v115 offset:512
    v_mfma_f32_16x16x32_bf16 v[176:179], v[44:47], v[84:87], v[176:179]
    ds_read_b64_tr_b16 v[106:107], v115 offset:1536
    v_mfma_f32_16x16x32_bf16 v[176:179], v[40:43], v[80:83], v[176:179]
    s_waitcnt lgkmcnt(6)
    v_mfma_f32_16x16x32_bf16 v[132:135], v[16:19], v[88:91], v[132:135]
    ds_read_b64_tr_b16 v[108:109], v115 offset:8704
    v_mfma_f32_16x16x32_bf16 v[132:135], v[20:23], v[92:95], v[132:135]
    ds_read_b64_tr_b16 v[110:111], v115 offset:9728
    v_mfma_f32_16x16x32_bf16 v[148:151], v[28:31], v[92:95], v[148:151]
    v_mfma_f32_16x16x32_bf16 v[148:151], v[24:27], v[88:91], v[148:151]
    s_waitcnt lgkmcnt(0)
    s_barrier
    v_mfma_f32_16x16x32_bf16 v[164:167], v[32:35], v[88:91], v[164:167]
    ds_read_b128 v[48:51], v112 offset:16384
    v_mfma_f32_16x16x32_bf16 v[164:167], v[36:39], v[92:95], v[164:167]
    ds_read_b128 v[52:55], v113 offset:16384
    v_mfma_f32_16x16x32_bf16 v[180:183], v[44:47], v[92:95], v[180:183]
    ds_read_b128 v[56:59], v112 offset:18432
    v_mfma_f32_16x16x32_bf16 v[180:183], v[40:43], v[88:91], v[180:183]
    ds_read_b128 v[60:63], v113 offset:18432
    v_mfma_f32_16x16x32_bf16 v[136:139], v[16:19], v[96:99], v[136:139]
    v_mfma_f32_16x16x32_bf16 v[136:139], v[20:23], v[100:103], v[136:139]
    ds_read_b128 v[64:67], v112 offset:20480
    v_mfma_f32_16x16x32_bf16 v[152:155], v[28:31], v[100:103], v[152:155]
    ds_read_b128 v[68:71], v113 offset:20480
    v_mfma_f32_16x16x32_bf16 v[152:155], v[24:27], v[96:99], v[152:155]
    ds_read_b128 v[72:75], v112 offset:22528
    v_mfma_f32_16x16x32_bf16 v[168:171], v[32:35], v[96:99], v[168:171]
    ds_read_b128 v[76:79], v113 offset:22528
    v_mfma_f32_16x16x32_bf16 v[168:171], v[36:39], v[100:103], v[168:171]
    v_mfma_f32_16x16x32_bf16 v[184:187], v[44:47], v[100:103], v[184:187]
    ds_read_b64_tr_b16 v[80:81], v114 offset:16384
    v_mfma_f32_16x16x32_bf16 v[184:187], v[40:43], v[96:99], v[184:187]
    ds_read_b64_tr_b16 v[82:83], v114 offset:17408
    v_mfma_f32_16x16x32_bf16 v[140:143], v[16:19], v[104:107], v[140:143]
    ds_read_b64_tr_b16 v[84:85], v114 offset:24576
    v_mfma_f32_16x16x32_bf16 v[140:143], v[20:23], v[108:111], v[140:143]
    ds_read_b64_tr_b16 v[86:87], v114 offset:25600
    v_mfma_f32_16x16x32_bf16 v[156:159], v[28:31], v[108:111], v[156:159]
    v_mfma_f32_16x16x32_bf16 v[156:159], v[24:27], v[104:107], v[156:159]
    ds_read_b64_tr_b16 v[88:89], v115 offset:16384
    v_mfma_f32_16x16x32_bf16 v[172:175], v[32:35], v[104:107], v[172:175]
    ds_read_b64_tr_b16 v[90:91], v115 offset:17408
    v_mfma_f32_16x16x32_bf16 v[172:175], v[36:39], v[108:111], v[172:175]
    ds_read_b64_tr_b16 v[92:93], v115 offset:24576
    v_mfma_f32_16x16x32_bf16 v[188:191], v[44:47], v[108:111], v[188:191]
    ds_read_b64_tr_b16 v[94:95], v115 offset:25600
    v_mfma_f32_16x16x32_bf16 v[188:191], v[40:43], v[104:107], v[188:191]
    s_waitcnt lgkmcnt(4)
    v_mfma_f32_16x16x32_bf16 v[128:131], v[48:51], v[80:83], v[128:131]
    ds_read_b64_tr_b16 v[96:97], v114 offset:16896
    v_mfma_f32_16x16x32_bf16 v[128:131], v[52:55], v[84:87], v[128:131]
    ds_read_b64_tr_b16 v[98:99], v114 offset:17920
    v_mfma_f32_16x16x32_bf16 v[144:147], v[60:63], v[84:87], v[144:147]
    ds_read_b64_tr_b16 v[100:101], v114 offset:25088
    v_mfma_f32_16x16x32_bf16 v[144:147], v[56:59], v[80:83], v[144:147]
    v_mfma_f32_16x16x32_bf16 v[160:163], v[64:67], v[80:83], v[160:163]
    ds_read_b64_tr_b16 v[102:103], v114 offset:26112
    v_mfma_f32_16x16x32_bf16 v[160:163], v[68:71], v[84:87], v[160:163]
    ds_read_b64_tr_b16 v[104:105], v115 offset:16896
    v_mfma_f32_16x16x32_bf16 v[176:179], v[76:79], v[84:87], v[176:179]
    ds_read_b64_tr_b16 v[106:107], v115 offset:17920
    v_mfma_f32_16x16x32_bf16 v[176:179], v[72:75], v[80:83], v[176:179]
    s_waitcnt lgkmcnt(6)
    v_mfma_f32_16x16x32_bf16 v[132:135], v[48:51], v[88:91], v[132:135]
    ds_read_b64_tr_b16 v[108:109], v115 offset:25088
    v_mfma_f32_16x16x32_bf16 v[132:135], v[52:55], v[92:95], v[132:135]
    ds_read_b64_tr_b16 v[110:111], v115 offset:26112
    v_mfma_f32_16x16x32_bf16 v[148:151], v[60:63], v[92:95], v[148:151]
    v_mfma_f32_16x16x32_bf16 v[148:151], v[56:59], v[88:91], v[148:151]
    s_waitcnt lgkmcnt(0)
    s_barrier
    v_mfma_f32_16x16x32_bf16 v[164:167], v[64:67], v[88:91], v[164:167]
    ds_read_b128 v[16:19], v112 offset:32768
    v_mfma_f32_16x16x32_bf16 v[164:167], v[68:71], v[92:95], v[164:167]
    ds_read_b128 v[20:23], v113 offset:32768
    v_mfma_f32_16x16x32_bf16 v[180:183], v[76:79], v[92:95], v[180:183]
    ds_read_b128 v[24:27], v112 offset:34816
    v_mfma_f32_16x16x32_bf16 v[180:183], v[72:75], v[88:91], v[180:183]
    ds_read_b128 v[28:31], v113 offset:34816
    v_mfma_f32_16x16x32_bf16 v[136:139], v[48:51], v[96:99], v[136:139]
    v_mfma_f32_16x16x32_bf16 v[136:139], v[52:55], v[100:103], v[136:139]
    ds_read_b128 v[32:35], v112 offset:36864
    v_mfma_f32_16x16x32_bf16 v[152:155], v[60:63], v[100:103], v[152:155]
    ds_read_b128 v[36:39], v113 offset:36864
    v_mfma_f32_16x16x32_bf16 v[152:155], v[56:59], v[96:99], v[152:155]
    ds_read_b128 v[40:43], v112 offset:38912
    v_mfma_f32_16x16x32_bf16 v[168:171], v[64:67], v[96:99], v[168:171]
    ds_read_b128 v[44:47], v113 offset:38912
    v_mfma_f32_16x16x32_bf16 v[168:171], v[68:71], v[100:103], v[168:171]
    v_mfma_f32_16x16x32_bf16 v[184:187], v[76:79], v[100:103], v[184:187]
    ds_read_b64_tr_b16 v[80:81], v114 offset:32768
    v_mfma_f32_16x16x32_bf16 v[184:187], v[72:75], v[96:99], v[184:187]
    ds_read_b64_tr_b16 v[82:83], v114 offset:33792
    v_mfma_f32_16x16x32_bf16 v[140:143], v[48:51], v[104:107], v[140:143]
    ds_read_b64_tr_b16 v[84:85], v114 offset:40960
    v_mfma_f32_16x16x32_bf16 v[140:143], v[52:55], v[108:111], v[140:143]
    ds_read_b64_tr_b16 v[86:87], v114 offset:41984
    v_mfma_f32_16x16x32_bf16 v[156:159], v[60:63], v[108:111], v[156:159]
    v_mfma_f32_16x16x32_bf16 v[156:159], v[56:59], v[104:107], v[156:159]
    ds_read_b64_tr_b16 v[88:89], v115 offset:32768
    v_mfma_f32_16x16x32_bf16 v[172:175], v[64:67], v[104:107], v[172:175]
    ds_read_b64_tr_b16 v[90:91], v115 offset:33792
    v_mfma_f32_16x16x32_bf16 v[172:175], v[68:71], v[108:111], v[172:175]
    ds_read_b64_tr_b16 v[92:93], v115 offset:40960
    v_mfma_f32_16x16x32_bf16 v[188:191], v[76:79], v[108:111], v[188:191]
    ds_read_b64_tr_b16 v[94:95], v115 offset:41984
    v_mfma_f32_16x16x32_bf16 v[188:191], v[72:75], v[104:107], v[188:191]
    s_waitcnt lgkmcnt(4)
    v_mfma_f32_16x16x32_bf16 v[128:131], v[16:19], v[80:83], v[128:131]
    ds_read_b64_tr_b16 v[96:97], v114 offset:33280
    v_mfma_f32_16x16x32_bf16 v[128:131], v[20:23], v[84:87], v[128:131]
    ds_read_b64_tr_b16 v[98:99], v114 offset:34304
    v_mfma_f32_16x16x32_bf16 v[144:147], v[28:31], v[84:87], v[144:147]
    ds_read_b64_tr_b16 v[100:101], v114 offset:41472
    v_mfma_f32_16x16x32_bf16 v[144:147], v[24:27], v[80:83], v[144:147]
    v_mfma_f32_16x16x32_bf16 v[160:163], v[32:35], v[80:83], v[160:163]
    ds_read_b64_tr_b16 v[102:103], v114 offset:42496
    v_mfma_f32_16x16x32_bf16 v[160:163], v[36:39], v[84:87], v[160:163]
    ds_read_b64_tr_b16 v[104:105], v115 offset:33280
    v_mfma_f32_16x16x32_bf16 v[176:179], v[44:47], v[84:87], v[176:179]
    ds_read_b64_tr_b16 v[106:107], v115 offset:34304
    v_mfma_f32_16x16x32_bf16 v[176:179], v[40:43], v[80:83], v[176:179]
    s_waitcnt lgkmcnt(6)
    v_mfma_f32_16x16x32_bf16 v[132:135], v[16:19], v[88:91], v[132:135]
    ds_read_b64_tr_b16 v[108:109], v115 offset:41472
    v_mfma_f32_16x16x32_bf16 v[132:135], v[20:23], v[92:95], v[132:135]
    ds_read_b64_tr_b16 v[110:111], v115 offset:42496
    v_mfma_f32_16x16x32_bf16 v[148:151], v[28:31], v[92:95], v[148:151]
    v_mfma_f32_16x16x32_bf16 v[148:151], v[24:27], v[88:91], v[148:151]
    s_waitcnt lgkmcnt(0)
    s_barrier
    v_mfma_f32_16x16x32_bf16 v[164:167], v[32:35], v[88:91], v[164:167]
    ds_read_b128 v[48:51], v112 offset:49152
    v_mfma_f32_16x16x32_bf16 v[164:167], v[36:39], v[92:95], v[164:167]
    ds_read_b128 v[52:55], v113 offset:49152
    v_mfma_f32_16x16x32_bf16 v[180:183], v[44:47], v[92:95], v[180:183]
    ds_read_b128 v[56:59], v112 offset:51200
    v_mfma_f32_16x16x32_bf16 v[180:183], v[40:43], v[88:91], v[180:183]
    ds_read_b128 v[60:63], v113 offset:51200
    v_mfma_f32_16x16x32_bf16 v[136:139], v[16:19], v[96:99], v[136:139]
    v_mfma_f32_16x16x32_bf16 v[136:139], v[20:23], v[100:103], v[136:139]
    ds_read_b128 v[64:67], v112 offset:53248
    v_mfma_f32_16x16x32_bf16 v[152:155], v[28:31], v[100:103], v[152:155]
    ds_read_b128 v[68:71], v113 offset:53248
    v_mfma_f32_16x16x32_bf16 v[152:155], v[24:27], v[96:99], v[152:155]
    ds_read_b128 v[72:75], v112 offset:55296
    v_mfma_f32_16x16x32_bf16 v[168:171], v[32:35], v[96:99], v[168:171]
    ds_read_b128 v[76:79], v113 offset:55296
    v_mfma_f32_16x16x32_bf16 v[168:171], v[36:39], v[100:103], v[168:171]
    v_mfma_f32_16x16x32_bf16 v[184:187], v[44:47], v[100:103], v[184:187]
    ds_read_b64_tr_b16 v[80:81], v114 offset:49152
    v_mfma_f32_16x16x32_bf16 v[184:187], v[40:43], v[96:99], v[184:187]
    ds_read_b64_tr_b16 v[82:83], v114 offset:50176
    v_mfma_f32_16x16x32_bf16 v[140:143], v[16:19], v[104:107], v[140:143]
    ds_read_b64_tr_b16 v[84:85], v114 offset:57344
    v_mfma_f32_16x16x32_bf16 v[140:143], v[20:23], v[108:111], v[140:143]
    ds_read_b64_tr_b16 v[86:87], v114 offset:58368
    v_mfma_f32_16x16x32_bf16 v[156:159], v[28:31], v[108:111], v[156:159]
    v_mfma_f32_16x16x32_bf16 v[156:159], v[24:27], v[104:107], v[156:159]
    ds_read_b64_tr_b16 v[88:89], v115 offset:49152
    v_mfma_f32_16x16x32_bf16 v[172:175], v[32:35], v[104:107], v[172:175]
    ds_read_b64_tr_b16 v[90:91], v115 offset:50176
    v_mfma_f32_16x16x32_bf16 v[172:175], v[36:39], v[108:111], v[172:175]
    ds_read_b64_tr_b16 v[92:93], v115 offset:57344
    v_mfma_f32_16x16x32_bf16 v[188:191], v[44:47], v[108:111], v[188:191]
    ds_read_b64_tr_b16 v[94:95], v115 offset:58368
    v_mfma_f32_16x16x32_bf16 v[188:191], v[40:43], v[104:107], v[188:191]
    s_waitcnt lgkmcnt(4)
    v_mfma_f32_16x16x32_bf16 v[128:131], v[48:51], v[80:83], v[128:131]
    ds_read_b64_tr_b16 v[96:97], v114 offset:49664
    v_mfma_f32_16x16x32_bf16 v[128:131], v[52:55], v[84:87], v[128:131]
    ds_read_b64_tr_b16 v[98:99], v114 offset:50688
    v_mfma_f32_16x16x32_bf16 v[144:147], v[60:63], v[84:87], v[144:147]
    ds_read_b64_tr_b16 v[100:101], v114 offset:57856
    v_mfma_f32_16x16x32_bf16 v[144:147], v[56:59], v[80:83], v[144:147]
    v_mfma_f32_16x16x32_bf16 v[160:163], v[64:67], v[80:83], v[160:163]
    ds_read_b64_tr_b16 v[102:103], v114 offset:58880
    v_mfma_f32_16x16x32_bf16 v[160:163], v[68:71], v[84:87], v[160:163]
    ds_read_b64_tr_b16 v[104:105], v115 offset:49664
    v_mfma_f32_16x16x32_bf16 v[176:179], v[76:79], v[84:87], v[176:179]
    ds_read_b64_tr_b16 v[106:107], v115 offset:50688
    v_mfma_f32_16x16x32_bf16 v[176:179], v[72:75], v[80:83], v[176:179]
    s_waitcnt lgkmcnt(6)
    v_mfma_f32_16x16x32_bf16 v[132:135], v[48:51], v[88:91], v[132:135]
    ds_read_b64_tr_b16 v[108:109], v115 offset:57856
    v_mfma_f32_16x16x32_bf16 v[132:135], v[52:55], v[92:95], v[132:135]
    ds_read_b64_tr_b16 v[110:111], v115 offset:58880
    v_mfma_f32_16x16x32_bf16 v[148:151], v[60:63], v[92:95], v[148:151]
    v_mfma_f32_16x16x32_bf16 v[148:151], v[56:59], v[88:91], v[148:151]
    s_waitcnt lgkmcnt(0)
    s_barrier
    v_mfma_f32_16x16x32_bf16 v[164:167], v[64:67], v[88:91], v[164:167]
    v_mfma_f32_16x16x32_bf16 v[164:167], v[68:71], v[92:95], v[164:167]
    s_lshl_b32 s58, s36, 8
    v_lshl_add_u32 v2, v13, 4, s58
    v_mfma_f32_16x16x32_bf16 v[180:183], v[76:79], v[92:95], v[180:183]
    v_add_u32 v2, 131072, v2
    v_mfma_f32_16x16x32_bf16 v[180:183], v[72:75], v[88:91], v[180:183]
    s_lshl_b32 s58, s37, 7
    v_lshl_add_u32 v3, v12, 2, s58
    v_mfma_f32_16x16x32_bf16 v[136:139], v[48:51], v[96:99], v[136:139]
    s_lshl_b32 s58, s36, 6
    v_xor_b32 v3, s58, v3
    v_mfma_f32_16x16x32_bf16 v[136:139], v[52:55], v[100:103], v[136:139]
    v_add_u32 v3, 132608, v3
    v_mfma_f32_16x16x32_bf16 v[152:155], v[60:63], v[100:103], v[152:155]
    v_xor_b32 v4, 64, v3
    v_mfma_f32_16x16x32_bf16 v[152:155], v[56:59], v[96:99], v[152:155]
    ds_read_b32 v40, v3 offset:0
    v_mfma_f32_16x16x32_bf16 v[168:171], v[64:67], v[96:99], v[168:171]
    ds_read_b32 v42, v4 offset:0
    v_mfma_f32_16x16x32_bf16 v[168:171], v[68:71], v[100:103], v[168:171]
    ds_read_b32 v44, v3 offset:256
    v_mfma_f32_16x16x32_bf16 v[184:187], v[76:79], v[100:103], v[184:187]
    ds_read_b32 v46, v4 offset:256
    v_mfma_f32_16x16x32_bf16 v[184:187], v[72:75], v[96:99], v[184:187]
    ds_read_b32 v41, v122 offset:76
    v_mfma_f32_16x16x32_bf16 v[140:143], v[48:51], v[104:107], v[140:143]
    ds_read_b32 v43, v122 offset:72
    v_mfma_f32_16x16x32_bf16 v[140:143], v[52:55], v[108:111], v[140:143]
    ds_read_b128 v[16:19], v2 offset:0
    v_mfma_f32_16x16x32_bf16 v[156:159], v[60:63], v[108:111], v[156:159]
    ds_read_b128 v[20:23], v2 offset:1024
    v_mfma_f32_16x16x32_bf16 v[156:159], v[56:59], v[104:107], v[156:159]
    ds_read_b128 v[24:27], v2 offset:512
    v_mfma_f32_16x16x32_bf16 v[172:175], v[64:67], v[104:107], v[172:175]
    ds_read_b128 v[28:31], v2 offset:64
    v_mfma_f32_16x16x32_bf16 v[172:175], v[68:71], v[108:111], v[172:175]
    ds_read_b128 v[32:35], v2 offset:1088
    v_mfma_f32_16x16x32_bf16 v[188:191], v[76:79], v[108:111], v[188:191]
    ds_read_b128 v[36:39], v2 offset:576
    v_mfma_f32_16x16x32_bf16 v[188:191], v[72:75], v[104:107], v[188:191]
    s_add_u32 s78, s78, 14336
    buffer_load_dwordx4 v[224:227], v9, s[52:55], s78 offen nt
    buffer_load_dwordx4 v[228:231], v9, s[88:91], s78 offen nt
    s_add_u32 s78, s78, 14336
    buffer_load_dwordx4 v[232:235], v9, s[52:55], s78 offen nt
    buffer_load_dwordx4 v[236:239], v9, s[88:91], s78 offen nt
    s_add_u32 s78, s78, 14336
    buffer_load_dwordx4 v[240:243], v9, s[52:55], s78 offen nt
    buffer_load_dwordx4 v[244:247], v9, s[88:91], s78 offen nt
    s_add_u32 s78, s78, 14336
    buffer_load_dwordx4 v[248:251], v9, s[52:55], s78 offen nt
    buffer_load_dwordx4 v[252:255], v9, s[88:91], s78 offen nt
    s_setprio 3
    ds_read_b128 v[48:51], v2 offset:128
    ds_read_b128 v[52:55], v2 offset:1152
    ds_read_b128 v[56:59], v2 offset:640
    ds_read_b128 v[60:63], v2 offset:192
    ds_read_b128 v[64:67], v2 offset:1216
    ds_read_b128 v[68:71], v2 offset:704
    v_mov_b32 v72, 0x3f803f80
    v_mov_b32 v73, 0x3f803f80
    v_mov_b32 v74, 0x3f803f80
    v_mov_b32 v75, 0x3f803f80
    s_mov_b32 s40, 0x3f317218
    s_mov_b32 s41, 0x3f317218
    s_mov_b32 s42, 0x35c1a2a0
    v_mov_b32 v11, 0xff
    s_waitcnt lgkmcnt(6)
    v_readfirstlane_b32 s60, v41
    v_readfirstlane_b32 s49, v43
    s_lshr_b32 s61, s60, 8
    s_lshr_b32 s62, s60, 16
    s_lshr_b32 s63, s60, 24
    s_mov_b32 s64, 0x0c0c0400
    s_mov_b32 s65, 0x04000c0c
    v_pk_fma_f32 v[96:97], v[16:17], v[40:41], v[128:129] op_sel_hi:[1,0,1] neg_lo:[1,0,0] neg_hi:[1,0,0]
    v_pk_fma_f32 v[104:105], v[16:17], v[42:43], v[132:133] op_sel_hi:[1,0,1] neg_lo:[1,0,0] neg_hi:[1,0,0]
    v_pk_fma_f32 v[136:137], v[16:17], v[44:45], v[136:137] op_sel_hi:[1,0,1] neg_lo:[1,0,0] neg_hi:[1,0,0]
    v_pk_fma_f32 v[98:99], v[18:19], v[40:41], v[130:131] op_sel_hi:[1,0,1] neg_lo:[1,0,0] neg_hi:[1,0,0]
    v_pk_fma_f32 v[106:107], v[18:19], v[42:43], v[134:135] op_sel_hi:[1,0,1] neg_lo:[1,0,0] neg_hi:[1,0,0]
    v_pk_fma_f32 v[138:139], v[18:19], v[44:45], v[138:139] op_sel_hi:[1,0,1] neg_lo:[1,0,0] neg_hi:[1,0,0]
    v_pk_mul_f32 v[96:97], v[96:97], v[20:21] op_sel_hi:[1,1]
    v_pk_mul_f32 v[104:105], v[104:105], v[20:21] op_sel_hi:[1,1]
    v_pk_mul_f32 v[136:137], v[136:137], v[24:25]
    v_pk_mul_f32 v[98:99], v[98:99], v[22:23] op_sel_hi:[1,1]
    v_pk_mul_f32 v[106:107], v[106:107], v[22:23] op_sel_hi:[1,1]
    v_pk_mul_f32 v[138:139], v[138:139], v[26:27]
    v_exp_f32 v100, v96 clamp
    v_exp_f32 v108, v104 clamp
    v_cvt_pk_bf16_f32 v88, v136, v137
    v_exp_f32 v101, v97 clamp
    v_exp_f32 v109, v105 clamp
    v_cvt_pk_bf16_f32 v89, v138, v139
    v_exp_f32 v102, v98 clamp
    v_exp_f32 v110, v106 clamp
    v_pk_fma_f32 v[140:141], v[16:17], v[46:47], v[140:141] op_sel_hi:[1,0,1] neg_lo:[1,0,0] neg_hi:[1,0,0]
    v_exp_f32 v103, v99 clamp
    v_exp_f32 v111, v107 clamp
    v_pk_fma_f32 v[142:143], v[18:19], v[46:47], v[142:143] op_sel_hi:[1,0,1] neg_lo:[1,0,0] neg_hi:[1,0,0]
    v_max_f32 v96, s42, v96
    v_max_f32 v104, s42, v104
    v_pk_mul_f32 v[140:141], v[140:141], v[24:25]
    v_max_f32 v97, s42, v97
    v_max_f32 v105, s42, v105
    v_pk_mul_f32 v[142:143], v[142:143], v[26:27]
    v_max_f32 v98, s42, v98
    v_max_f32 v106, s42, v106
    v_cvt_pk_bf16_f32 v92, v140, v141
    v_max_f32 v99, s42, v99
    v_max_f32 v107, s42, v107
    v_cvt_pk_bf16_f32 v93, v142, v143
    v_pk_fma_f32 v[96:97], v[96:97], s[40:41], v[100:101]
    v_pk_fma_f32 v[104:105], v[104:105], s[40:41], v[108:109]
    v_pk_fma_f32 v[98:99], v[98:99], s[40:41], v[102:103]
    v_pk_fma_f32 v[106:107], v[106:107], s[40:41], v[110:111]
    v_cvt_pk_bf16_f32 v80, v96, v97
    v_cvt_pk_bf16_f32 v84, v104, v105
    v_cvt_pk_bf16_f32 v81, v98, v99
    v_cvt_pk_bf16_f32 v85, v106, v107
    v_pk_fma_f32 v[96:97], v[28:29], v[40:41], v[144:145] op_sel_hi:[1,0,1] neg_lo:[1,0,0] neg_hi:[1,0,0]
    v_pk_fma_f32 v[104:105], v[28:29], v[42:43], v[148:149] op_sel_hi:[1,0,1] neg_lo:[1,0,0] neg_hi:[1,0,0]
    v_pk_fma_f32 v[152:153], v[28:29], v[44:45], v[152:153] op_sel_hi:[1,0,1] neg_lo:[1,0,0] neg_hi:[1,0,0]
    v_pk_fma_f32 v[98:99], v[30:31], v[40:41], v[146:147] op_sel_hi:[1,0,1] neg_lo:[1,0,0] neg_hi:[1,0,0]
    v_pk_fma_f32 v[106:107], v[30:31], v[42:43], v[150:151] op_sel_hi:[1,0,1] neg_lo:[1,0,0] neg_hi:[1,0,0]
    v_pk_fma_f32 v[154:155], v[30:31], v[44:45], v[154:155] op_sel_hi:[1,0,1] neg_lo:[1,0,0] neg_hi:[1,0,0]
    v_pk_mul_f32 v[96:97], v[96:97], v[32:33] op_sel_hi:[1,1]
    v_pk_mul_f32 v[104:105], v[104:105], v[32:33] op_sel_hi:[1,1]
    v_pk_mul_f32 v[152:153], v[152:153], v[36:37]
    v_pk_mul_f32 v[98:99], v[98:99], v[34:35] op_sel_hi:[1,1]
    v_pk_mul_f32 v[106:107], v[106:107], v[34:35] op_sel_hi:[1,1]
    v_pk_mul_f32 v[154:155], v[154:155], v[38:39]
    v_exp_f32 v100, v96 clamp
    v_exp_f32 v108, v104 clamp
    v_cvt_pk_bf16_f32 v90, v152, v153
    v_exp_f32 v101, v97 clamp
    v_exp_f32 v109, v105 clamp
    v_cvt_pk_bf16_f32 v91, v154, v155
    v_exp_f32 v102, v98 clamp
    v_exp_f32 v110, v106 clamp
    v_pk_fma_f32 v[156:157], v[28:29], v[46:47], v[156:157] op_sel_hi:[1,0,1] neg_lo:[1,0,0] neg_hi:[1,0,0]
    v_exp_f32 v103, v99 clamp
    v_exp_f32 v111, v107 clamp
    v_pk_fma_f32 v[158:159], v[30:31], v[46:47], v[158:159] op_sel_hi:[1,0,1] neg_lo:[1,0,0] neg_hi:[1,0,0]
    v_max_f32 v96, s42, v96
    v_max_f32 v104, s42, v104
    v_pk_mul_f32 v[156:157], v[156:157], v[36:37]
    v_max_f32 v97, s42, v97
    v_max_f32 v105, s42, v105
    v_pk_mul_f32 v[158:159], v[158:159], v[38:39]
    v_max_f32 v98, s42, v98
    v_max_f32 v106, s42, v106
    v_cvt_pk_bf16_f32 v94, v156, v157
    v_max_f32 v99, s42, v99
    v_max_f32 v107, s42, v107
    v_cvt_pk_bf16_f32 v95, v158, v159
    v_pk_fma_f32 v[96:97], v[96:97], s[40:41], v[100:101]
    v_pk_fma_f32 v[104:105], v[104:105], s[40:41], v[108:109]
    v_pk_fma_f32 v[98:99], v[98:99], s[40:41], v[102:103]
    v_pk_fma_f32 v[106:107], v[106:107], s[40:41], v[110:111]
    v_cvt_pk_bf16_f32 v82, v96, v97
    v_cvt_pk_bf16_f32 v86, v104, v105
    v_cvt_pk_bf16_f32 v83, v98, v99
    v_cvt_pk_bf16_f32 v87, v106, v107
    s_nop 0
    v_mfma_f32_16x16x32_bf16 v[144:147], v[80:83], v[88:91], 0
    v_mfma_f32_16x16x32_bf16 v[148:151], v[84:87], v[88:91], 0
    v_mfma_f32_16x16x32_bf16 v[152:155], v[80:83], v[92:95], 0
    v_mfma_f32_16x16x32_bf16 v[156:159], v[84:87], v[92:95], 0
    v_mfma_f32_16x16x32_bf16 v[16:19], v[80:83], v[72:75], 0
    v_mfma_f32_16x16x32_bf16 v[20:23], v[84:87], v[72:75], 0
    s_waitcnt lgkmcnt(0)
    v_pk_fma_f32 v[96:97], v[48:49], v[40:41], v[160:161] op_sel_hi:[1,0,1] neg_lo:[1,0,0] neg_hi:[1,0,0]
    v_pk_fma_f32 v[104:105], v[48:49], v[42:43], v[164:165] op_sel_hi:[1,0,1] neg_lo:[1,0,0] neg_hi:[1,0,0]
    v_pk_fma_f32 v[168:169], v[48:49], v[44:45], v[168:169] op_sel_hi:[1,0,1] neg_lo:[1,0,0] neg_hi:[1,0,0]
    v_pk_fma_f32 v[98:99], v[50:51], v[40:41], v[162:163] op_sel_hi:[1,0,1] neg_lo:[1,0,0] neg_hi:[1,0,0]
    v_pk_fma_f32 v[106:107], v[50:51], v[42:43], v[166:167] op_sel_hi:[1,0,1] neg_lo:[1,0,0] neg_hi:[1,0,0]
    v_pk_fma_f32 v[170:171], v[50:51], v[44:45], v[170:171] op_sel_hi:[1,0,1] neg_lo:[1,0,0] neg_hi:[1,0,0]
    v_pk_mul_f32 v[96:97], v[96:97], v[52:53] op_sel_hi:[1,1]
    v_pk_mul_f32 v[104:105], v[104:105], v[52:53] op_sel_hi:[1,1]
    v_pk_mul_f32 v[168:169], v[168:169], v[56:57]
    v_pk_mul_f32 v[98:99], v[98:99], v[54:55] op_sel_hi:[1,1]
    v_pk_mul_f32 v[106:107], v[106:107], v[54:55] op_sel_hi:[1,1]
    v_pk_mul_f32 v[170:171], v[170:171], v[58:59]
    v_exp_f32 v100, v96 clamp
    v_exp_f32 v108, v104 clamp
    v_cvt_pk_bf16_f32 v136, v168, v169
    v_exp_f32 v101, v97 clamp
    v_exp_f32 v109, v105 clamp
    v_cvt_pk_bf16_f32 v137, v170, v171
    v_exp_f32 v102, v98 clamp
    v_exp_f32 v110, v106 clamp
    v_pk_fma_f32 v[172:173], v[48:49], v[46:47], v[172:173] op_sel_hi:[1,0,1] neg_lo:[1,0,0] neg_hi:[1,0,0]
    v_exp_f32 v103, v99 clamp
    v_exp_f32 v111, v107 clamp
    v_pk_fma_f32 v[174:175], v[50:51], v[46:47], v[174:175] op_sel_hi:[1,0,1] neg_lo:[1,0,0] neg_hi:[1,0,0]
    v_max_f32 v96, s42, v96
    v_max_f32 v104, s42, v104
    v_pk_mul_f32 v[172:173], v[172:173], v[56:57]
    v_max_f32 v97, s42, v97
    v_max_f32 v105, s42, v105
    v_pk_mul_f32 v[174:175], v[174:175], v[58:59]
    v_max_f32 v98, s42, v98
    v_max_f32 v106, s42, v106
    v_cvt_pk_bf16_f32 v140, v172, v173
    v_max_f32 v99, s42, v99
    v_max_f32 v107, s42, v107
    v_cvt_pk_bf16_f32 v141, v174, v175
    v_pk_fma_f32 v[96:97], v[96:97], s[40:41], v[100:101]
    v_pk_fma_f32 v[104:105], v[104:105], s[40:41], v[108:109]
    v_pk_fma_f32 v[98:99], v[98:99], s[40:41], v[102:103]
    v_pk_fma_f32 v[106:107], v[106:107], s[40:41], v[110:111]
    v_cvt_pk_bf16_f32 v128, v96, v97
    v_cvt_pk_bf16_f32 v132, v104, v105
    v_cvt_pk_bf16_f32 v129, v98, v99
    v_cvt_pk_bf16_f32 v133, v106, v107
    v_pk_fma_f32 v[96:97], v[60:61], v[40:41], v[176:177] op_sel_hi:[1,0,1] neg_lo:[1,0,0] neg_hi:[1,0,0]
    v_pk_fma_f32 v[104:105], v[60:61], v[42:43], v[180:181] op_sel_hi:[1,0,1] neg_lo:[1,0,0] neg_hi:[1,0,0]
    v_pk_fma_f32 v[184:185], v[60:61], v[44:45], v[184:185] op_sel_hi:[1,0,1] neg_lo:[1,0,0] neg_hi:[1,0,0]
    v_pk_fma_f32 v[98:99], v[62:63], v[40:41], v[178:179] op_sel_hi:[1,0,1] neg_lo:[1,0,0] neg_hi:[1,0,0]
    v_pk_fma_f32 v[106:107], v[62:63], v[42:43], v[182:183] op_sel_hi:[1,0,1] neg_lo:[1,0,0] neg_hi:[1,0,0]
    v_pk_fma_f32 v[186:187], v[62:63], v[44:45], v[186:187] op_sel_hi:[1,0,1] neg_lo:[1,0,0] neg_hi:[1,0,0]
    v_pk_mul_f32 v[96:97], v[96:97], v[64:65] op_sel_hi:[1,1]
    v_pk_mul_f32 v[104:105], v[104:105], v[64:65] op_sel_hi:[1,1]
    v_pk_mul_f32 v[184:185], v[184:185], v[68:69]
    v_pk_mul_f32 v[98:99], v[98:99], v[66:67] op_sel_hi:[1,1]
    v_pk_mul_f32 v[106:107], v[106:107], v[66:67] op_sel_hi:[1,1]
    v_pk_mul_f32 v[186:187], v[186:187], v[70:71]
    v_exp_f32 v100, v96 clamp
    v_exp_f32 v108, v104 clamp
    v_cvt_pk_bf16_f32 v138, v184, v185
    v_exp_f32 v101, v97 clamp
    v_exp_f32 v109, v105 clamp
    v_cvt_pk_bf16_f32 v139, v186, v187
    v_exp_f32 v102, v98 clamp
    v_exp_f32 v110, v106 clamp
    v_pk_fma_f32 v[188:189], v[60:61], v[46:47], v[188:189] op_sel_hi:[1,0,1] neg_lo:[1,0,0] neg_hi:[1,0,0]
    v_exp_f32 v103, v99 clamp
    v_exp_f32 v111, v107 clamp
    v_pk_fma_f32 v[190:191], v[62:63], v[46:47], v[190:191] op_sel_hi:[1,0,1] neg_lo:[1,0,0] neg_hi:[1,0,0]
    v_max_f32 v96, s42, v96
    v_max_f32 v104, s42, v104
    v_pk_mul_f32 v[188:189], v[188:189], v[68:69]
    v_max_f32 v97, s42, v97
    v_max_f32 v105, s42, v105
    v_pk_mul_f32 v[190:191], v[190:191], v[70:71]
    v_max_f32 v98, s42, v98
    v_max_f32 v106, s42, v106
    v_cvt_pk_bf16_f32 v142, v188, v189
    v_max_f32 v99, s42, v99
    v_max_f32 v107, s42, v107
    v_cvt_pk_bf16_f32 v143, v190, v191
    v_pk_fma_f32 v[96:97], v[96:97], s[40:41], v[100:101]
    v_pk_fma_f32 v[104:105], v[104:105], s[40:41], v[108:109]
    v_pk_fma_f32 v[98:99], v[98:99], s[40:41], v[102:103]
    v_pk_fma_f32 v[106:107], v[106:107], s[40:41], v[110:111]
    v_cvt_pk_bf16_f32 v130, v96, v97
    v_cvt_pk_bf16_f32 v134, v104, v105
    v_cvt_pk_bf16_f32 v131, v98, v99
    v_cvt_pk_bf16_f32 v135, v106, v107
    s_nop 0
    v_mfma_f32_16x16x32_bf16 v[144:147], v[128:131], v[136:139], v[144:147]
    v_mfma_f32_16x16x32_bf16 v[148:151], v[132:135], v[136:139], v[148:151]
    v_mfma_f32_16x16x32_bf16 v[152:155], v[128:131], v[140:143], v[152:155]
    v_mfma_f32_16x16x32_bf16 v[156:159], v[132:135], v[140:143], v[156:159]
    v_mfma_f32_16x16x32_bf16 v[16:19], v[128:131], v[72:75], v[16:19]
    v_mfma_f32_16x16x32_bf16 v[20:23], v[132:135], v[72:75], v[20:23]
    v_lshlrev_b32 v120, 4, v1
    s_mul_i32 s58, s27, 3072
    s_add_u32 s58, s58, 142336
    v_add_u32 v2, s58, v120
    s_lshl_b32 s59, s36, 10
    v_add_u32 v3, s59, v2
    v_subrev_u32 v4, s59, v2
    ds_write_b128 v3, v[152:155]
    ds_write_b128 v4, v[156:159] offset:1024
    ds_write_b128 v2, v[20:23] offset:2048
    s_xor_b32 s58, s27, 2
    v_add_u32 v5, s58, v122
    s_mul_i32 s58, s58, 3072
    s_add_u32 s58, s58, 142336
    v_add_u32 v2, s58, v120
    v_add_u32 v3, s59, v2
    v_subrev_u32 v4, s59, v2
    s_waitcnt lgkmcnt(0)
    s_mov_b64 exec, 1
    ds_write_b8 v123, v124 offset:12
    s_mov_b64 exec, -1
    s_lshl_b32 s43, s23, 1
    s_add_u32 s43, s43, s37
    s_lshl_b32 s58, s43, 4
    s_add_u32 s58, s58, s22
    s_lshl_b32 s44, s58, 7
    s_lshl_b32 s45, s36, 6
    s_add_u32 s44, s44, s45
    s_add_u32 s44, s44, 8388608
    s_mul_i32 s58, s58, 4224
    s_lshl_b32 s45, s36, 11
    s_add_u32 s58, s58, s45
    s_add_u32 s58, s58, 11534336
    s_add_u32 s45, s58, s59
    s_sub_u32 s46, s58, s59
    v_mov_b32 v121, 1073741824
    v_lshlrev_b32 v6, 4, v13
    v_cmp_eq_u32 vcc, 0, v12
    s_nop 1
    v_cndmask_b32 v6, v121, v6, vcc
    s_mov_b32 s57, 0
L_pr:
    ds_read_u8 v7, v5 offset:12
    ds_read_b128 v[96:99], v3
    ds_read_b128 v[100:103], v4 offset:1024
    ds_read_b128 v[104:107], v2 offset:2048
    s_waitcnt lgkmcnt(3)
    v_cmp_ne_u32 vcc, 1, v7
    s_add_u32 s57, s57, 1
    s_waitcnt lgkmcnt(0)
    s_cbranch_vccz L_prd
    s_cmp_lt_u32 s57, 524288
    s_cbranch_scc1 L_pr
L_prd:
    v_pk_add_f32 v[144:145], v[144:145], v[96:97]
    v_pk_add_f32 v[146:147], v[146:147], v[98:99]
    v_bfi_b32 v144, v11, s60, v144
    v_bfi_b32 v145, v11, s61, v145
    v_bfi_b32 v146, v11, s62, v146
    v_bfi_b32 v147, v11, s63, v147
    buffer_store_dwordx4 v[144:147], v120, s[16:19], s45 offen sc1
    v_pk_add_f32 v[148:149], v[148:149], v[100:101]
    v_pk_add_f32 v[150:151], v[150:151], v[102:103]
    v_bfi_b32 v148, v11, s60, v148
    v_bfi_b32 v149, v11, s61, v149
    v_bfi_b32 v150, v11, s62, v150
    v_bfi_b32 v151, v11, s63, v151
    buffer_store_dwordx4 v[148:151], v120, s[16:19], s46 offen offset:1024 sc1
    v_pk_add_f32 v[16:17], v[16:17], v[104:105]
    v_pk_add_f32 v[18:19], v[18:19], v[106:107]
    v_bfi_b32 v16, v11, s60, v16
    v_bfi_b32 v17, v11, s61, v17
    v_bfi_b32 v18, v11, s62, v18
    v_bfi_b32 v19, v11, s63, v19
    buffer_store_dwordx4 v[16:19], v6, s[16:19], s44 offen sc1
    s_mov_b64 exec, 1
    ds_write_b8 v123, v124 offset:60
    s_mov_b64 exec, -1
    v_lshrrev_b32 v2, 3, v1
    v_and_b32 v3, 7, v1
    v_lshlrev_b32 v118, 11, v2
    v_lshl_add_u32 v118, v3, 4, v118
    s_lshl_b32 s58, s27, 8
    s_add_u32 s58, s58, 135168
    v_lshl_add_u32 v119, v2, 3, s58
    v_lshlrev_b32 v3, 4, v3
    v_mul_u32_u24 v4, 4224, v2
    v_add_u32 v4, v4, v3
    v_lshl_add_u32 v5, v2, 7, v3
    s_lshr_b32 s58, s22, 3
    s_lshl_b32 s59, s23, 1
    s_add_u32 s45, s58, s59
    s_mul_i32 s44, s45, 67584
    s_lshl_b32 s58, s22, 9
    s_and_b32 s58, s58, 0xfff
    s_add_u32 s44, s44, s58
    s_lshl_b32 s58, s27, 7
    s_add_u32 s44, s44, s58
    s_add_u32 s44, s44, 11534336
    s_lshl_b32 s58, s23, 4
    s_add_u32 s58, s58, s22
    s_lshl_b32 s46, s58, 9
    s_lshl_b32 s59, s27, 7
    s_add_u32 s46, s46, s59
    s_add_u32 s46, s46, 8781824
    v_cmp_gt_u32 vcc, 8, v1
    s_nop 1
    v_cndmask_b32 v6, v121, v120, vcc
    s_and_b32 s72, s49, 0x7ff
    s_sub_u32 s72, 0x7ff, s72
    s_lshl_b32 s49, s72, 3
    s_add_u32 s49, s49, 8585216
    s_lshl_b32 s73, s72, 11
    s_lshl_b32 s59, s87, 7
    s_add_u32 s73, s73, s59
    s_lshl_b32 s59, s27, 5
    s_add_u32 s73, s73, s59
    v_lshlrev_b32 v7, 1, v12
    v_mov_b32 v8, 0
    buffer_load_ushort v60, v7, s[8:11], s73 offen
    buffer_load_dwordx2 v[62:63], v8, s[16:19], s49 offen sc1
    v_and_b32 v2, 1, v1
    v_mov_b32 v3, 0xffff
    v_mov_b32 v7, 0xffff0000
    v_cmp_eq_u32 vcc, 1, v2
    s_nop 1
    v_cndmask_b32 v3, v3, v7, vcc
    v_lshrrev_b32 v2, 1, v1
    v_xor_b32 v2, v2, v1
    v_and_b32 v2, 8, v2
    v_cmp_eq_u32 vcc, 0, v2
    s_nop 1
    v_cndmask_b32 v3, 0, v3, vcc
    v_bfe_u32 v2, v1, 1, 2
    v_cmp_eq_u32 vcc, 0, v2
    s_nop 1
    v_cndmask_b32 v64, 0, v3, vcc
    v_cmp_eq_u32 vcc, 1, v2
    s_nop 1
    v_cndmask_b32 v65, 0, v3, vcc
    v_cmp_eq_u32 vcc, 2, v2
    s_nop 1
    v_cndmask_b32 v66, 0, v3, vcc
    v_cmp_eq_u32 vcc, 3, v2
    s_nop 1
    v_cndmask_b32 v67, 0, v3, vcc
    v_and_b32 v2, 15, v1
    v_lshlrev_b32 v117, 5, v2
    v_bfe_u32 v2, v1, 4, 1
    v_lshl_add_u32 v117, v2, 4, v117
    v_lshrrev_b32 v2, 5, v1
    v_lshl_add_u32 v117, v2, 9, v117
    s_sleep 20
    s_and_b32 s58, s22, 7
    s_lshl_b32 s58, s58, 2
    s_add_u32 s58, s58, s27
    s_cmp_eq_u32 s58, 29
    s_cbranch_scc1 L_zwave
    s_add_u32 s58, s44, 0
    buffer_load_dwordx4 v[24:27], v4, s[16:19], s58 offen sc1
    s_add_u32 s58, s44, 33792
    buffer_load_dwordx4 v[28:31], v4, s[16:19], s58 offen sc1
    s_waitcnt vmcnt(1)
    v_perm_b32 v56, v25, v24, s64
    v_perm_b32 v57, v27, v26, s65
    v_or_b32 v56, v56, v57
    v_cmp_ne_u32 vcc, s60, v56
    s_mov_b32 s57, 0
    s_nop 0
    s_cbranch_vccz L_gk61
L_gt62:
    s_sleep 6
    s_add_u32 s58, s44, 0
    buffer_load_dwordx4 v[24:27], v4, s[16:19], s58 offen sc1
    s_add_u32 s58, s44, 33792
    buffer_load_dwordx4 v[28:31], v4, s[16:19], s58 offen sc1
    s_waitcnt vmcnt(0)
    v_perm_b32 v56, v25, v24, s64
    v_perm_b32 v57, v27, v26, s65
    v_or_b32 v56, v56, v57
    v_cmp_ne_u32 vcc, s60, v56
    s_add_u32 s57, s57, 1
    s_nop 0
    s_cbranch_vccz L_gk61
    s_cmp_lt_u32 s57, 32768
    s_cbranch_scc1 L_gt62
L_gk61:
    v_and_b32 v24, 0xffffff00, v24
    v_and_b32 v25, 0xffffff00, v25
    v_and_b32 v26, 0xffffff00, v26
    v_and_b32 v27, 0xffffff00, v27
    s_waitcnt vmcnt(0)
    v_perm_b32 v56, v29, v28, s64
    v_perm_b32 v57, v31, v30, s65
    v_or_b32 v56, v56, v57
    v_cmp_ne_u32 vcc, s60, v56
    s_mov_b32 s57, 0
    s_nop 0
    s_cbranch_vccz L_gk64
L_gt65:
    s_sleep 6
    s_add_u32 s58, s44, 33792
    buffer_load_dwordx4 v[28:31], v4, s[16:19], s58 offen sc1
    s_waitcnt vmcnt(0)
    v_perm_b32 v56, v29, v28, s64
    v_perm_b32 v57, v31, v30, s65
    v_or_b32 v56, v56, v57
    v_cmp_ne_u32 vcc, s60, v56
    s_add_u32 s57, s57, 1
    s_nop 0
    s_cbranch_vccz L_gk64
    s_cmp_lt_u32 s57, 32768
    s_cbranch_scc1 L_gt65
L_gk64:
    v_and_b32 v28, 0xffffff00, v28
    v_and_b32 v29, 0xffffff00, v29
    v_and_b32 v30, 0xffffff00, v30
    v_and_b32 v31, 0xffffff00, v31
    v_pk_add_f32 v[24:25], v[24:25], v[28:29]
    v_pk_add_f32 v[26:27], v[26:27], v[30:31]
    s_nop 0
    v_add_f32_dpp v24, v24, v24 row_ror:8 row_mask:0xf bank_mask:0xf
    v_add_f32_dpp v25, v25, v25 row_ror:8 row_mask:0xf bank_mask:0xf
    v_add_f32_dpp v26, v26, v26 row_ror:8 row_mask:0xf bank_mask:0xf
    v_add_f32_dpp v27, v27, v27 row_ror:8 row_mask:0xf bank_mask:0xf
    v_mov_b32 v28, v24
    v_mov_b32 v29, v25
    v_mov_b32 v30, v26
    v_mov_b32 v31, v27
    v_permlane16_swap_b32 v24, v28
    v_permlane16_swap_b32 v25, v29
    v_permlane16_swap_b32 v26, v30
    v_permlane16_swap_b32 v27, v31
    v_pk_add_f32 v[24:25], v[24:25], v[28:29]
    v_pk_add_f32 v[26:27], v[26:27], v[30:31]
    v_mov_b32 v28, v24
    v_mov_b32 v29, v25
    v_mov_b32 v30, v26
    v_mov_b32 v31, v27
    v_permlane32_swap_b32 v24, v28
    v_permlane32_swap_b32 v25, v29
    v_permlane32_swap_b32 v26, v30
    v_permlane32_swap_b32 v27, v31
    v_pk_add_f32 v[24:25], v[24:25], v[28:29]
    v_pk_add_f32 v[26:27], v[26:27], v[30:31]
    v_bfi_b32 v24, v11, s60, v24
    v_bfi_b32 v25, v11, s61, v25
    v_bfi_b32 v26, v11, s62, v26
    v_bfi_b32 v27, v11, s63, v27
    buffer_store_dwordx4 v[24:27], v6, s[16:19], s46 offen sc1
    s_branch L_noz
L_zwave:
    s_lshl_b32 s47, s45, 11
    s_add_u32 s47, s47, 8388608
    s_lshl_b32 s45, s45, 7
    s_add_u32 s45, s45, 8912896
    buffer_load_dwordx4 v[40:43], v5, s[16:19], s47 offen offset:0 sc1
    buffer_load_dwordx4 v[44:47], v5, s[16:19], s47 offen offset:1024 sc1
    s_add_u32 s58, s44, 0
    buffer_load_dwordx4 v[24:27], v4, s[16:19], s58 offen sc1
    s_add_u32 s58, s44, 33792
    buffer_load_dwordx4 v[28:31], v4, s[16:19], s58 offen sc1
    s_waitcnt vmcnt(3)
    v_perm_b32 v56, v41, v40, s64
    v_perm_b32 v57, v43, v42, s65
    v_or_b32 v56, v56, v57
    v_cmp_ne_u32 vcc, s60, v56
    s_mov_b32 s57, 0
    s_nop 0
    s_cbranch_vccz L_gk67
L_gt68:
    s_sleep 6
    buffer_load_dwordx4 v[40:43], v5, s[16:19], s47 offen offset:0 sc1
    buffer_load_dwordx4 v[44:47], v5, s[16:19], s47 offen offset:1024 sc1
    s_add_u32 s58, s44, 0
    buffer_load_dwordx4 v[24:27], v4, s[16:19], s58 offen sc1
    s_add_u32 s58, s44, 33792
    buffer_load_dwordx4 v[28:31], v4, s[16:19], s58 offen sc1
    s_waitcnt vmcnt(0)
    v_perm_b32 v56, v41, v40, s64
    v_perm_b32 v57, v43, v42, s65
    v_or_b32 v56, v56, v57
    v_cmp_ne_u32 vcc, s60, v56
    s_add_u32 s57, s57, 1
    s_nop 0
    s_cbranch_vccz L_gk67
    s_cmp_lt_u32 s57, 32768
    s_cbranch_scc1 L_gt68
L_gk67:
    v_and_b32 v40, 0xffffff00, v40
    v_and_b32 v41, 0xffffff00, v41
    v_and_b32 v42, 0xffffff00, v42
    v_and_b32 v43, 0xffffff00, v43
    s_waitcnt vmcnt(2)
    v_perm_b32 v56, v45, v44, s64
    v_perm_b32 v57, v47, v46, s65
    v_or_b32 v56, v56, v57
    v_cmp_ne_u32 vcc, s60, v56
    s_mov_b32 s57, 0
    s_nop 0
    s_cbranch_vccz L_gk70
L_gt71:
    s_sleep 6
    buffer_load_dwordx4 v[44:47], v5, s[16:19], s47 offen offset:1024 sc1
    s_add_u32 s58, s44, 0
    buffer_load_dwordx4 v[24:27], v4, s[16:19], s58 offen sc1
    s_add_u32 s58, s44, 33792
    buffer_load_dwordx4 v[28:31], v4, s[16:19], s58 offen sc1
    s_waitcnt vmcnt(0)
    v_perm_b32 v56, v45, v44, s64
    v_perm_b32 v57, v47, v46, s65
    v_or_b32 v56, v56, v57
    v_cmp_ne_u32 vcc, s60, v56
    s_add_u32 s57, s57, 1
    s_nop 0
    s_cbranch_vccz L_gk70
    s_cmp_lt_u32 s57, 32768
    s_cbranch_scc1 L_gt71
L_gk70:
    v_and_b32 v44, 0xffffff00, v44
    v_and_b32 v45, 0xffffff00, v45
    v_and_b32 v46, 0xffffff00, v46
    v_and_b32 v47, 0xffffff00, v47
    v_pk_add_f32 v[40:41], v[40:41], v[44:45]
    v_pk_add_f32 v[42:43], v[42:43], v[46:47]
    s_nop 0
    v_add_f32_dpp v40, v40, v40 row_ror:8 row_mask:0xf bank_mask:0xf
    v_add_f32_dpp v41, v41, v41 row_ror:8 row_mask:0xf bank_mask:0xf
    v_add_f32_dpp v42, v42, v42 row_ror:8 row_mask:0xf bank_mask:0xf
    v_add_f32_dpp v43, v43, v43 row_ror:8 row_mask:0xf bank_mask:0xf
    v_mov_b32 v44, v40
    v_mov_b32 v45, v41
    v_mov_b32 v46, v42
    v_mov_b32 v47, v43
    v_permlane16_swap_b32 v40, v44
    v_permlane16_swap_b32 v41, v45
    v_permlane16_swap_b32 v42, v46
    v_permlane16_swap_b32 v43, v47
    v_pk_add_f32 v[40:41], v[40:41], v[44:45]
    v_pk_add_f32 v[42:43], v[42:43], v[46:47]
    v_mov_b32 v44, v40
    v_mov_b32 v45, v41
    v_mov_b32 v46, v42
    v_mov_b32 v47, v43
    v_permlane32_swap_b32 v40, v44
    v_permlane32_swap_b32 v41, v45
    v_permlane32_swap_b32 v42, v46
    v_permlane32_swap_b32 v43, v47
    v_pk_add_f32 v[40:41], v[40:41], v[44:45]
    v_pk_add_f32 v[42:43], v[42:43], v[46:47]
    v_bfi_b32 v40, v11, s60, v40
    v_bfi_b32 v41, v11, s61, v41
    v_bfi_b32 v42, v11, s62, v42
    v_bfi_b32 v43, v11, s63, v43
    buffer_store_dwordx4 v[40:43], v6, s[16:19], s45 offen sc1
    s_waitcnt vmcnt(2)
    v_perm_b32 v56, v25, v24, s64
    v_perm_b32 v57, v27, v26, s65
    v_or_b32 v56, v56, v57
    v_cmp_ne_u32 vcc, s60, v56
    s_mov_b32 s57, 0
    s_nop 0
    s_cbranch_vccz L_gk73
L_gt74:
    s_sleep 6
    s_add_u32 s58, s44, 0
    buffer_load_dwordx4 v[24:27], v4, s[16:19], s58 offen sc1
    s_add_u32 s58, s44, 33792
    buffer_load_dwordx4 v[28:31], v4, s[16:19], s58 offen sc1
    s_waitcnt vmcnt(0)
    v_perm_b32 v56, v25, v24, s64
    v_perm_b32 v57, v27, v26, s65
    v_or_b32 v56, v56, v57
    v_cmp_ne_u32 vcc, s60, v56
    s_add_u32 s57, s57, 1
    s_nop 0
    s_cbranch_vccz L_gk73
    s_cmp_lt_u32 s57, 32768
    s_cbranch_scc1 L_gt74
L_gk73:
    v_and_b32 v24, 0xffffff00, v24
    v_and_b32 v25, 0xffffff00, v25
    v_and_b32 v26, 0xffffff00, v26
    v_and_b32 v27, 0xffffff00, v27
    s_waitcnt vmcnt(1)
    v_perm_b32 v56, v29, v28, s64
    v_perm_b32 v57, v31, v30, s65
    v_or_b32 v56, v56, v57
    v_cmp_ne_u32 vcc, s60, v56
    s_mov_b32 s57, 0
    s_nop 0
    s_cbranch_vccz L_gk76
L_gt77:
    s_sleep 6
    s_add_u32 s58, s44, 33792
    buffer_load_dwordx4 v[28:31], v4, s[16:19], s58 offen sc1
    s_waitcnt vmcnt(0)
    v_perm_b32 v56, v29, v28, s64
    v_perm_b32 v57, v31, v30, s65
    v_or_b32 v56, v56, v57
    v_cmp_ne_u32 vcc, s60, v56
    s_add_u32 s57, s57, 1
    s_nop 0
    s_cbranch_vccz L_gk76
    s_cmp_lt_u32 s57, 32768
    s_cbranch_scc1 L_gt77
L_gk76:
    v_and_b32 v28, 0xffffff00, v28
    v_and_b32 v29, 0xffffff00, v29
    v_and_b32 v30, 0xffffff00, v30
    v_and_b32 v31, 0xffffff00, v31
    v_pk_add_f32 v[24:25], v[24:25], v[28:29]
    v_pk_add_f32 v[26:27], v[26:27], v[30:31]
    s_nop 0
    v_add_f32_dpp v24, v24, v24 row_ror:8 row_mask:0xf bank_mask:0xf
    v_add_f32_dpp v25, v25, v25 row_ror:8 row_mask:0xf bank_mask:0xf
    v_add_f32_dpp v26, v26, v26 row_ror:8 row_mask:0xf bank_mask:0xf
    v_add_f32_dpp v27, v27, v27 row_ror:8 row_mask:0xf bank_mask:0xf
    v_mov_b32 v28, v24
    v_mov_b32 v29, v25
    v_mov_b32 v30, v26
    v_mov_b32 v31, v27
    v_permlane16_swap_b32 v24, v28
    v_permlane16_swap_b32 v25, v29
    v_permlane16_swap_b32 v26, v30
    v_permlane16_swap_b32 v27, v31
    v_pk_add_f32 v[24:25], v[24:25], v[28:29]
    v_pk_add_f32 v[26:27], v[26:27], v[30:31]
    v_mov_b32 v28, v24
    v_mov_b32 v29, v25
    v_mov_b32 v30, v26
    v_mov_b32 v31, v27
    v_permlane32_swap_b32 v24, v28
    v_permlane32_swap_b32 v25, v29
    v_permlane32_swap_b32 v26, v30
    v_permlane32_swap_b32 v27, v31
    v_pk_add_f32 v[24:25], v[24:25], v[28:29]
    v_pk_add_f32 v[26:27], v[26:27], v[30:31]
    v_bfi_b32 v24, v11, s60, v24
    v_bfi_b32 v25, v11, s61, v25
    v_bfi_b32 v26, v11, s62, v26
    v_bfi_b32 v27, v11, s63, v27
    buffer_store_dwordx4 v[24:27], v6, s[16:19], s46 offen sc1
L_noz:
    s_cmp_ge_u32 s3, 224
    s_cbranch_scc1 L_ng79
    s_mov_b32 s57, 0
    s_mov_b32 s58, 0x05040100
L_xt80:
    v_perm_b32 v2, v63, v62, s58
    v_cmp_ne_u32 vcc, s60, v2
    s_add_u32 s57, s57, 1
    s_nop 0
    s_cbranch_vccz L_xk81
    s_cmp_ge_u32 s57, 32768
    s_cbranch_scc1 L_xk81
    v_mov_b32 v2, 0
    buffer_load_dwordx2 v[62:63], v2, s[16:19], s49 offen sc1
    s_waitcnt vmcnt(0)
    s_branch L_xt80
L_xk81:
    v_and_b32 v62, 0xffff0000, v62
    v_and_b32 v63, 0xffff0000, v63
    v_rcp_f32 v63, v63
    v_lshlrev_b32 v60, 16, v60
    v_sub_f32 v60, v60, v62
    v_cvt_pk_bf16_f32 v60, v60, v60
    v_lshlrev_b32 v60, 16, v60
    v_mul_f32 v60, v60, v63
    v_cvt_pk_bf16_f32 v60, v60, v60
    v_lshrrev_b32 v2, 5, v1
    v_lshlrev_b32 v2, 2, v2
    ds_bpermute_b32 v84, v2, v60 offset:0
    ds_bpermute_b32 v85, v2, v60 offset:8
    ds_bpermute_b32 v86, v2, v60 offset:16
    ds_bpermute_b32 v87, v2, v60 offset:24
    ds_bpermute_b32 v88, v2, v60 offset:32
    ds_bpermute_b32 v89, v2, v60 offset:40
    ds_bpermute_b32 v90, v2, v60 offset:48
    ds_bpermute_b32 v91, v2, v60 offset:56
    s_lshl_b32 s58, s27, 11
    s_add_u32 s58, s58, 142336
    v_add_u32 v3, s58, v117
    s_waitcnt lgkmcnt(0)
    v_and_b32 v68, v84, v64
    v_and_b32 v69, v84, v65
    v_and_b32 v70, v84, v66
    v_and_b32 v71, v84, v67
    s_nop 1
    v_mfma_f32_16x16x32_bf16 v[76:79], v[68:71], v[192:195], 0
    v_mfma_f32_16x16x32_bf16 v[80:83], v[68:71], v[196:199], 0
    v_and_b32 v72, v85, v64
    v_and_b32 v73, v85, v65
    v_and_b32 v74, v85, v66
    v_and_b32 v75, v85, v67
    s_nop 1
    v_mfma_f32_16x16x32_bf16 v[76:79], v[72:75], v[200:203], v[76:79]
    v_mfma_f32_16x16x32_bf16 v[80:83], v[72:75], v[204:207], v[80:83]
    v_and_b32 v68, v86, v64
    v_and_b32 v69, v86, v65
    v_and_b32 v70, v86, v66
    v_and_b32 v71, v86, v67
    s_nop 1
    v_mfma_f32_16x16x32_bf16 v[76:79], v[68:71], v[208:211], v[76:79]
    v_mfma_f32_16x16x32_bf16 v[80:83], v[68:71], v[212:215], v[80:83]
    v_and_b32 v72, v87, v64
    v_and_b32 v73, v87, v65
    v_and_b32 v74, v87, v66
    v_and_b32 v75, v87, v67
    s_nop 1
    v_mfma_f32_16x16x32_bf16 v[76:79], v[72:75], v[216:219], v[76:79]
    v_mfma_f32_16x16x32_bf16 v[80:83], v[72:75], v[220:223], v[80:83]
    v_and_b32 v68, v88, v64
    v_and_b32 v69, v88, v65
    v_and_b32 v70, v88, v66
    v_and_b32 v71, v88, v67
    s_nop 1
    v_mfma_f32_16x16x32_bf16 v[76:79], v[68:71], v[224:227], v[76:79]
    v_mfma_f32_16x16x32_bf16 v[80:83], v[68:71], v[228:231], v[80:83]
    v_and_b32 v72, v89, v64
    v_and_b32 v73, v89, v65
    v_and_b32 v74, v89, v66
    v_and_b32 v75, v89, v67
    s_nop 1
    v_mfma_f32_16x16x32_bf16 v[76:79], v[72:75], v[232:235], v[76:79]
    v_mfma_f32_16x16x32_bf16 v[80:83], v[72:75], v[236:239], v[80:83]
    v_and_b32 v68, v90, v64
    v_and_b32 v69, v90, v65
    v_and_b32 v70, v90, v66
    v_and_b32 v71, v90, v67
    s_nop 1
    v_mfma_f32_16x16x32_bf16 v[76:79], v[68:71], v[240:243], v[76:79]
    v_mfma_f32_16x16x32_bf16 v[80:83], v[68:71], v[244:247], v[80:83]
    v_and_b32 v72, v91, v64
    v_and_b32 v73, v91, v65
    v_and_b32 v74, v91, v66
    v_and_b32 v75, v91, v67
    s_nop 1
    v_mfma_f32_16x16x32_bf16 v[76:79], v[72:75], v[248:251], v[76:79]
    v_mfma_f32_16x16x32_bf16 v[80:83], v[72:75], v[252:255], v[80:83]
    s_nop 6
    ds_write_b128 v3, v[76:79]
    ds_write_b128 v3, v[80:83] offset:1024
    v_and_b32 v2, 31, v1
    v_lshlrev_b32 v2, 4, v2
    s_lshl_b32 s58, s27, 9
    v_add_u32 v2, s58, v2
    v_add_u32 v3, 142336, v2
    s_waitcnt lgkmcnt(0)
    s_mov_b64 exec, 1
    ds_write_b8 v123, v124 offset:8
    s_mov_b64 exec, -1
    s_mov_b32 s57, 0
L_sl82:
    ds_read_b32 v7, v122 offset:8
    s_waitcnt lgkmcnt(0)
    v_cmp_ne_u32 vcc, 0x1010101, v7
    s_add_u32 s57, s57, 1
    s_nop 0
    s_cbranch_vccz L_sld83
    s_sleep 1
    s_cmp_lt_u32 s57, 262144
    s_cbranch_scc1 L_sl82
L_sld83:
    ds_read_b128 v[92:95], v3 offset:0
    ds_read_b128 v[96:99], v3 offset:2048
    ds_read_b128 v[100:103], v3 offset:4096
    ds_read_b128 v[104:107], v3 offset:6144
    s_waitcnt lgkmcnt(0)
    v_pk_add_f32 v[92:93], v[92:93], v[96:97]
    v_pk_add_f32 v[100:101], v[100:101], v[104:105]
    v_pk_add_f32 v[94:95], v[94:95], v[98:99]
    v_pk_add_f32 v[102:103], v[102:103], v[106:107]
    v_pk_add_f32 v[92:93], v[92:93], v[100:101]
    v_pk_add_f32 v[94:95], v[94:95], v[102:103]
    v_bfi_b32 v92, v11, s60, v92
    v_bfi_b32 v93, v11, s61, v93
    v_bfi_b32 v94, v11, s62, v94
    v_bfi_b32 v95, v11, s63, v95
    v_cmp_gt_u32 vcc, 32, v1
    s_nop 1
    v_cndmask_b32 v2, v121, v2, vcc
    s_lshl_b32 s58, s3, 11
    s_add_u32 s58, s58, 11010048
    buffer_store_dwordx4 v[92:95], v2, s[16:19], s58 offen sc1
    s_mov_b64 exec, 1
    ds_write_b8 v123, v124 offset:16
    s_mov_b64 exec, -1
L_ng79:
    s_xor_b32 s43, s43, 2
    s_lshl_b32 s46, s43, 12
    s_lshl_b32 s58, s36, 11
    s_add_u32 s46, s46, s58
    s_add_u32 s46, s46, 8781824
    s_lshl_b32 s45, s43, 7
    s_add_u32 s45, s45, 8912896
    v_lshlrev_b32 v4, 4, v13
    s_mul_i32 s58, s37, 3072
    s_add_u32 s58, s58, 136192
    v_add_u32 v5, s58, v120
    s_lshl_b32 s58, s36, 10
    v_add_u32 v6, s58, v5
    s_lshl_b32 s38, s28, 7
    s_lshl_b32 s58, s27, 5
    s_add_u32 s38, s38, s58
    s_lshl_b32 s39, s38, 11
    s_lshl_b32 s58, s29, 7
    s_add_u32 s39, s39, s58
    buffer_load_dwordx4 v[128:131], v120, s[16:19], s46 offen offset:0 sc1
    buffer_load_dwordx4 v[132:135], v120, s[16:19], s46 offen offset:1024 sc1
    buffer_load_dwordx4 v[136:139], v4, s[16:19], s45 offen offset:0 sc1
    buffer_load_dwordx4 v[140:143], v4, s[16:19], s45 offen offset:64 sc1
    s_add_u32 s59, s39, 0
    buffer_load_dwordx4 v[96:99], v118, s[8:11], s59 offen
    s_add_u32 s59, s39, 16384
    buffer_load_dwordx4 v[100:103], v118, s[8:11], s59 offen
    s_add_u32 s59, s39, 32768
    buffer_load_dwordx4 v[104:107], v118, s[8:11], s59 offen
    s_add_u32 s59, s39, 49152
    buffer_load_dwordx4 v[108:111], v118, s[8:11], s59 offen
    s_waitcnt vmcnt(7)
    v_perm_b32 v56, v129, v128, s64
    v_perm_b32 v57, v131, v130, s65
    v_or_b32 v56, v56, v57
    v_cmp_ne_u32 vcc, s60, v56
    s_mov_b32 s57, 0
    s_nop 0
    s_cbranch_vccz L_gk84
L_gt85:
    s_sleep 6
    buffer_load_dwordx4 v[128:131], v120, s[16:19], s46 offen offset:0 sc1
    buffer_load_dwordx4 v[132:135], v120, s[16:19], s46 offen offset:1024 sc1
    buffer_load_dwordx4 v[136:139], v4, s[16:19], s45 offen offset:0 sc1
    buffer_load_dwordx4 v[140:143], v4, s[16:19], s45 offen offset:64 sc1
    s_waitcnt vmcnt(0)
    v_perm_b32 v56, v129, v128, s64
    v_perm_b32 v57, v131, v130, s65
    v_or_b32 v56, v56, v57
    v_cmp_ne_u32 vcc, s60, v56
    s_add_u32 s57, s57, 1
    s_nop 0
    s_cbranch_vccz L_gk84
    s_cmp_lt_u32 s57, 32768
    s_cbranch_scc1 L_gt85
L_gk84:
    v_and_b32 v128, 0xffffff00, v128
    v_and_b32 v129, 0xffffff00, v129
    v_and_b32 v130, 0xffffff00, v130
    v_and_b32 v131, 0xffffff00, v131
    v_cvt_pk_bf16_f32 v144, v128, v129
    v_cvt_pk_bf16_f32 v145, v130, v131
    s_waitcnt vmcnt(6)
    v_perm_b32 v56, v133, v132, s64
    v_perm_b32 v57, v135, v134, s65
    v_or_b32 v56, v56, v57
    v_cmp_ne_u32 vcc, s60, v56
    s_mov_b32 s57, 0
    s_nop 0
    s_cbranch_vccz L_gk87
L_gt88:
    s_sleep 6
    buffer_load_dwordx4 v[132:135], v120, s[16:19], s46 offen offset:1024 sc1
    buffer_load_dwordx4 v[136:139], v4, s[16:19], s45 offen offset:0 sc1
    buffer_load_dwordx4 v[140:143], v4, s[16:19], s45 offen offset:64 sc1
    s_waitcnt vmcnt(0)
    v_perm_b32 v56, v133, v132, s64
    v_perm_b32 v57, v135, v134, s65
    v_or_b32 v56, v56, v57
    v_cmp_ne_u32 vcc, s60, v56
    s_add_u32 s57, s57, 1
    s_nop 0
    s_cbranch_vccz L_gk87
    s_cmp_lt_u32 s57, 32768
    s_cbranch_scc1 L_gt88
L_gk87:
    v_and_b32 v132, 0xffffff00, v132
    v_and_b32 v133, 0xffffff00, v133
    v_and_b32 v134, 0xffffff00, v134
    v_and_b32 v135, 0xffffff00, v135
    v_cvt_pk_bf16_f32 v146, v132, v133
    v_cvt_pk_bf16_f32 v147, v134, v135
    ds_write_b128 v6, v[144:147]
    s_waitcnt vmcnt(5)
    v_perm_b32 v56, v137, v136, s64
    v_perm_b32 v57, v139, v138, s65
    v_or_b32 v56, v56, v57
    v_cmp_ne_u32 vcc, s60, v56
    s_mov_b32 s57, 0
    s_nop 0
    s_cbranch_vccz L_gk90
L_gt91:
    s_sleep 6
    buffer_load_dwordx4 v[136:139], v4, s[16:19], s45 offen offset:0 sc1
    buffer_load_dwordx4 v[140:143], v4, s[16:19], s45 offen offset:64 sc1
    s_waitcnt vmcnt(0)
    v_perm_b32 v56, v137, v136, s64
    v_perm_b32 v57, v139, v138, s65
    v_or_b32 v56, v56, v57
    v_cmp_ne_u32 vcc, s60, v56
    s_add_u32 s57, s57, 1
    s_nop 0
    s_cbranch_vccz L_gk90
    s_cmp_lt_u32 s57, 32768
    s_cbranch_scc1 L_gt91
L_gk90:
    v_and_b32 v136, 0xffffff00, v136
    v_and_b32 v137, 0xffffff00, v137
    v_and_b32 v138, 0xffffff00, v138
    v_and_b32 v139, 0xffffff00, v139
    v_cvt_pk_bf16_f32 v148, v136, v137
    v_cvt_pk_bf16_f32 v149, v138, v139
    s_waitcnt vmcnt(4)
    v_perm_b32 v56, v141, v140, s64
    v_perm_b32 v57, v143, v142, s65
    v_or_b32 v56, v56, v57
    v_cmp_ne_u32 vcc, s60, v56
    s_mov_b32 s57, 0
    s_nop 0
    s_cbranch_vccz L_gk93
L_gt94:
    s_sleep 6
    buffer_load_dwordx4 v[140:143], v4, s[16:19], s45 offen offset:64 sc1
    s_waitcnt vmcnt(0)
    v_perm_b32 v56, v141, v140, s64
    v_perm_b32 v57, v143, v142, s65
    v_or_b32 v56, v56, v57
    v_cmp_ne_u32 vcc, s60, v56
    s_add_u32 s57, s57, 1
    s_nop 0
    s_cbranch_vccz L_gk93
    s_cmp_lt_u32 s57, 32768
    s_cbranch_scc1 L_gt94
L_gk93:
    v_and_b32 v140, 0xffffff00, v140
    v_and_b32 v141, 0xffffff00, v141
    v_and_b32 v142, 0xffffff00, v142
    v_and_b32 v143, 0xffffff00, v143
    v_cvt_pk_bf16_f32 v150, v140, v141
    v_cvt_pk_bf16_f32 v151, v142, v143
    ds_write_b128 v5, v[148:151] offset:2048
    s_waitcnt lgkmcnt(0)
    s_mov_b64 exec, 1
    ds_write_b8 v123, v124 offset:20
    s_mov_b64 exec, -1
    s_setprio 0
    s_cmp_ge_u32 s3, 224
    s_cbranch_scc1 L_nh96
    s_cmp_lg_u32 s27, 0
    s_cbranch_scc1 L_nh96
    v_lshrrev_b32 v2, 2, v1
    v_lshlrev_b32 v2, 11, v2
    v_and_b32 v3, 3, v1
    v_lshl_add_u32 v2, v3, 4, v2
    s_lshr_b32 s58, s3, 4
    s_lshl_b32 s58, s58, 15
    s_lshl_b32 s59, s87, 6
    s_add_u32 s58, s58, s59
    s_add_u32 s58, s58, 11010048
    buffer_load_dwordx4 v[32:35], v2, s[16:19], s58 offen offset:0 sc1
    buffer_load_dwordx4 v[36:39], v2, s[16:19], s58 offen offset:1024 sc1
    s_waitcnt vmcnt(1)
    v_perm_b32 v56, v33, v32, s64
    v_perm_b32 v57, v35, v34, s65
    v_or_b32 v56, v56, v57
    v_cmp_ne_u32 vcc, s60, v56
    s_mov_b32 s57, 0
    s_nop 0
    s_cbranch_vccz L_gk97
L_gt98:
    s_sleep 6
    buffer_load_dwordx4 v[32:35], v2, s[16:19], s58 offen offset:0 sc1
    buffer_load_dwordx4 v[36:39], v2, s[16:19], s58 offen offset:1024 sc1
    s_waitcnt vmcnt(0)
    v_perm_b32 v56, v33, v32, s64
    v_perm_b32 v57, v35, v34, s65
    v_or_b32 v56, v56, v57
    v_cmp_ne_u32 vcc, s60, v56
    s_add_u32 s57, s57, 1
    s_nop 0
    s_cbranch_vccz L_gk97
    s_cmp_lt_u32 s57, 32768
    s_cbranch_scc1 L_gt98
L_gk97:
    v_and_b32 v32, 0xffffff00, v32
    v_and_b32 v33, 0xffffff00, v33
    v_and_b32 v34, 0xffffff00, v34
    v_and_b32 v35, 0xffffff00, v35
    s_waitcnt vmcnt(0)
    v_perm_b32 v56, v37, v36, s64
    v_perm_b32 v57, v39, v38, s65
    v_or_b32 v56, v56, v57
    v_cmp_ne_u32 vcc, s60, v56
    s_mov_b32 s57, 0
    s_nop 0
    s_cbranch_vccz L_gk100
L_gt101:
    s_sleep 6
    buffer_load_dwordx4 v[36:39], v2, s[16:19], s58 offen offset:1024 sc1
    s_waitcnt vmcnt(0)
    v_perm_b32 v56, v37, v36, s64
    v_perm_b32 v57, v39, v38, s65
    v_or_b32 v56, v56, v57
    v_cmp_ne_u32 vcc, s60, v56
    s_add_u32 s57, s57, 1
    s_nop 0
    s_cbranch_vccz L_gk100
    s_cmp_lt_u32 s57, 32768
    s_cbranch_scc1 L_gt101
L_gk100:
    v_and_b32 v36, 0xffffff00, v36
    v_and_b32 v37, 0xffffff00, v37
    v_and_b32 v38, 0xffffff00, v38
    v_and_b32 v39, 0xffffff00, v39
    v_add_f32_dpp v32, v32, v32 row_ror:8 row_mask:0xf bank_mask:0xf
    v_add_f32_dpp v33, v33, v33 row_ror:8 row_mask:0xf bank_mask:0xf
    v_add_f32_dpp v34, v34, v34 row_ror:8 row_mask:0xf bank_mask:0xf
    v_add_f32_dpp v35, v35, v35 row_ror:8 row_mask:0xf bank_mask:0xf
    v_add_f32_dpp v36, v36, v36 row_ror:8 row_mask:0xf bank_mask:0xf
    v_add_f32_dpp v37, v37, v37 row_ror:8 row_mask:0xf bank_mask:0xf
    v_add_f32_dpp v38, v38, v38 row_ror:8 row_mask:0xf bank_mask:0xf
    v_add_f32_dpp v39, v39, v39 row_ror:8 row_mask:0xf bank_mask:0xf
    v_add_f32_dpp v32, v32, v32 row_ror:4 row_mask:0xf bank_mask:0xf
    v_add_f32_dpp v33, v33, v33 row_ror:4 row_mask:0xf bank_mask:0xf
    v_add_f32_dpp v34, v34, v34 row_ror:4 row_mask:0xf bank_mask:0xf
    v_add_f32_dpp v35, v35, v35 row_ror:4 row_mask:0xf bank_mask:0xf
    v_add_f32_dpp v36, v36, v36 row_ror:4 row_mask:0xf bank_mask:0xf
    v_add_f32_dpp v37, v37, v37 row_ror:4 row_mask:0xf bank_mask:0xf
    v_add_f32_dpp v38, v38, v38 row_ror:4 row_mask:0xf bank_mask:0xf
    v_add_f32_dpp v39, v39, v39 row_ror:4 row_mask:0xf bank_mask:0xf
    v_mov_b32 v40, v32
    v_mov_b32 v41, v33
    v_mov_b32 v42, v34
    v_mov_b32 v43, v35
    v_mov_b32 v44, v36
    v_mov_b32 v45, v37
    v_mov_b32 v46, v38
    v_mov_b32 v47, v39
    v_permlane16_swap_b32 v32, v40
    v_permlane16_swap_b32 v33, v41
    v_permlane16_swap_b32 v34, v42
    v_permlane16_swap_b32 v35, v43
    v_permlane16_swap_b32 v36, v44
    v_permlane16_swap_b32 v37, v45
    v_permlane16_swap_b32 v38, v46
    v_permlane16_swap_b32 v39, v47
    v_pk_add_f32 v[32:33], v[32:33], v[40:41]
    v_pk_add_f32 v[34:35], v[34:35], v[42:43]
    v_pk_add_f32 v[36:37], v[36:37], v[44:45]
    v_pk_add_f32 v[38:39], v[38:39], v[46:47]
    v_mov_b32 v40, v32
    v_mov_b32 v41, v33
    v_mov_b32 v42, v34
    v_mov_b32 v43, v35
    v_mov_b32 v44, v36
    v_mov_b32 v45, v37
    v_mov_b32 v46, v38
    v_mov_b32 v47, v39
    v_permlane32_swap_b32 v32, v40
    v_permlane32_swap_b32 v33, v41
    v_permlane32_swap_b32 v34, v42
    v_permlane32_swap_b32 v35, v43
    v_permlane32_swap_b32 v36, v44
    v_permlane32_swap_b32 v37, v45
    v_permlane32_swap_b32 v38, v46
    v_permlane32_swap_b32 v39, v47
    v_pk_add_f32 v[32:33], v[32:33], v[40:41]
    v_pk_add_f32 v[34:35], v[34:35], v[42:43]
    v_pk_add_f32 v[36:37], v[36:37], v[44:45]
    v_pk_add_f32 v[38:39], v[38:39], v[46:47]
    v_cvt_pk_bf16_f32 v32, v32, v32
    v_cvt_pk_bf16_f32 v33, v33, v33
    v_cvt_pk_bf16_f32 v34, v34, v34
    v_cvt_pk_bf16_f32 v35, v35, v35
    v_cvt_pk_bf16_f32 v36, v36, v36
    v_cvt_pk_bf16_f32 v37, v37, v37
    v_cvt_pk_bf16_f32 v38, v38, v38
    v_cvt_pk_bf16_f32 v39, v39, v39
    v_lshlrev_b32 v32, 16, v32
    v_lshlrev_b32 v33, 16, v33
    v_lshlrev_b32 v34, 16, v34
    v_lshlrev_b32 v35, 16, v35
    v_lshlrev_b32 v36, 16, v36
    v_lshlrev_b32 v37, 16, v37
    v_lshlrev_b32 v38, 16, v38
    v_lshlrev_b32 v39, 16, v39
    v_mul_f32 v40, 0xbfb8aa3b, v32
    v_mul_f32 v41, 0xbfb8aa3b, v33
    v_mul_f32 v42, 0xbfb8aa3b, v34
    v_mul_f32 v43, 0xbfb8aa3b, v35
    v_exp_f32 v40, v40
    v_exp_f32 v41, v41
    v_exp_f32 v42, v42
    v_exp_f32 v43, v43
    v_add_f32 v40, 1.0, v40
    v_add_f32 v41, 1.0, v41
    v_add_f32 v42, 1.0, v42
    v_add_f32 v43, 1.0, v43
    v_rcp_f32 v40, v40
    v_rcp_f32 v41, v41
    v_rcp_f32 v42, v42
    v_rcp_f32 v43, v43
    v_mul_f32 v32, v32, v40
    v_mul_f32 v33, v33, v41
    v_mul_f32 v34, v34, v42
    v_mul_f32 v35, v35, v43
    v_cvt_pk_bf16_f32 v32, v32, v32
    v_cvt_pk_bf16_f32 v33, v33, v33
    v_cvt_pk_bf16_f32 v34, v34, v34
    v_cvt_pk_bf16_f32 v35, v35, v35
    v_lshlrev_b32 v32, 16, v32
    v_lshlrev_b32 v33, 16, v33
    v_lshlrev_b32 v34, 16, v34
    v_lshlrev_b32 v35, 16, v35
    v_mul_f32 v32, v32, v36
    v_mul_f32 v33, v33, v37
    v_mul_f32 v34, v34, v38
    v_mul_f32 v35, v35, v39
    v_cvt_pk_bf16_f32 v32, v32, v32
    v_cvt_pk_bf16_f32 v33, v33, v33
    v_cvt_pk_bf16_f32 v34, v34, v34
    v_cvt_pk_bf16_f32 v35, v35, v35
    v_add_u32 v2, 133632, v120
    s_mov_b64 exec, 15
    ds_write_b128 v2, v[32:35]
    s_mov_b64 exec, 1
    s_waitcnt lgkmcnt(0)
    ds_write_b32 v122, v124 offset:68
    s_mov_b64 exec, -1
L_nh96:
    s_mov_b32 s57, 0
L_sl103:
    ds_read_b32 v56, v122 offset:52
    s_waitcnt lgkmcnt(0)
    v_cmp_ne_u32 vcc, 0x1010101, v56
    s_add_u32 s57, s57, 1
    s_nop 0
    s_cbranch_vccz L_sld104
    s_sleep 1
    s_cmp_lt_u32 s57, 262144
    s_cbranch_scc1 L_sl103
L_sld104:
    s_add_u32 s82, s48, 0
    s_and_b32 s82, s82, 31
    s_lshl_b32 s82, s82, 16
    s_add_u32 s82, s82, s81
    s_add_u32 m0, s80, 65536
    s_nop 0
    buffer_load_dwordx4 v126, s[92:95], s82 offen lds
    s_add_u32 s82, s48, 1
    s_and_b32 s82, s82, 31
    s_lshl_b32 s82, s82, 16
    s_add_u32 s82, s82, s81
    s_add_u32 m0, s80, 69632
    s_nop 0
    buffer_load_dwordx4 v126, s[92:95], s82 offen lds
    s_add_u32 s82, s48, 2
    s_and_b32 s82, s82, 31
    s_lshl_b32 s82, s82, 16
    s_add_u32 s82, s82, s81
    s_add_u32 m0, s80, 73728
    s_nop 0
    buffer_load_dwordx4 v126, s[92:95], s82 offen lds
    s_add_u32 s82, s48, 3
    s_and_b32 s82, s82, 31
    s_lshl_b32 s82, s82, 16
    s_add_u32 s82, s82, s81
    s_add_u32 m0, s80, 77824
    s_nop 0
    buffer_load_dwordx4 v126, s[92:95], s82 offen lds
    s_add_u32 s82, s48, 4
    s_and_b32 s82, s82, 31
    s_lshl_b32 s82, s82, 16
    s_add_u32 s82, s82, s81
    s_add_u32 m0, s80, 81920
    s_nop 0
    buffer_load_dwordx4 v126, s[92:95], s82 offen lds
    s_add_u32 s82, s48, 5
    s_and_b32 s82, s82, 31
    s_lshl_b32 s82, s82, 16
    s_add_u32 s82, s82, s81
    s_add_u32 m0, s80, 86016
    s_nop 0
    buffer_load_dwordx4 v126, s[92:95], s82 offen lds
    s_add_u32 s82, s48, 6
    s_and_b32 s82, s82, 31
    s_lshl_b32 s82, s82, 16
    s_add_u32 s82, s82, s81
    s_add_u32 m0, s80, 90112
    s_nop 0
    buffer_load_dwordx4 v126, s[92:95], s82 offen lds
    s_add_u32 s82, s48, 7
    s_and_b32 s82, s82, 31
    s_lshl_b32 s82, s82, 16
    s_add_u32 s82, s82, s81
    s_add_u32 m0, s80, 94208
    s_nop 0
    buffer_load_dwordx4 v126, s[92:95], s82 offen lds
    s_add_u32 s82, s48, 8
    s_and_b32 s82, s82, 31
    s_lshl_b32 s82, s82, 16
    s_add_u32 s82, s82, s81
    s_add_u32 m0, s80, 98304
    s_nop 0
    buffer_load_dwordx4 v126, s[92:95], s82 offen lds
    s_add_u32 s82, s48, 9
    s_and_b32 s82, s82, 31
    s_lshl_b32 s82, s82, 16
    s_add_u32 s82, s82, s81
    s_add_u32 m0, s80, 102400
    s_nop 0
    buffer_load_dwordx4 v126, s[92:95], s82 offen lds
    s_add_u32 s82, s48, 10
    s_and_b32 s82, s82, 31
    s_lshl_b32 s82, s82, 16
    s_add_u32 s82, s82, s81
    s_add_u32 m0, s80, 106496
    s_nop 0
    buffer_load_dwordx4 v126, s[92:95], s82 offen lds
    s_add_u32 s82, s48, 11
    s_and_b32 s82, s82, 31
    s_lshl_b32 s82, s82, 16
    s_add_u32 s82, s82, s81
    s_add_u32 m0, s80, 110592
    s_nop 0
    buffer_load_dwordx4 v126, s[92:95], s82 offen lds
    s_add_u32 s82, s48, 12
    s_and_b32 s82, s82, 31
    s_lshl_b32 s82, s82, 16
    s_add_u32 s82, s82, s81
    s_add_u32 m0, s80, 114688
    s_nop 0
    buffer_load_dwordx4 v126, s[92:95], s82 offen lds
    s_add_u32 s82, s48, 13
    s_and_b32 s82, s82, 31
    s_lshl_b32 s82, s82, 16
    s_add_u32 s82, s82, s81
    s_add_u32 m0, s80, 118784
    s_nop 0
    buffer_load_dwordx4 v126, s[92:95], s82 offen lds
    s_add_u32 s82, s48, 14
    s_and_b32 s82, s82, 31
    s_lshl_b32 s82, s82, 16
    s_add_u32 s82, s82, s81
    s_add_u32 m0, s80, 122880
    s_nop 0
    buffer_load_dwordx4 v126, s[92:95], s82 offen lds
    s_add_u32 s82, s48, 15
    s_and_b32 s82, s82, 31
    s_lshl_b32 s82, s82, 16
    s_add_u32 s82, s82, s81
    s_add_u32 m0, s80, 126976
    s_nop 0
    buffer_load_dwordx4 v126, s[92:95], s82 offen lds
    ds_read_b64 v[16:17], v119 offset:0
    ds_read_b64 v[18:19], v119 offset:64
    ds_read_b64 v[20:21], v119 offset:128
    ds_read_b64 v[22:23], v119 offset:192
    s_waitcnt vmcnt(16) lgkmcnt(0)
    v_mov_b32 v26, v17
    v_mov_b32 v30, v19
    v_mov_b32 v34, v21
    v_mov_b32 v38, v23
    v_lshlrev_b32 v128, 16, v96
    v_lshlrev_b32 v136, 16, v100
    v_lshlrev_b32 v144, 16, v104
    v_lshlrev_b32 v152, 16, v108
    v_and_b32 v129, 0xffff0000, v96
    v_and_b32 v137, 0xffff0000, v100
    v_and_b32 v145, 0xffff0000, v104
    v_and_b32 v153, 0xffff0000, v108
    v_pk_add_f32 v[24:25], v[128:129], v[16:17] op_sel_hi:[1,0] neg_lo:[0,1] neg_hi:[0,1]
    v_pk_add_f32 v[28:29], v[136:137], v[18:19] op_sel_hi:[1,0] neg_lo:[0,1] neg_hi:[0,1]
    v_pk_add_f32 v[32:33], v[144:145], v[20:21] op_sel_hi:[1,0] neg_lo:[0,1] neg_hi:[0,1]
    v_pk_add_f32 v[36:37], v[152:153], v[22:23] op_sel_hi:[1,0] neg_lo:[0,1] neg_hi:[0,1]
    v_cvt_pk_bf16_f32 v25, v24, v25
    v_cvt_pk_bf16_f32 v29, v28, v29
    v_cvt_pk_bf16_f32 v33, v32, v33
    v_cvt_pk_bf16_f32 v37, v36, v37
    v_lshlrev_b32 v24, 16, v25
    v_lshlrev_b32 v28, 16, v29
    v_lshlrev_b32 v32, 16, v33
    v_lshlrev_b32 v36, 16, v37
    v_and_b32 v25, 0xffff0000, v25
    v_and_b32 v29, 0xffff0000, v29
    v_and_b32 v33, 0xffff0000, v33
    v_and_b32 v37, 0xffff0000, v37
    v_pk_mul_f32 v[24:25], v[24:25], v[26:27] op_sel_hi:[1,0]
    v_pk_mul_f32 v[28:29], v[28:29], v[30:31] op_sel_hi:[1,0]
    v_pk_mul_f32 v[32:33], v[32:33], v[34:35] op_sel_hi:[1,0]
    v_pk_mul_f32 v[36:37], v[36:37], v[38:39] op_sel_hi:[1,0]
    v_cvt_pk_bf16_f32 v25, v24, v25
    v_cvt_pk_bf16_f32 v29, v28, v29
    v_cvt_pk_bf16_f32 v33, v32, v33
    v_cvt_pk_bf16_f32 v37, v36, v37
    v_lshlrev_b32 v24, 16, v25
    v_lshlrev_b32 v28, 16, v29
    v_lshlrev_b32 v32, 16, v33
    v_lshlrev_b32 v36, 16, v37
    v_and_b32 v25, 0xffff0000, v25
    v_and_b32 v29, 0xffff0000, v29
    v_and_b32 v33, 0xffff0000, v33
    v_and_b32 v37, 0xffff0000, v37
    v_pk_add_f32 v[128:129], v[128:129], v[24:25]
    v_pk_add_f32 v[136:137], v[136:137], v[28:29]
    v_pk_add_f32 v[144:145], v[144:145], v[32:33]
    v_pk_add_f32 v[152:153], v[152:153], v[36:37]
    v_lshlrev_b32 v130, 16, v97
    v_lshlrev_b32 v138, 16, v101
    v_lshlrev_b32 v146, 16, v105
    v_lshlrev_b32 v154, 16, v109
    v_and_b32 v131, 0xffff0000, v97
    v_and_b32 v139, 0xffff0000, v101
    v_and_b32 v147, 0xffff0000, v105
    v_and_b32 v155, 0xffff0000, v109
    v_pk_add_f32 v[24:25], v[130:131], v[16:17] op_sel_hi:[1,0] neg_lo:[0,1] neg_hi:[0,1]
    v_pk_add_f32 v[28:29], v[138:139], v[18:19] op_sel_hi:[1,0] neg_lo:[0,1] neg_hi:[0,1]
    v_pk_add_f32 v[32:33], v[146:147], v[20:21] op_sel_hi:[1,0] neg_lo:[0,1] neg_hi:[0,1]
    v_pk_add_f32 v[36:37], v[154:155], v[22:23] op_sel_hi:[1,0] neg_lo:[0,1] neg_hi:[0,1]
    v_cvt_pk_bf16_f32 v25, v24, v25
    v_cvt_pk_bf16_f32 v29, v28, v29
    v_cvt_pk_bf16_f32 v33, v32, v33
    v_cvt_pk_bf16_f32 v37, v36, v37
    v_lshlrev_b32 v24, 16, v25
    v_lshlrev_b32 v28, 16, v29
    v_lshlrev_b32 v32, 16, v33
    v_lshlrev_b32 v36, 16, v37
    v_and_b32 v25, 0xffff0000, v25
    v_and_b32 v29, 0xffff0000, v29
    v_and_b32 v33, 0xffff0000, v33
    v_and_b32 v37, 0xffff0000, v37
    v_pk_mul_f32 v[24:25], v[24:25], v[26:27] op_sel_hi:[1,0]
    v_pk_mul_f32 v[28:29], v[28:29], v[30:31] op_sel_hi:[1,0]
    v_pk_mul_f32 v[32:33], v[32:33], v[34:35] op_sel_hi:[1,0]
    v_pk_mul_f32 v[36:37], v[36:37], v[38:39] op_sel_hi:[1,0]
    v_cvt_pk_bf16_f32 v25, v24, v25
    v_cvt_pk_bf16_f32 v29, v28, v29
    v_cvt_pk_bf16_f32 v33, v32, v33
    v_cvt_pk_bf16_f32 v37, v36, v37
    v_lshlrev_b32 v24, 16, v25
    v_lshlrev_b32 v28, 16, v29
    v_lshlrev_b32 v32, 16, v33
    v_lshlrev_b32 v36, 16, v37
    v_and_b32 v25, 0xffff0000, v25
    v_and_b32 v29, 0xffff0000, v29
    v_and_b32 v33, 0xffff0000, v33
    v_and_b32 v37, 0xffff0000, v37
    v_pk_add_f32 v[130:131], v[130:131], v[24:25]
    v_pk_add_f32 v[138:139], v[138:139], v[28:29]
    v_pk_add_f32 v[146:147], v[146:147], v[32:33]
    v_pk_add_f32 v[154:155], v[154:155], v[36:37]
    v_lshlrev_b32 v132, 16, v98
    v_lshlrev_b32 v140, 16, v102
    v_lshlrev_b32 v148, 16, v106
    v_lshlrev_b32 v156, 16, v110
    v_and_b32 v133, 0xffff0000, v98
    v_and_b32 v141, 0xffff0000, v102
    v_and_b32 v149, 0xffff0000, v106
    v_and_b32 v157, 0xffff0000, v110
    v_pk_add_f32 v[24:25], v[132:133], v[16:17] op_sel_hi:[1,0] neg_lo:[0,1] neg_hi:[0,1]
    v_pk_add_f32 v[28:29], v[140:141], v[18:19] op_sel_hi:[1,0] neg_lo:[0,1] neg_hi:[0,1]
    v_pk_add_f32 v[32:33], v[148:149], v[20:21] op_sel_hi:[1,0] neg_lo:[0,1] neg_hi:[0,1]
    v_pk_add_f32 v[36:37], v[156:157], v[22:23] op_sel_hi:[1,0] neg_lo:[0,1] neg_hi:[0,1]
    v_cvt_pk_bf16_f32 v25, v24, v25
    v_cvt_pk_bf16_f32 v29, v28, v29
    v_cvt_pk_bf16_f32 v33, v32, v33
    v_cvt_pk_bf16_f32 v37, v36, v37
    v_lshlrev_b32 v24, 16, v25
    v_lshlrev_b32 v28, 16, v29
    v_lshlrev_b32 v32, 16, v33
    v_lshlrev_b32 v36, 16, v37
    v_and_b32 v25, 0xffff0000, v25
    v_and_b32 v29, 0xffff0000, v29
    v_and_b32 v33, 0xffff0000, v33
    v_and_b32 v37, 0xffff0000, v37
    v_pk_mul_f32 v[24:25], v[24:25], v[26:27] op_sel_hi:[1,0]
    v_pk_mul_f32 v[28:29], v[28:29], v[30:31] op_sel_hi:[1,0]
    v_pk_mul_f32 v[32:33], v[32:33], v[34:35] op_sel_hi:[1,0]
    v_pk_mul_f32 v[36:37], v[36:37], v[38:39] op_sel_hi:[1,0]
    v_cvt_pk_bf16_f32 v25, v24, v25
    v_cvt_pk_bf16_f32 v29, v28, v29
    v_cvt_pk_bf16_f32 v33, v32, v33
    v_cvt_pk_bf16_f32 v37, v36, v37
    v_lshlrev_b32 v24, 16, v25
    v_lshlrev_b32 v28, 16, v29
    v_lshlrev_b32 v32, 16, v33
    v_lshlrev_b32 v36, 16, v37
    v_and_b32 v25, 0xffff0000, v25
    v_and_b32 v29, 0xffff0000, v29
    v_and_b32 v33, 0xffff0000, v33
    v_and_b32 v37, 0xffff0000, v37
    v_pk_add_f32 v[132:133], v[132:133], v[24:25]
    v_pk_add_f32 v[140:141], v[140:141], v[28:29]
    v_pk_add_f32 v[148:149], v[148:149], v[32:33]
    v_pk_add_f32 v[156:157], v[156:157], v[36:37]
    v_lshlrev_b32 v134, 16, v99
    v_lshlrev_b32 v142, 16, v103
    v_lshlrev_b32 v150, 16, v107
    v_lshlrev_b32 v158, 16, v111
    v_and_b32 v135, 0xffff0000, v99
    v_and_b32 v143, 0xffff0000, v103
    v_and_b32 v151, 0xffff0000, v107
    v_and_b32 v159, 0xffff0000, v111
    v_pk_add_f32 v[24:25], v[134:135], v[16:17] op_sel_hi:[1,0] neg_lo:[0,1] neg_hi:[0,1]
    v_pk_add_f32 v[28:29], v[142:143], v[18:19] op_sel_hi:[1,0] neg_lo:[0,1] neg_hi:[0,1]
    v_pk_add_f32 v[32:33], v[150:151], v[20:21] op_sel_hi:[1,0] neg_lo:[0,1] neg_hi:[0,1]
    v_pk_add_f32 v[36:37], v[158:159], v[22:23] op_sel_hi:[1,0] neg_lo:[0,1] neg_hi:[0,1]
    v_cvt_pk_bf16_f32 v25, v24, v25
    v_cvt_pk_bf16_f32 v29, v28, v29
    v_cvt_pk_bf16_f32 v33, v32, v33
    v_cvt_pk_bf16_f32 v37, v36, v37
    v_lshlrev_b32 v24, 16, v25
    v_lshlrev_b32 v28, 16, v29
    v_lshlrev_b32 v32, 16, v33
    v_lshlrev_b32 v36, 16, v37
    v_and_b32 v25, 0xffff0000, v25
    v_and_b32 v29, 0xffff0000, v29
    v_and_b32 v33, 0xffff0000, v33
    v_and_b32 v37, 0xffff0000, v37
    v_pk_mul_f32 v[24:25], v[24:25], v[26:27] op_sel_hi:[1,0]
    v_pk_mul_f32 v[28:29], v[28:29], v[30:31] op_sel_hi:[1,0]
    v_pk_mul_f32 v[32:33], v[32:33], v[34:35] op_sel_hi:[1,0]
    v_pk_mul_f32 v[36:37], v[36:37], v[38:39] op_sel_hi:[1,0]
    v_cvt_pk_bf16_f32 v25, v24, v25
    v_cvt_pk_bf16_f32 v29, v28, v29
    v_cvt_pk_bf16_f32 v33, v32, v33
    v_cvt_pk_bf16_f32 v37, v36, v37
    v_lshlrev_b32 v24, 16, v25
    v_lshlrev_b32 v28, 16, v29
    v_lshlrev_b32 v32, 16, v33
    v_lshlrev_b32 v36, 16, v37
    v_and_b32 v25, 0xffff0000, v25
    v_and_b32 v29, 0xffff0000, v29
    v_and_b32 v33, 0xffff0000, v33
    v_and_b32 v37, 0xffff0000, v37
    v_pk_add_f32 v[134:135], v[134:135], v[24:25]
    v_pk_add_f32 v[142:143], v[142:143], v[28:29]
    v_pk_add_f32 v[150:151], v[150:151], v[32:33]
    v_pk_add_f32 v[158:159], v[158:159], v[36:37]
    s_waitcnt vmcnt(0)
    s_mov_b64 exec, 1
    ds_write_b8 v123, v124 offset:4
    s_mov_b64 exec, -1
    s_mov_b32 s57, 0
L_sl105:
    ds_read_b32 v7, v122 offset:160
    s_waitcnt lgkmcnt(0)
    v_cmp_ne_u32 vcc, 0x1010101, v7
    s_add_u32 s57, s57, 1
    s_nop 0
    s_cbranch_vccz L_sld106
    s_sleep 1
    s_cmp_lt_u32 s57, 262144
    s_cbranch_scc1 L_sl105
L_sld106:
    s_add_u32 s82, s48, 16
    s_and_b32 s82, s82, 31
    s_lshl_b32 s82, s82, 16
    s_add_u32 s82, s82, s81
    s_add_u32 m0, s80, 0
    s_nop 0
    buffer_load_dwordx4 v126, s[92:95], s82 offen lds
    s_add_u32 s82, s48, 17
    s_and_b32 s82, s82, 31
    s_lshl_b32 s82, s82, 16
    s_add_u32 s82, s82, s81
    s_add_u32 m0, s80, 4096
    s_nop 0
    buffer_load_dwordx4 v126, s[92:95], s82 offen lds
    s_add_u32 s82, s48, 18
    s_and_b32 s82, s82, 31
    s_lshl_b32 s82, s82, 16
    s_add_u32 s82, s82, s81
    s_add_u32 m0, s80, 8192
    s_nop 0
    buffer_load_dwordx4 v126, s[92:95], s82 offen lds
    s_add_u32 s82, s48, 19
    s_and_b32 s82, s82, 31
    s_lshl_b32 s82, s82, 16
    s_add_u32 s82, s82, s81
    s_add_u32 m0, s80, 12288
    s_nop 0
    buffer_load_dwordx4 v126, s[92:95], s82 offen lds
    s_add_u32 s82, s48, 20
    s_and_b32 s82, s82, 31
    s_lshl_b32 s82, s82, 16
    s_add_u32 s82, s82, s81
    s_add_u32 m0, s80, 16384
    s_nop 0
    buffer_load_dwordx4 v126, s[92:95], s82 offen lds
    s_add_u32 s82, s48, 21
    s_and_b32 s82, s82, 31
    s_lshl_b32 s82, s82, 16
    s_add_u32 s82, s82, s81
    s_add_u32 m0, s80, 20480
    s_nop 0
    buffer_load_dwordx4 v126, s[92:95], s82 offen lds
    s_add_u32 s82, s48, 22
    s_and_b32 s82, s82, 31
    s_lshl_b32 s82, s82, 16
    s_add_u32 s82, s82, s81
    s_add_u32 m0, s80, 24576
    s_nop 0
    buffer_load_dwordx4 v126, s[92:95], s82 offen lds
    s_add_u32 s82, s48, 23
    s_and_b32 s82, s82, 31
    s_lshl_b32 s82, s82, 16
    s_add_u32 s82, s82, s81
    s_add_u32 m0, s80, 28672
    s_nop 0
    buffer_load_dwordx4 v126, s[92:95], s82 offen lds
    s_add_u32 s82, s48, 24
    s_and_b32 s82, s82, 31
    s_lshl_b32 s82, s82, 16
    s_add_u32 s82, s82, s81
    s_add_u32 m0, s80, 32768
    s_nop 0
    buffer_load_dwordx4 v126, s[92:95], s82 offen lds
    s_add_u32 s82, s48, 25
    s_and_b32 s82, s82, 31
    s_lshl_b32 s82, s82, 16
    s_add_u32 s82, s82, s81
    s_add_u32 m0, s80, 36864
    s_nop 0
    buffer_load_dwordx4 v126, s[92:95], s82 offen lds
    s_add_u32 s82, s48, 26
    s_and_b32 s82, s82, 31
    s_lshl_b32 s82, s82, 16
    s_add_u32 s82, s82, s81
    s_add_u32 m0, s80, 40960
    s_nop 0
    buffer_load_dwordx4 v126, s[92:95], s82 offen lds
    s_add_u32 s82, s48, 27
    s_and_b32 s82, s82, 31
    s_lshl_b32 s82, s82, 16
    s_add_u32 s82, s82, s81
    s_add_u32 m0, s80, 45056
    s_nop 0
    buffer_load_dwordx4 v126, s[92:95], s82 offen lds
    s_add_u32 s82, s48, 28
    s_and_b32 s82, s82, 31
    s_lshl_b32 s82, s82, 16
    s_add_u32 s82, s82, s81
    s_add_u32 m0, s80, 49152
    s_nop 0
    buffer_load_dwordx4 v126, s[92:95], s82 offen lds
    s_add_u32 s82, s48, 29
    s_and_b32 s82, s82, 31
    s_lshl_b32 s82, s82, 16
    s_add_u32 s82, s82, s81
    s_add_u32 m0, s80, 53248
    s_nop 0
    buffer_load_dwordx4 v126, s[92:95], s82 offen lds
    s_add_u32 s82, s48, 30
    s_and_b32 s82, s82, 31
    s_lshl_b32 s82, s82, 16
    s_add_u32 s82, s82, s81
    s_add_u32 m0, s80, 57344
    s_nop 0
    buffer_load_dwordx4 v126, s[92:95], s82 offen lds
    s_add_u32 s82, s48, 31
    s_and_b32 s82, s82, 31
    s_lshl_b32 s82, s82, 16
    s_add_u32 s82, s82, s81
    s_add_u32 m0, s80, 61440
    s_nop 0
    buffer_load_dwordx4 v126, s[92:95], s82 offen lds
    v_lshl_add_u32 v114, v13, 9, v10
    v_xor_b32 v115, 32, v114
    v_add_u32 v112, 0x10000, v114
    v_add_u32 v113, 0x10000, v115
    v_add_u32 v116, 32768, v120
    s_lshl_b32 s47, s28, 3
    s_lshl_b32 s58, s27, 1
    s_add_u32 s47, s47, s58
    s_lshl_b32 s47, s47, 15
    v_lshlrev_b32 v117, 7, v12
    s_lshl_b32 s50, s28, 2
    s_add_u32 s50, s50, s27
    s_lshl_b32 s50, s50, 11
    s_add_u32 s50, s50, 8650752
    s_mov_b32 s57, 0
L_sl107:
    ds_read_b32 v4, v122 offset:4
    s_waitcnt lgkmcnt(0)
    v_cmp_ne_u32 vcc, 0x1010101, v4
    s_add_u32 s57, s57, 1
    s_nop 0
    s_cbranch_vccz L_sld108
    s_sleep 1
    s_cmp_lt_u32 s57, 262144
    s_cbranch_scc1 L_sl107
L_sld108:
    s_setprio 3
    s_sleep 8
    s_mov_b32 s57, 0
L_s3:
    buffer_load_dword v4, v117, s[16:19], s50 offen sc1
    s_waitcnt vmcnt(0)
    v_cmp_ne_u32 vcc, s60, v4
    s_add_u32 s57, s57, 1
    s_nop 0
    s_cbranch_vccz L_s3d
    s_sleep 4
    s_cmp_lt_u32 s57, 32768
    s_cbranch_scc1 L_s3
L_s3d:
    s_mov_b64 exec, 1
    ds_write_b8 v123, v124 offset:0
    s_mov_b64 exec, -1
    s_add_u32 s58, s48, 0
    s_and_b32 s58, s58, 31
    s_lshl_b32 s58, s58, 10
    s_add_u32 s51, s58, s47
    buffer_load_dwordx4 v[16:19], v120, s[16:19], s51 offen offset:0 sc1
    buffer_load_dwordx4 v[20:23], v116, s[16:19], s51 offen offset:0 sc1
    buffer_load_dwordx4 v[24:27], v120, s[16:19], s51 offen offset:1024 sc1
    buffer_load_dwordx4 v[28:31], v116, s[16:19], s51 offen offset:1024 sc1
    buffer_load_dwordx4 v[32:35], v120, s[16:19], s51 offen offset:2048 sc1
    buffer_load_dwordx4 v[36:39], v116, s[16:19], s51 offen offset:2048 sc1
    buffer_load_dwordx4 v[40:43], v120, s[16:19], s51 offen offset:3072 sc1
    buffer_load_dwordx4 v[44:47], v116, s[16:19], s51 offen offset:3072 sc1
    ds_read_b64_tr_b16 v[80:81], v112 offset:0
    ds_read_b64_tr_b16 v[82:83], v112 offset:2048
    ds_read_b64_tr_b16 v[84:85], v112 offset:4096
    ds_read_b64_tr_b16 v[86:87], v112 offset:6144
    ds_read_b64_tr_b16 v[88:89], v113 offset:0
    ds_read_b64_tr_b16 v[90:91], v113 offset:2048
    ds_read_b64_tr_b16 v[92:93], v113 offset:4096
    ds_read_b64_tr_b16 v[94:95], v113 offset:6144
    ds_read_b64_tr_b16 v[96:97], v112 offset:256
    ds_read_b64_tr_b16 v[98:99], v112 offset:2304
    ds_read_b64_tr_b16 v[100:101], v112 offset:4352
    ds_read_b64_tr_b16 v[102:103], v112 offset:6400
    s_waitcnt vmcnt(4)
    s_waitcnt lgkmcnt(8)
    v_mfma_f32_16x16x32_bf16 v[160:163], v[80:83], v[16:19], 0
    ds_read_b64_tr_b16 v[104:105], v113 offset:256
    v_mfma_f32_16x16x32_bf16 v[160:163], v[84:87], v[24:27], v[160:163]
    ds_read_b64_tr_b16 v[106:107], v113 offset:2304
    s_add_u32 s58, s48, 4
    s_and_b32 s58, s58, 31
    s_lshl_b32 s58, s58, 10
    s_add_u32 s51, s58, s47
    buffer_load_dwordx4 v[48:51], v120, s[16:19], s51 offen offset:0 sc1
    buffer_load_dwordx4 v[52:55], v116, s[16:19], s51 offen offset:0 sc1
    v_mfma_f32_16x16x32_bf16 v[176:179], v[84:87], v[28:31], 0
    ds_read_b64_tr_b16 v[108:109], v113 offset:4352
    v_mfma_f32_16x16x32_bf16 v[176:179], v[80:83], v[20:23], v[176:179]
    ds_read_b64_tr_b16 v[110:111], v113 offset:6400
    s_waitcnt lgkmcnt(8)
    v_mfma_f32_16x16x32_bf16 v[164:167], v[88:91], v[16:19], 0
    ds_read_b64_tr_b16 v[80:81], v112 offset:8192
    v_mfma_f32_16x16x32_bf16 v[164:167], v[92:95], v[24:27], v[164:167]
    ds_read_b64_tr_b16 v[82:83], v112 offset:10240
    buffer_load_dwordx4 v[56:59], v120, s[16:19], s51 offen offset:1024 sc1
    buffer_load_dwordx4 v[60:63], v116, s[16:19], s51 offen offset:1024 sc1
    v_mfma_f32_16x16x32_bf16 v[180:183], v[92:95], v[28:31], 0
    ds_read_b64_tr_b16 v[84:85], v112 offset:12288
    v_mfma_f32_16x16x32_bf16 v[180:183], v[88:91], v[20:23], v[180:183]
    ds_read_b64_tr_b16 v[86:87], v112 offset:14336
    s_waitcnt lgkmcnt(8)
    v_mfma_f32_16x16x32_bf16 v[168:171], v[96:99], v[16:19], 0
    ds_read_b64_tr_b16 v[88:89], v113 offset:8192
    v_mfma_f32_16x16x32_bf16 v[168:171], v[100:103], v[24:27], v[168:171]
    ds_read_b64_tr_b16 v[90:91], v113 offset:10240
    buffer_load_dwordx4 v[64:67], v120, s[16:19], s51 offen offset:2048 sc1
    v_mfma_f32_16x16x32_bf16 v[184:187], v[100:103], v[28:31], 0
    ds_read_b64_tr_b16 v[92:93], v113 offset:12288
    v_mfma_f32_16x16x32_bf16 v[184:187], v[96:99], v[20:23], v[184:187]
    ds_read_b64_tr_b16 v[94:95], v113 offset:14336
    s_waitcnt lgkmcnt(8)
    v_mfma_f32_16x16x32_bf16 v[172:175], v[104:107], v[16:19], 0
    ds_read_b64_tr_b16 v[96:97], v112 offset:8448
    v_mfma_f32_16x16x32_bf16 v[172:175], v[108:111], v[24:27], v[172:175]
    ds_read_b64_tr_b16 v[98:99], v112 offset:10496
    buffer_load_dwordx4 v[68:71], v116, s[16:19], s51 offen offset:2048 sc1
    v_mfma_f32_16x16x32_bf16 v[188:191], v[108:111], v[28:31], 0
    ds_read_b64_tr_b16 v[100:101], v112 offset:12544
    v_mfma_f32_16x16x32_bf16 v[188:191], v[104:107], v[20:23], v[188:191]
    ds_read_b64_tr_b16 v[102:103], v112 offset:14592
    s_waitcnt vmcnt(6)
    s_waitcnt lgkmcnt(8)
    v_mfma_f32_16x16x32_bf16 v[160:163], v[80:83], v[32:35], v[160:163]
    ds_read_b64_tr_b16 v[104:105], v113 offset:8448
    v_mfma_f32_16x16x32_bf16 v[160:163], v[84:87], v[40:43], v[160:163]
    ds_read_b64_tr_b16 v[106:107], v113 offset:10496
    buffer_load_dwordx4 v[72:75], v120, s[16:19], s51 offen offset:3072 sc1
    buffer_load_dwordx4 v[76:79], v116, s[16:19], s51 offen offset:3072 sc1
    v_mfma_f32_16x16x32_bf16 v[176:179], v[84:87], v[44:47], v[176:179]
    ds_read_b64_tr_b16 v[108:109], v113 offset:12544
    v_mfma_f32_16x16x32_bf16 v[176:179], v[80:83], v[36:39], v[176:179]
    ds_read_b64_tr_b16 v[110:111], v113 offset:14592
    s_waitcnt lgkmcnt(8)
    v_mfma_f32_16x16x32_bf16 v[164:167], v[88:91], v[32:35], v[164:167]
    ds_read_b64_tr_b16 v[80:81], v112 offset:16384
    v_mfma_f32_16x16x32_bf16 v[164:167], v[92:95], v[40:43], v[164:167]
    ds_read_b64_tr_b16 v[82:83], v112 offset:18432
    s_add_u32 s58, s48, 8
    s_and_b32 s58, s58, 31
    s_lshl_b32 s58, s58, 10
    s_add_u32 s51, s58, s47
    buffer_load_dwordx4 v[16:19], v120, s[16:19], s51 offen offset:0 sc1
    v_mfma_f32_16x16x32_bf16 v[180:183], v[92:95], v[44:47], v[180:183]
    ds_read_b64_tr_b16 v[84:85], v112 offset:20480
    v_mfma_f32_16x16x32_bf16 v[180:183], v[88:91], v[36:39], v[180:183]
    ds_read_b64_tr_b16 v[86:87], v112 offset:22528
    s_waitcnt lgkmcnt(8)
    v_mfma_f32_16x16x32_bf16 v[168:171], v[96:99], v[32:35], v[168:171]
    ds_read_b64_tr_b16 v[88:89], v113 offset:16384
    v_mfma_f32_16x16x32_bf16 v[168:171], v[100:103], v[40:43], v[168:171]
    ds_read_b64_tr_b16 v[90:91], v113 offset:18432
    buffer_load_dwordx4 v[20:23], v116, s[16:19], s51 offen offset:0 sc1
    v_mfma_f32_16x16x32_bf16 v[184:187], v[100:103], v[44:47], v[184:187]
    ds_read_b64_tr_b16 v[92:93], v113 offset:20480
    v_mfma_f32_16x16x32_bf16 v[184:187], v[96:99], v[36:39], v[184:187]
    ds_read_b64_tr_b16 v[94:95], v113 offset:22528
    s_waitcnt lgkmcnt(8)
    v_mfma_f32_16x16x32_bf16 v[172:175], v[104:107], v[32:35], v[172:175]
    ds_read_b64_tr_b16 v[96:97], v112 offset:16640
    v_mfma_f32_16x16x32_bf16 v[172:175], v[108:111], v[40:43], v[172:175]
    ds_read_b64_tr_b16 v[98:99], v112 offset:18688
    buffer_load_dwordx4 v[24:27], v120, s[16:19], s51 offen offset:1024 sc1
    v_mfma_f32_16x16x32_bf16 v[188:191], v[108:111], v[44:47], v[188:191]
    ds_read_b64_tr_b16 v[100:101], v112 offset:20736
    v_mfma_f32_16x16x32_bf16 v[188:191], v[104:107], v[36:39], v[188:191]
    ds_read_b64_tr_b16 v[102:103], v112 offset:22784
    s_waitcnt vmcnt(7)
    s_waitcnt lgkmcnt(8)
    v_mfma_f32_16x16x32_bf16 v[160:163], v[80:83], v[48:51], v[160:163]
    ds_read_b64_tr_b16 v[104:105], v113 offset:16640
    v_mfma_f32_16x16x32_bf16 v[160:163], v[84:87], v[56:59], v[160:163]
    ds_read_b64_tr_b16 v[106:107], v113 offset:18688
    buffer_load_dwordx4 v[28:31], v116, s[16:19], s51 offen offset:1024 sc1
    buffer_load_dwordx4 v[32:35], v120, s[16:19], s51 offen offset:2048 sc1
    v_mfma_f32_16x16x32_bf16 v[176:179], v[84:87], v[60:63], v[176:179]
    ds_read_b64_tr_b16 v[108:109], v113 offset:20736
    v_mfma_f32_16x16x32_bf16 v[176:179], v[80:83], v[52:55], v[176:179]
    ds_read_b64_tr_b16 v[110:111], v113 offset:22784
    s_waitcnt lgkmcnt(8)
    v_mfma_f32_16x16x32_bf16 v[164:167], v[88:91], v[48:51], v[164:167]
    ds_read_b64_tr_b16 v[80:81], v112 offset:24576
    v_mfma_f32_16x16x32_bf16 v[164:167], v[92:95], v[56:59], v[164:167]
    ds_read_b64_tr_b16 v[82:83], v112 offset:26624
    buffer_load_dwordx4 v[36:39], v116, s[16:19], s51 offen offset:2048 sc1
    v_mfma_f32_16x16x32_bf16 v[180:183], v[92:95], v[60:63], v[180:183]
    ds_read_b64_tr_b16 v[84:85], v112 offset:28672
    v_mfma_f32_16x16x32_bf16 v[180:183], v[88:91], v[52:55], v[180:183]
    ds_read_b64_tr_b16 v[86:87], v112 offset:30720
    s_waitcnt lgkmcnt(8)
    v_mfma_f32_16x16x32_bf16 v[168:171], v[96:99], v[48:51], v[168:171]
    ds_read_b64_tr_b16 v[88:89], v113 offset:24576
    v_mfma_f32_16x16x32_bf16 v[168:171], v[100:103], v[56:59], v[168:171]
    ds_read_b64_tr_b16 v[90:91], v113 offset:26624
    buffer_load_dwordx4 v[40:43], v120, s[16:19], s51 offen offset:3072 sc1
    v_mfma_f32_16x16x32_bf16 v[184:187], v[100:103], v[60:63], v[184:187]
    ds_read_b64_tr_b16 v[92:93], v113 offset:28672
    v_mfma_f32_16x16x32_bf16 v[184:187], v[96:99], v[52:55], v[184:187]
    ds_read_b64_tr_b16 v[94:95], v113 offset:30720
    s_waitcnt lgkmcnt(8)
    v_mfma_f32_16x16x32_bf16 v[172:175], v[104:107], v[48:51], v[172:175]
    ds_read_b64_tr_b16 v[96:97], v112 offset:24832
    v_mfma_f32_16x16x32_bf16 v[172:175], v[108:111], v[56:59], v[172:175]
    ds_read_b64_tr_b16 v[98:99], v112 offset:26880
    buffer_load_dwordx4 v[44:47], v116, s[16:19], s51 offen offset:3072 sc1
    v_mfma_f32_16x16x32_bf16 v[188:191], v[108:111], v[60:63], v[188:191]
    ds_read_b64_tr_b16 v[100:101], v112 offset:28928
    v_mfma_f32_16x16x32_bf16 v[188:191], v[104:107], v[52:55], v[188:191]
    ds_read_b64_tr_b16 v[102:103], v112 offset:30976
    s_waitcnt vmcnt(8)
    s_waitcnt lgkmcnt(8)
    v_mfma_f32_16x16x32_bf16 v[160:163], v[80:83], v[64:67], v[160:163]
    ds_read_b64_tr_b16 v[104:105], v113 offset:24832
    v_mfma_f32_16x16x32_bf16 v[160:163], v[84:87], v[72:75], v[160:163]
    ds_read_b64_tr_b16 v[106:107], v113 offset:26880
    s_add_u32 s58, s48, 12
    s_and_b32 s58, s58, 31
    s_lshl_b32 s58, s58, 10
    s_add_u32 s51, s58, s47
    buffer_load_dwordx4 v[48:51], v120, s[16:19], s51 offen offset:0 sc1
    v_mfma_f32_16x16x32_bf16 v[176:179], v[84:87], v[76:79], v[176:179]
    ds_read_b64_tr_b16 v[108:109], v113 offset:28928
    v_mfma_f32_16x16x32_bf16 v[176:179], v[80:83], v[68:71], v[176:179]
    ds_read_b64_tr_b16 v[110:111], v113 offset:30976
    s_mov_b64 exec, 1
    ds_write_b8 v123, v124 offset:24
    s_mov_b64 exec, -1
    s_waitcnt lgkmcnt(9)
    s_nop 0
    v_mfma_f32_16x16x32_bf16 v[164:167], v[88:91], v[64:67], v[164:167]
    ds_read_b64_tr_b16 v[80:81], v112 offset:32768
    v_mfma_f32_16x16x32_bf16 v[164:167], v[92:95], v[72:75], v[164:167]
    ds_read_b64_tr_b16 v[82:83], v112 offset:34816
    buffer_load_dwordx4 v[52:55], v116, s[16:19], s51 offen offset:0 sc1
    v_mfma_f32_16x16x32_bf16 v[180:183], v[92:95], v[76:79], v[180:183]
    ds_read_b64_tr_b16 v[84:85], v112 offset:36864
    v_mfma_f32_16x16x32_bf16 v[180:183], v[88:91], v[68:71], v[180:183]
    ds_read_b64_tr_b16 v[86:87], v112 offset:38912
    s_waitcnt lgkmcnt(9)
    v_mfma_f32_16x16x32_bf16 v[168:171], v[96:99], v[64:67], v[168:171]
    ds_read_b64_tr_b16 v[88:89], v113 offset:32768
    v_mfma_f32_16x16x32_bf16 v[168:171], v[100:103], v[72:75], v[168:171]
    ds_read_b64_tr_b16 v[90:91], v113 offset:34816
    buffer_load_dwordx4 v[56:59], v120, s[16:19], s51 offen offset:1024 sc1
    v_mfma_f32_16x16x32_bf16 v[184:187], v[100:103], v[76:79], v[184:187]
    ds_read_b64_tr_b16 v[92:93], v113 offset:36864
    v_mfma_f32_16x16x32_bf16 v[184:187], v[96:99], v[68:71], v[184:187]
    ds_read_b64_tr_b16 v[94:95], v113 offset:38912
    s_waitcnt lgkmcnt(9)
    v_mfma_f32_16x16x32_bf16 v[172:175], v[104:107], v[64:67], v[172:175]
    ds_read_b64_tr_b16 v[96:97], v112 offset:33024
    v_mfma_f32_16x16x32_bf16 v[172:175], v[108:111], v[72:75], v[172:175]
    ds_read_b64_tr_b16 v[98:99], v112 offset:35072
    buffer_load_dwordx4 v[60:63], v116, s[16:19], s51 offen offset:1024 sc1
    v_mfma_f32_16x16x32_bf16 v[188:191], v[108:111], v[76:79], v[188:191]
    ds_read_b64_tr_b16 v[100:101], v112 offset:37120
    v_mfma_f32_16x16x32_bf16 v[188:191], v[104:107], v[68:71], v[188:191]
    ds_read_b64_tr_b16 v[102:103], v112 offset:39168
    s_waitcnt vmcnt(8)
    s_waitcnt lgkmcnt(8)
    v_mfma_f32_16x16x32_bf16 v[160:163], v[80:83], v[16:19], v[160:163]
    ds_read_b64_tr_b16 v[104:105], v113 offset:33024
    v_mfma_f32_16x16x32_bf16 v[160:163], v[84:87], v[24:27], v[160:163]
    ds_read_b64_tr_b16 v[106:107], v113 offset:35072
    buffer_load_dwordx4 v[64:67], v120, s[16:19], s51 offen offset:2048 sc1
    v_mfma_f32_16x16x32_bf16 v[176:179], v[84:87], v[28:31], v[176:179]
    ds_read_b64_tr_b16 v[108:109], v113 offset:37120
    v_mfma_f32_16x16x32_bf16 v[176:179], v[80:83], v[20:23], v[176:179]
    ds_read_b64_tr_b16 v[110:111], v113 offset:39168
    s_waitcnt lgkmcnt(8)
    v_mfma_f32_16x16x32_bf16 v[164:167], v[88:91], v[16:19], v[164:167]
    ds_read_b64_tr_b16 v[80:81], v112 offset:40960
    v_mfma_f32_16x16x32_bf16 v[164:167], v[92:95], v[24:27], v[164:167]
    ds_read_b64_tr_b16 v[82:83], v112 offset:43008
    buffer_load_dwordx4 v[68:71], v116, s[16:19], s51 offen offset:2048 sc1
    v_mfma_f32_16x16x32_bf16 v[180:183], v[92:95], v[28:31], v[180:183]
    ds_read_b64_tr_b16 v[84:85], v112 offset:45056
    v_mfma_f32_16x16x32_bf16 v[180:183], v[88:91], v[20:23], v[180:183]
    ds_read_b64_tr_b16 v[86:87], v112 offset:47104
    s_waitcnt lgkmcnt(8)
    v_mfma_f32_16x16x32_bf16 v[168:171], v[96:99], v[16:19], v[168:171]
    ds_read_b64_tr_b16 v[88:89], v113 offset:40960
    v_mfma_f32_16x16x32_bf16 v[168:171], v[100:103], v[24:27], v[168:171]
    ds_read_b64_tr_b16 v[90:91], v113 offset:43008
    buffer_load_dwordx4 v[72:75], v120, s[16:19], s51 offen offset:3072 sc1
    v_mfma_f32_16x16x32_bf16 v[184:187], v[100:103], v[28:31], v[184:187]
    ds_read_b64_tr_b16 v[92:93], v113 offset:45056
    v_mfma_f32_16x16x32_bf16 v[184:187], v[96:99], v[20:23], v[184:187]
    ds_read_b64_tr_b16 v[94:95], v113 offset:47104
    s_waitcnt lgkmcnt(8)
    v_mfma_f32_16x16x32_bf16 v[172:175], v[104:107], v[16:19], v[172:175]
    ds_read_b64_tr_b16 v[96:97], v112 offset:41216
    v_mfma_f32_16x16x32_bf16 v[172:175], v[108:111], v[24:27], v[172:175]
    ds_read_b64_tr_b16 v[98:99], v112 offset:43264
    buffer_load_dwordx4 v[76:79], v116, s[16:19], s51 offen offset:3072 sc1
    v_mfma_f32_16x16x32_bf16 v[188:191], v[108:111], v[28:31], v[188:191]
    ds_read_b64_tr_b16 v[100:101], v112 offset:45312
    v_mfma_f32_16x16x32_bf16 v[188:191], v[104:107], v[20:23], v[188:191]
    ds_read_b64_tr_b16 v[102:103], v112 offset:47360
    s_waitcnt vmcnt(8)
    s_waitcnt lgkmcnt(8)
    v_mfma_f32_16x16x32_bf16 v[160:163], v[80:83], v[32:35], v[160:163]
    ds_read_b64_tr_b16 v[104:105], v113 offset:41216
    v_mfma_f32_16x16x32_bf16 v[160:163], v[84:87], v[40:43], v[160:163]
    ds_read_b64_tr_b16 v[106:107], v113 offset:43264
    s_add_u32 s58, s48, 16
    s_and_b32 s58, s58, 31
    s_lshl_b32 s58, s58, 10
    s_add_u32 s51, s58, s47
    buffer_load_dwordx4 v[16:19], v120, s[16:19], s51 offen offset:0 sc1
    v_mfma_f32_16x16x32_bf16 v[176:179], v[84:87], v[44:47], v[176:179]
    ds_read_b64_tr_b16 v[108:109], v113 offset:45312
    v_mfma_f32_16x16x32_bf16 v[176:179], v[80:83], v[36:39], v[176:179]
    ds_read_b64_tr_b16 v[110:111], v113 offset:47360
    s_waitcnt lgkmcnt(8)
    v_mfma_f32_16x16x32_bf16 v[164:167], v[88:91], v[32:35], v[164:167]
    ds_read_b64_tr_b16 v[80:81], v112 offset:49152
    v_mfma_f32_16x16x32_bf16 v[164:167], v[92:95], v[40:43], v[164:167]
    ds_read_b64_tr_b16 v[82:83], v112 offset:51200
    buffer_load_dwordx4 v[20:23], v116, s[16:19], s51 offen offset:0 sc1
    v_mfma_f32_16x16x32_bf16 v[180:183], v[92:95], v[44:47], v[180:183]
    ds_read_b64_tr_b16 v[84:85], v112 offset:53248
    v_mfma_f32_16x16x32_bf16 v[180:183], v[88:91], v[36:39], v[180:183]
    ds_read_b64_tr_b16 v[86:87], v112 offset:55296
    s_waitcnt lgkmcnt(8)
    v_mfma_f32_16x16x32_bf16 v[168:171], v[96:99], v[32:35], v[168:171]
    ds_read_b64_tr_b16 v[88:89], v113 offset:49152
    v_mfma_f32_16x16x32_bf16 v[168:171], v[100:103], v[40:43], v[168:171]
    ds_read_b64_tr_b16 v[90:91], v113 offset:51200
    buffer_load_dwordx4 v[24:27], v120, s[16:19], s51 offen offset:1024 sc1
    v_mfma_f32_16x16x32_bf16 v[184:187], v[100:103], v[44:47], v[184:187]
    ds_read_b64_tr_b16 v[92:93], v113 offset:53248
    v_mfma_f32_16x16x32_bf16 v[184:187], v[96:99], v[36:39], v[184:187]
    ds_read_b64_tr_b16 v[94:95], v113 offset:55296
    s_waitcnt lgkmcnt(8)
    v_mfma_f32_16x16x32_bf16 v[172:175], v[104:107], v[32:35], v[172:175]
    ds_read_b64_tr_b16 v[96:97], v112 offset:49408
    v_mfma_f32_16x16x32_bf16 v[172:175], v[108:111], v[40:43], v[172:175]
    ds_read_b64_tr_b16 v[98:99], v112 offset:51456
    buffer_load_dwordx4 v[28:31], v116, s[16:19], s51 offen offset:1024 sc1
    v_mfma_f32_16x16x32_bf16 v[188:191], v[108:111], v[44:47], v[188:191]
    ds_read_b64_tr_b16 v[100:101], v112 offset:53504
    v_mfma_f32_16x16x32_bf16 v[188:191], v[104:107], v[36:39], v[188:191]
    ds_read_b64_tr_b16 v[102:103], v112 offset:55552
    s_waitcnt vmcnt(8)
    s_waitcnt lgkmcnt(8)
    v_mfma_f32_16x16x32_bf16 v[160:163], v[80:83], v[48:51], v[160:163]
    ds_read_b64_tr_b16 v[104:105], v113 offset:49408
    v_mfma_f32_16x16x32_bf16 v[160:163], v[84:87], v[56:59], v[160:163]
    ds_read_b64_tr_b16 v[106:107], v113 offset:51456
    buffer_load_dwordx4 v[32:35], v120, s[16:19], s51 offen offset:2048 sc1
    v_mfma_f32_16x16x32_bf16 v[176:179], v[84:87], v[60:63], v[176:179]
    ds_read_b64_tr_b16 v[108:109], v113 offset:53504
    v_mfma_f32_16x16x32_bf16 v[176:179], v[80:83], v[52:55], v[176:179]
    ds_read_b64_tr_b16 v[110:111], v113 offset:55552
    s_waitcnt lgkmcnt(8)
    v_mfma_f32_16x16x32_bf16 v[164:167], v[88:91], v[48:51], v[164:167]
    ds_read_b64_tr_b16 v[80:81], v112 offset:57344
    v_mfma_f32_16x16x32_bf16 v[164:167], v[92:95], v[56:59], v[164:167]
    ds_read_b64_tr_b16 v[82:83], v112 offset:59392
    buffer_load_dwordx4 v[36:39], v116, s[16:19], s51 offen offset:2048 sc1
    v_mfma_f32_16x16x32_bf16 v[180:183], v[92:95], v[60:63], v[180:183]
    ds_read_b64_tr_b16 v[84:85], v112 offset:61440
    v_mfma_f32_16x16x32_bf16 v[180:183], v[88:91], v[52:55], v[180:183]
    ds_read_b64_tr_b16 v[86:87], v112 offset:63488
    s_waitcnt lgkmcnt(8)
    v_mfma_f32_16x16x32_bf16 v[168:171], v[96:99], v[48:51], v[168:171]
    ds_read_b64_tr_b16 v[88:89], v113 offset:57344
    v_mfma_f32_16x16x32_bf16 v[168:171], v[100:103], v[56:59], v[168:171]
    ds_read_b64_tr_b16 v[90:91], v113 offset:59392
    buffer_load_dwordx4 v[40:43], v120, s[16:19], s51 offen offset:3072 sc1
    v_mfma_f32_16x16x32_bf16 v[184:187], v[100:103], v[60:63], v[184:187]
    ds_read_b64_tr_b16 v[92:93], v113 offset:61440
    v_mfma_f32_16x16x32_bf16 v[184:187], v[96:99], v[52:55], v[184:187]
    ds_read_b64_tr_b16 v[94:95], v113 offset:63488
    s_waitcnt lgkmcnt(8)
    v_mfma_f32_16x16x32_bf16 v[172:175], v[104:107], v[48:51], v[172:175]
    ds_read_b64_tr_b16 v[96:97], v112 offset:57600
    v_mfma_f32_16x16x32_bf16 v[172:175], v[108:111], v[56:59], v[172:175]
    ds_read_b64_tr_b16 v[98:99], v112 offset:59648
    buffer_load_dwordx4 v[44:47], v116, s[16:19], s51 offen offset:3072 sc1
    v_mfma_f32_16x16x32_bf16 v[188:191], v[108:111], v[60:63], v[188:191]
    ds_read_b64_tr_b16 v[100:101], v112 offset:61696
    v_mfma_f32_16x16x32_bf16 v[188:191], v[104:107], v[52:55], v[188:191]
    ds_read_b64_tr_b16 v[102:103], v112 offset:63744
    ds_read_b32 v4, v122 offset:0
    s_waitcnt vmcnt(8)
    s_waitcnt lgkmcnt(9)
    v_mfma_f32_16x16x32_bf16 v[160:163], v[80:83], v[64:67], v[160:163]
    ds_read_b64_tr_b16 v[104:105], v113 offset:57600
    v_mfma_f32_16x16x32_bf16 v[160:163], v[84:87], v[72:75], v[160:163]
    ds_read_b64_tr_b16 v[106:107], v113 offset:59648
    s_add_u32 s58, s48, 20
    s_and_b32 s58, s58, 31
    s_lshl_b32 s58, s58, 10
    s_add_u32 s51, s58, s47
    buffer_load_dwordx4 v[48:51], v120, s[16:19], s51 offen offset:0 sc1
    v_mfma_f32_16x16x32_bf16 v[176:179], v[84:87], v[76:79], v[176:179]
    ds_read_b64_tr_b16 v[108:109], v113 offset:61696
    v_mfma_f32_16x16x32_bf16 v[176:179], v[80:83], v[68:71], v[176:179]
    ds_read_b64_tr_b16 v[110:111], v113 offset:63744
    s_waitcnt lgkmcnt(4)
    v_cmp_ne_u32 vcc, 0x1010101, v4
    s_nop 1
    s_cbranch_vccnz L_cs109
L_cb110:
    v_mfma_f32_16x16x32_bf16 v[164:167], v[88:91], v[64:67], v[164:167]
    ds_read_b64_tr_b16 v[80:81], v114 offset:0
    v_mfma_f32_16x16x32_bf16 v[164:167], v[92:95], v[72:75], v[164:167]
    ds_read_b64_tr_b16 v[82:83], v114 offset:2048
    buffer_load_dwordx4 v[52:55], v116, s[16:19], s51 offen offset:0 sc1
    v_mfma_f32_16x16x32_bf16 v[180:183], v[92:95], v[76:79], v[180:183]
    ds_read_b64_tr_b16 v[84:85], v114 offset:4096
    v_mfma_f32_16x16x32_bf16 v[180:183], v[88:91], v[68:71], v[180:183]
    ds_read_b64_tr_b16 v[86:87], v114 offset:6144
    v_mfma_f32_16x16x32_bf16 v[168:171], v[96:99], v[64:67], v[168:171]
    ds_read_b64_tr_b16 v[88:89], v115 offset:0
    v_mfma_f32_16x16x32_bf16 v[168:171], v[100:103], v[72:75], v[168:171]
    ds_read_b64_tr_b16 v[90:91], v115 offset:2048
    buffer_load_dwordx4 v[56:59], v120, s[16:19], s51 offen offset:1024 sc1
    v_mfma_f32_16x16x32_bf16 v[184:187], v[100:103], v[76:79], v[184:187]
    ds_read_b64_tr_b16 v[92:93], v115 offset:4096
    v_mfma_f32_16x16x32_bf16 v[184:187], v[96:99], v[68:71], v[184:187]
    ds_read_b64_tr_b16 v[94:95], v115 offset:6144
    s_waitcnt lgkmcnt(8)
    v_mfma_f32_16x16x32_bf16 v[172:175], v[104:107], v[64:67], v[172:175]
    ds_read_b64_tr_b16 v[96:97], v114 offset:256
    v_mfma_f32_16x16x32_bf16 v[172:175], v[108:111], v[72:75], v[172:175]
    ds_read_b64_tr_b16 v[98:99], v114 offset:2304
    buffer_load_dwordx4 v[60:63], v116, s[16:19], s51 offen offset:1024 sc1
    v_mfma_f32_16x16x32_bf16 v[188:191], v[108:111], v[76:79], v[188:191]
    ds_read_b64_tr_b16 v[100:101], v114 offset:4352
    v_mfma_f32_16x16x32_bf16 v[188:191], v[104:107], v[68:71], v[188:191]
    ds_read_b64_tr_b16 v[102:103], v114 offset:6400
    s_waitcnt vmcnt(8)
    s_waitcnt lgkmcnt(8)
    v_mfma_f32_16x16x32_bf16 v[160:163], v[80:83], v[16:19], v[160:163]
    ds_read_b64_tr_b16 v[104:105], v115 offset:256
    v_mfma_f32_16x16x32_bf16 v[160:163], v[84:87], v[24:27], v[160:163]
    ds_read_b64_tr_b16 v[106:107], v115 offset:2304
    buffer_load_dwordx4 v[64:67], v120, s[16:19], s51 offen offset:2048 sc1
    v_mfma_f32_16x16x32_bf16 v[176:179], v[84:87], v[28:31], v[176:179]
    ds_read_b64_tr_b16 v[108:109], v115 offset:4352
    v_mfma_f32_16x16x32_bf16 v[176:179], v[80:83], v[20:23], v[176:179]
    ds_read_b64_tr_b16 v[110:111], v115 offset:6400
    s_waitcnt lgkmcnt(8)
    v_mfma_f32_16x16x32_bf16 v[164:167], v[88:91], v[16:19], v[164:167]
    ds_read_b64_tr_b16 v[80:81], v114 offset:8192
    v_mfma_f32_16x16x32_bf16 v[164:167], v[92:95], v[24:27], v[164:167]
    ds_read_b64_tr_b16 v[82:83], v114 offset:10240
    buffer_load_dwordx4 v[68:71], v116, s[16:19], s51 offen offset:2048 sc1
    v_mfma_f32_16x16x32_bf16 v[180:183], v[92:95], v[28:31], v[180:183]
    ds_read_b64_tr_b16 v[84:85], v114 offset:12288
    v_mfma_f32_16x16x32_bf16 v[180:183], v[88:91], v[20:23], v[180:183]
    ds_read_b64_tr_b16 v[86:87], v114 offset:14336
    s_waitcnt lgkmcnt(8)
    v_mfma_f32_16x16x32_bf16 v[168:171], v[96:99], v[16:19], v[168:171]
    ds_read_b64_tr_b16 v[88:89], v115 offset:8192
    v_mfma_f32_16x16x32_bf16 v[168:171], v[100:103], v[24:27], v[168:171]
    ds_read_b64_tr_b16 v[90:91], v115 offset:10240
    buffer_load_dwordx4 v[72:75], v120, s[16:19], s51 offen offset:3072 sc1
    v_mfma_f32_16x16x32_bf16 v[184:187], v[100:103], v[28:31], v[184:187]
    ds_read_b64_tr_b16 v[92:93], v115 offset:12288
    v_mfma_f32_16x16x32_bf16 v[184:187], v[96:99], v[20:23], v[184:187]
    ds_read_b64_tr_b16 v[94:95], v115 offset:14336
    s_waitcnt lgkmcnt(8)
    v_mfma_f32_16x16x32_bf16 v[172:175], v[104:107], v[16:19], v[172:175]
    ds_read_b64_tr_b16 v[96:97], v114 offset:8448
    v_mfma_f32_16x16x32_bf16 v[172:175], v[108:111], v[24:27], v[172:175]
    ds_read_b64_tr_b16 v[98:99], v114 offset:10496
    buffer_load_dwordx4 v[76:79], v116, s[16:19], s51 offen offset:3072 sc1
    v_mfma_f32_16x16x32_bf16 v[188:191], v[108:111], v[28:31], v[188:191]
    ds_read_b64_tr_b16 v[100:101], v114 offset:12544
    v_mfma_f32_16x16x32_bf16 v[188:191], v[104:107], v[20:23], v[188:191]
    ds_read_b64_tr_b16 v[102:103], v114 offset:14592
    s_waitcnt vmcnt(8)
    s_waitcnt lgkmcnt(8)
    v_mfma_f32_16x16x32_bf16 v[160:163], v[80:83], v[32:35], v[160:163]
    ds_read_b64_tr_b16 v[104:105], v115 offset:8448
    v_mfma_f32_16x16x32_bf16 v[160:163], v[84:87], v[40:43], v[160:163]
    ds_read_b64_tr_b16 v[106:107], v115 offset:10496
    s_add_u32 s58, s48, 24
    s_and_b32 s58, s58, 31
    s_lshl_b32 s58, s58, 10
    s_add_u32 s51, s58, s47
    buffer_load_dwordx4 v[16:19], v120, s[16:19], s51 offen offset:0 sc1
    v_mfma_f32_16x16x32_bf16 v[176:179], v[84:87], v[44:47], v[176:179]
    ds_read_b64_tr_b16 v[108:109], v115 offset:12544
    v_mfma_f32_16x16x32_bf16 v[176:179], v[80:83], v[36:39], v[176:179]
    ds_read_b64_tr_b16 v[110:111], v115 offset:14592
    s_waitcnt lgkmcnt(8)
    v_mfma_f32_16x16x32_bf16 v[164:167], v[88:91], v[32:35], v[164:167]
    ds_read_b64_tr_b16 v[80:81], v114 offset:16384
    v_mfma_f32_16x16x32_bf16 v[164:167], v[92:95], v[40:43], v[164:167]
    ds_read_b64_tr_b16 v[82:83], v114 offset:18432
    buffer_load_dwordx4 v[20:23], v116, s[16:19], s51 offen offset:0 sc1
    v_mfma_f32_16x16x32_bf16 v[180:183], v[92:95], v[44:47], v[180:183]
    ds_read_b64_tr_b16 v[84:85], v114 offset:20480
    v_mfma_f32_16x16x32_bf16 v[180:183], v[88:91], v[36:39], v[180:183]
    ds_read_b64_tr_b16 v[86:87], v114 offset:22528
    s_waitcnt lgkmcnt(8)
    v_mfma_f32_16x16x32_bf16 v[168:171], v[96:99], v[32:35], v[168:171]
    ds_read_b64_tr_b16 v[88:89], v115 offset:16384
    v_mfma_f32_16x16x32_bf16 v[168:171], v[100:103], v[40:43], v[168:171]
    ds_read_b64_tr_b16 v[90:91], v115 offset:18432
    buffer_load_dwordx4 v[24:27], v120, s[16:19], s51 offen offset:1024 sc1
    v_mfma_f32_16x16x32_bf16 v[184:187], v[100:103], v[44:47], v[184:187]
    ds_read_b64_tr_b16 v[92:93], v115 offset:20480
    v_mfma_f32_16x16x32_bf16 v[184:187], v[96:99], v[36:39], v[184:187]
    ds_read_b64_tr_b16 v[94:95], v115 offset:22528
    s_waitcnt lgkmcnt(8)
    v_mfma_f32_16x16x32_bf16 v[172:175], v[104:107], v[32:35], v[172:175]
    ds_read_b64_tr_b16 v[96:97], v114 offset:16640
    v_mfma_f32_16x16x32_bf16 v[172:175], v[108:111], v[40:43], v[172:175]
    ds_read_b64_tr_b16 v[98:99], v114 offset:18688
    buffer_load_dwordx4 v[28:31], v116, s[16:19], s51 offen offset:1024 sc1
    v_mfma_f32_16x16x32_bf16 v[188:191], v[108:111], v[44:47], v[188:191]
    ds_read_b64_tr_b16 v[100:101], v114 offset:20736
    v_mfma_f32_16x16x32_bf16 v[188:191], v[104:107], v[36:39], v[188:191]
    ds_read_b64_tr_b16 v[102:103], v114 offset:22784
    s_waitcnt vmcnt(8)
    s_waitcnt lgkmcnt(8)
    v_mfma_f32_16x16x32_bf16 v[160:163], v[80:83], v[48:51], v[160:163]
    ds_read_b64_tr_b16 v[104:105], v115 offset:16640
    v_mfma_f32_16x16x32_bf16 v[160:163], v[84:87], v[56:59], v[160:163]
    ds_read_b64_tr_b16 v[106:107], v115 offset:18688
    buffer_load_dwordx4 v[32:35], v120, s[16:19], s51 offen offset:2048 sc1
    v_mfma_f32_16x16x32_bf16 v[176:179], v[84:87], v[60:63], v[176:179]
    ds_read_b64_tr_b16 v[108:109], v115 offset:20736
    v_mfma_f32_16x16x32_bf16 v[176:179], v[80:83], v[52:55], v[176:179]
    ds_read_b64_tr_b16 v[110:111], v115 offset:22784
    s_waitcnt lgkmcnt(8)
    v_mfma_f32_16x16x32_bf16 v[164:167], v[88:91], v[48:51], v[164:167]
    ds_read_b64_tr_b16 v[80:81], v114 offset:24576
    v_mfma_f32_16x16x32_bf16 v[164:167], v[92:95], v[56:59], v[164:167]
    ds_read_b64_tr_b16 v[82:83], v114 offset:26624
    buffer_load_dwordx4 v[36:39], v116, s[16:19], s51 offen offset:2048 sc1
    v_mfma_f32_16x16x32_bf16 v[180:183], v[92:95], v[60:63], v[180:183]
    ds_read_b64_tr_b16 v[84:85], v114 offset:28672
    v_mfma_f32_16x16x32_bf16 v[180:183], v[88:91], v[52:55], v[180:183]
    ds_read_b64_tr_b16 v[86:87], v114 offset:30720
    s_waitcnt lgkmcnt(8)
    v_mfma_f32_16x16x32_bf16 v[168:171], v[96:99], v[48:51], v[168:171]
    ds_read_b64_tr_b16 v[88:89], v115 offset:24576
    v_mfma_f32_16x16x32_bf16 v[168:171], v[100:103], v[56:59], v[168:171]
    ds_read_b64_tr_b16 v[90:91], v115 offset:26624
    buffer_load_dwordx4 v[40:43], v120, s[16:19], s51 offen offset:3072 sc1
    v_mfma_f32_16x16x32_bf16 v[184:187], v[100:103], v[60:63], v[184:187]
    ds_read_b64_tr_b16 v[92:93], v115 offset:28672
    v_mfma_f32_16x16x32_bf16 v[184:187], v[96:99], v[52:55], v[184:187]
    ds_read_b64_tr_b16 v[94:95], v115 offset:30720
    s_waitcnt lgkmcnt(8)
    v_mfma_f32_16x16x32_bf16 v[172:175], v[104:107], v[48:51], v[172:175]
    ds_read_b64_tr_b16 v[96:97], v114 offset:24832
    v_mfma_f32_16x16x32_bf16 v[172:175], v[108:111], v[56:59], v[172:175]
    ds_read_b64_tr_b16 v[98:99], v114 offset:26880
    buffer_load_dwordx4 v[44:47], v116, s[16:19], s51 offen offset:3072 sc1
    v_mfma_f32_16x16x32_bf16 v[188:191], v[108:111], v[60:63], v[188:191]
    ds_read_b64_tr_b16 v[100:101], v114 offset:28928
    v_mfma_f32_16x16x32_bf16 v[188:191], v[104:107], v[52:55], v[188:191]
    ds_read_b64_tr_b16 v[102:103], v114 offset:30976
    s_waitcnt vmcnt(8)
    s_waitcnt lgkmcnt(8)
    v_mfma_f32_16x16x32_bf16 v[160:163], v[80:83], v[64:67], v[160:163]
    ds_read_b64_tr_b16 v[104:105], v115 offset:24832
    v_mfma_f32_16x16x32_bf16 v[160:163], v[84:87], v[72:75], v[160:163]
    ds_read_b64_tr_b16 v[106:107], v115 offset:26880
    s_add_u32 s58, s48, 28
    s_and_b32 s58, s58, 31
    s_lshl_b32 s58, s58, 10
    s_add_u32 s51, s58, s47
    buffer_load_dwordx4 v[48:51], v120, s[16:19], s51 offen offset:0 sc1
    v_mfma_f32_16x16x32_bf16 v[176:179], v[84:87], v[76:79], v[176:179]
    ds_read_b64_tr_b16 v[108:109], v115 offset:28928
    v_mfma_f32_16x16x32_bf16 v[176:179], v[80:83], v[68:71], v[176:179]
    ds_read_b64_tr_b16 v[110:111], v115 offset:30976
    s_waitcnt lgkmcnt(8)
    v_mfma_f32_16x16x32_bf16 v[164:167], v[88:91], v[64:67], v[164:167]
    ds_read_b64_tr_b16 v[80:81], v114 offset:32768
    v_mfma_f32_16x16x32_bf16 v[164:167], v[92:95], v[72:75], v[164:167]
    ds_read_b64_tr_b16 v[82:83], v114 offset:34816
    buffer_load_dwordx4 v[52:55], v116, s[16:19], s51 offen offset:0 sc1
    v_mfma_f32_16x16x32_bf16 v[180:183], v[92:95], v[76:79], v[180:183]
    ds_read_b64_tr_b16 v[84:85], v114 offset:36864
    v_mfma_f32_16x16x32_bf16 v[180:183], v[88:91], v[68:71], v[180:183]
    ds_read_b64_tr_b16 v[86:87], v114 offset:38912
    s_waitcnt lgkmcnt(8)
    v_mfma_f32_16x16x32_bf16 v[168:171], v[96:99], v[64:67], v[168:171]
    ds_read_b64_tr_b16 v[88:89], v115 offset:32768
    v_mfma_f32_16x16x32_bf16 v[168:171], v[100:103], v[72:75], v[168:171]
    ds_read_b64_tr_b16 v[90:91], v115 offset:34816
    buffer_load_dwordx4 v[56:59], v120, s[16:19], s51 offen offset:1024 sc1
    v_mfma_f32_16x16x32_bf16 v[184:187], v[100:103], v[76:79], v[184:187]
    ds_read_b64_tr_b16 v[92:93], v115 offset:36864
    v_mfma_f32_16x16x32_bf16 v[184:187], v[96:99], v[68:71], v[184:187]
    ds_read_b64_tr_b16 v[94:95], v115 offset:38912
    s_waitcnt lgkmcnt(8)
    v_mfma_f32_16x16x32_bf16 v[172:175], v[104:107], v[64:67], v[172:175]
    ds_read_b64_tr_b16 v[96:97], v114 offset:33024
    v_mfma_f32_16x16x32_bf16 v[172:175], v[108:111], v[72:75], v[172:175]
    ds_read_b64_tr_b16 v[98:99], v114 offset:35072
    buffer_load_dwordx4 v[60:63], v116, s[16:19], s51 offen offset:1024 sc1
    v_mfma_f32_16x16x32_bf16 v[188:191], v[108:111], v[76:79], v[188:191]
    ds_read_b64_tr_b16 v[100:101], v114 offset:37120
    v_mfma_f32_16x16x32_bf16 v[188:191], v[104:107], v[68:71], v[188:191]
    ds_read_b64_tr_b16 v[102:103], v114 offset:39168
    s_waitcnt vmcnt(8)
    s_waitcnt lgkmcnt(8)
    v_mfma_f32_16x16x32_bf16 v[160:163], v[80:83], v[16:19], v[160:163]
    ds_read_b64_tr_b16 v[104:105], v115 offset:33024
    v_mfma_f32_16x16x32_bf16 v[160:163], v[84:87], v[24:27], v[160:163]
    ds_read_b64_tr_b16 v[106:107], v115 offset:35072
    buffer_load_dwordx4 v[64:67], v120, s[16:19], s51 offen offset:2048 sc1
    v_mfma_f32_16x16x32_bf16 v[176:179], v[84:87], v[28:31], v[176:179]
    ds_read_b64_tr_b16 v[108:109], v115 offset:37120
    v_mfma_f32_16x16x32_bf16 v[176:179], v[80:83], v[20:23], v[176:179]
    ds_read_b64_tr_b16 v[110:111], v115 offset:39168
    s_waitcnt lgkmcnt(8)
    v_mfma_f32_16x16x32_bf16 v[164:167], v[88:91], v[16:19], v[164:167]
    ds_read_b64_tr_b16 v[80:81], v114 offset:40960
    v_mfma_f32_16x16x32_bf16 v[164:167], v[92:95], v[24:27], v[164:167]
    ds_read_b64_tr_b16 v[82:83], v114 offset:43008
    buffer_load_dwordx4 v[68:71], v116, s[16:19], s51 offen offset:2048 sc1
    v_mfma_f32_16x16x32_bf16 v[180:183], v[92:95], v[28:31], v[180:183]
    ds_read_b64_tr_b16 v[84:85], v114 offset:45056
    v_mfma_f32_16x16x32_bf16 v[180:183], v[88:91], v[20:23], v[180:183]
    ds_read_b64_tr_b16 v[86:87], v114 offset:47104
    s_waitcnt lgkmcnt(8)
    v_mfma_f32_16x16x32_bf16 v[168:171], v[96:99], v[16:19], v[168:171]
    ds_read_b64_tr_b16 v[88:89], v115 offset:40960
    v_mfma_f32_16x16x32_bf16 v[168:171], v[100:103], v[24:27], v[168:171]
    ds_read_b64_tr_b16 v[90:91], v115 offset:43008
    buffer_load_dwordx4 v[72:75], v120, s[16:19], s51 offen offset:3072 sc1
    v_mfma_f32_16x16x32_bf16 v[184:187], v[100:103], v[28:31], v[184:187]
    ds_read_b64_tr_b16 v[92:93], v115 offset:45056
    v_mfma_f32_16x16x32_bf16 v[184:187], v[96:99], v[20:23], v[184:187]
    ds_read_b64_tr_b16 v[94:95], v115 offset:47104
    s_waitcnt lgkmcnt(8)
    v_mfma_f32_16x16x32_bf16 v[172:175], v[104:107], v[16:19], v[172:175]
    ds_read_b64_tr_b16 v[96:97], v114 offset:41216
    v_mfma_f32_16x16x32_bf16 v[172:175], v[108:111], v[24:27], v[172:175]
    ds_read_b64_tr_b16 v[98:99], v114 offset:43264
    buffer_load_dwordx4 v[76:79], v116, s[16:19], s51 offen offset:3072 sc1
    v_mfma_f32_16x16x32_bf16 v[188:191], v[108:111], v[28:31], v[188:191]
    ds_read_b64_tr_b16 v[100:101], v114 offset:45312
    v_mfma_f32_16x16x32_bf16 v[188:191], v[104:107], v[20:23], v[188:191]
    ds_read_b64_tr_b16 v[102:103], v114 offset:47360
    s_waitcnt vmcnt(8)
    s_waitcnt lgkmcnt(8)
    v_mfma_f32_16x16x32_bf16 v[160:163], v[80:83], v[32:35], v[160:163]
    ds_read_b64_tr_b16 v[104:105], v115 offset:41216
    v_mfma_f32_16x16x32_bf16 v[160:163], v[84:87], v[40:43], v[160:163]
    ds_read_b64_tr_b16 v[106:107], v115 offset:43264
    v_mfma_f32_16x16x32_bf16 v[176:179], v[84:87], v[44:47], v[176:179]
    ds_read_b64_tr_b16 v[108:109], v115 offset:45312
    v_mfma_f32_16x16x32_bf16 v[176:179], v[80:83], v[36:39], v[176:179]
    ds_read_b64_tr_b16 v[110:111], v115 offset:47360
    s_waitcnt lgkmcnt(8)
    v_mfma_f32_16x16x32_bf16 v[164:167], v[88:91], v[32:35], v[164:167]
    ds_read_b64_tr_b16 v[80:81], v114 offset:49152
    v_mfma_f32_16x16x32_bf16 v[164:167], v[92:95], v[40:43], v[164:167]
    ds_read_b64_tr_b16 v[82:83], v114 offset:51200
    v_mfma_f32_16x16x32_bf16 v[180:183], v[92:95], v[44:47], v[180:183]
    ds_read_b64_tr_b16 v[84:85], v114 offset:53248
    v_mfma_f32_16x16x32_bf16 v[180:183], v[88:91], v[36:39], v[180:183]
    ds_read_b64_tr_b16 v[86:87], v114 offset:55296
    s_waitcnt lgkmcnt(8)
    v_mfma_f32_16x16x32_bf16 v[168:171], v[96:99], v[32:35], v[168:171]
    ds_read_b64_tr_b16 v[88:89], v115 offset:49152
    v_mfma_f32_16x16x32_bf16 v[168:171], v[100:103], v[40:43], v[168:171]
    ds_read_b64_tr_b16 v[90:91], v115 offset:51200
    v_mfma_f32_16x16x32_bf16 v[184:187], v[100:103], v[44:47], v[184:187]
    ds_read_b64_tr_b16 v[92:93], v115 offset:53248
    v_mfma_f32_16x16x32_bf16 v[184:187], v[96:99], v[36:39], v[184:187]
    ds_read_b64_tr_b16 v[94:95], v115 offset:55296
    s_waitcnt lgkmcnt(8)
    v_mfma_f32_16x16x32_bf16 v[172:175], v[104:107], v[32:35], v[172:175]
    ds_read_b64_tr_b16 v[96:97], v114 offset:49408
    v_mfma_f32_16x16x32_bf16 v[172:175], v[108:111], v[40:43], v[172:175]
    ds_read_b64_tr_b16 v[98:99], v114 offset:51456
    v_mfma_f32_16x16x32_bf16 v[188:191], v[108:111], v[44:47], v[188:191]
    ds_read_b64_tr_b16 v[100:101], v114 offset:53504
    v_mfma_f32_16x16x32_bf16 v[188:191], v[104:107], v[36:39], v[188:191]
    ds_read_b64_tr_b16 v[102:103], v114 offset:55552
    s_waitcnt vmcnt(4)
    s_waitcnt lgkmcnt(8)
    v_mfma_f32_16x16x32_bf16 v[160:163], v[80:83], v[48:51], v[160:163]
    ds_read_b64_tr_b16 v[104:105], v115 offset:49408
    v_mfma_f32_16x16x32_bf16 v[160:163], v[84:87], v[56:59], v[160:163]
    ds_read_b64_tr_b16 v[106:107], v115 offset:51456
    v_mfma_f32_16x16x32_bf16 v[176:179], v[84:87], v[60:63], v[176:179]
    ds_read_b64_tr_b16 v[108:109], v115 offset:53504
    v_mfma_f32_16x16x32_bf16 v[176:179], v[80:83], v[52:55], v[176:179]
    ds_read_b64_tr_b16 v[110:111], v115 offset:55552
    ds_read_b32 v4, v122 offset:24
    s_waitcnt lgkmcnt(9)
    v_mfma_f32_16x16x32_bf16 v[164:167], v[88:91], v[48:51], v[164:167]
    ds_read_b64_tr_b16 v[80:81], v114 offset:57344
    v_mfma_f32_16x16x32_bf16 v[164:167], v[92:95], v[56:59], v[164:167]
    ds_read_b64_tr_b16 v[82:83], v114 offset:59392
    v_mfma_f32_16x16x32_bf16 v[180:183], v[92:95], v[60:63], v[180:183]
    ds_read_b64_tr_b16 v[84:85], v114 offset:61440
    v_mfma_f32_16x16x32_bf16 v[180:183], v[88:91], v[52:55], v[180:183]
    ds_read_b64_tr_b16 v[86:87], v114 offset:63488
    s_waitcnt lgkmcnt(9)
    v_mfma_f32_16x16x32_bf16 v[168:171], v[96:99], v[48:51], v[168:171]
    ds_read_b64_tr_b16 v[88:89], v115 offset:57344
    v_mfma_f32_16x16x32_bf16 v[168:171], v[100:103], v[56:59], v[168:171]
    ds_read_b64_tr_b16 v[90:91], v115 offset:59392
    v_mfma_f32_16x16x32_bf16 v[184:187], v[100:103], v[60:63], v[184:187]
    ds_read_b64_tr_b16 v[92:93], v115 offset:61440
    v_mfma_f32_16x16x32_bf16 v[184:187], v[96:99], v[52:55], v[184:187]
    ds_read_b64_tr_b16 v[94:95], v115 offset:63488
    s_waitcnt lgkmcnt(9)
    v_mfma_f32_16x16x32_bf16 v[172:175], v[104:107], v[48:51], v[172:175]
    ds_read_b64_tr_b16 v[96:97], v114 offset:57600
    v_mfma_f32_16x16x32_bf16 v[172:175], v[108:111], v[56:59], v[172:175]
    ds_read_b64_tr_b16 v[98:99], v114 offset:59648
    v_mfma_f32_16x16x32_bf16 v[188:191], v[108:111], v[60:63], v[188:191]
    ds_read_b64_tr_b16 v[100:101], v114 offset:61696
    v_mfma_f32_16x16x32_bf16 v[188:191], v[104:107], v[52:55], v[188:191]
    ds_read_b64_tr_b16 v[102:103], v114 offset:63744
    s_waitcnt vmcnt(0)
    s_waitcnt lgkmcnt(8)
    v_mfma_f32_16x16x32_bf16 v[160:163], v[80:83], v[64:67], v[160:163]
    ds_read_b64_tr_b16 v[104:105], v115 offset:57600
    v_mfma_f32_16x16x32_bf16 v[160:163], v[84:87], v[72:75], v[160:163]
    ds_read_b64_tr_b16 v[106:107], v115 offset:59648
    v_mfma_f32_16x16x32_bf16 v[176:179], v[84:87], v[76:79], v[176:179]
    ds_read_b64_tr_b16 v[108:109], v115 offset:61696
    v_mfma_f32_16x16x32_bf16 v[176:179], v[80:83], v[68:71], v[176:179]
    ds_read_b64_tr_b16 v[110:111], v115 offset:63744
    s_waitcnt lgkmcnt(8)
    v_mfma_f32_16x16x32_bf16 v[164:167], v[88:91], v[64:67], v[164:167]
    v_mfma_f32_16x16x32_bf16 v[164:167], v[92:95], v[72:75], v[164:167]
    v_mfma_f32_16x16x32_bf16 v[180:183], v[92:95], v[76:79], v[180:183]
    v_mfma_f32_16x16x32_bf16 v[180:183], v[88:91], v[68:71], v[180:183]
    s_waitcnt lgkmcnt(4)
    v_mfma_f32_16x16x32_bf16 v[168:171], v[96:99], v[64:67], v[168:171]
    v_mfma_f32_16x16x32_bf16 v[168:171], v[100:103], v[72:75], v[168:171]
    v_mfma_f32_16x16x32_bf16 v[184:187], v[100:103], v[76:79], v[184:187]
    v_mfma_f32_16x16x32_bf16 v[184:187], v[96:99], v[68:71], v[184:187]
    s_waitcnt lgkmcnt(0)
    v_mfma_f32_16x16x32_bf16 v[172:175], v[104:107], v[64:67], v[172:175]
    v_mfma_f32_16x16x32_bf16 v[172:175], v[108:111], v[72:75], v[172:175]
    v_mfma_f32_16x16x32_bf16 v[188:191], v[108:111], v[76:79], v[188:191]
    v_mfma_f32_16x16x32_bf16 v[188:191], v[104:107], v[68:71], v[188:191]
    s_mul_i32 s58, s27, 4608
    s_add_u32 s58, s58, 65536
    v_mul_u32_u24 v2, 144, v12
    v_lshl_add_u32 v2, v13, 3, v2
    v_add_u32 v2, s58, v2
    v_lshrrev_b32 v3, 3, v1
    v_mul_u32_u24 v3, 144, v3
    v_and_b32 v7, 7, v1
    v_lshl_add_u32 v3, v7, 4, v3
    v_add_u32 v3, s58, v3
    v_cmp_ne_u32 vcc, 0x1010101, v4
    s_nop 1
    s_cbranch_vccnz L_cs112
L_cb113:
    v_cvt_pk_bf16_f32 v16, v160, v161
    v_cvt_pk_bf16_f32 v17, v162, v163
    ds_write_b64 v2, v[16:17] offset:0
    v_cvt_pk_bf16_f32 v18, v164, v165
    v_cvt_pk_bf16_f32 v19, v166, v167
    ds_write_b64 v2, v[18:19] offset:32
    v_cvt_pk_bf16_f32 v20, v168, v169
    v_cvt_pk_bf16_f32 v21, v170, v171
    ds_write_b64 v2, v[20:21] offset:64
    v_cvt_pk_bf16_f32 v22, v172, v173
    v_cvt_pk_bf16_f32 v23, v174, v175
    ds_write_b64 v2, v[22:23] offset:96
    v_cvt_pk_bf16_f32 v24, v176, v177
    v_cvt_pk_bf16_f32 v25, v178, v179
    ds_write_b64 v2, v[24:25] offset:2304
    v_cvt_pk_bf16_f32 v26, v180, v181
    v_cvt_pk_bf16_f32 v27, v182, v183
    ds_write_b64 v2, v[26:27] offset:2336
    v_cvt_pk_bf16_f32 v28, v184, v185
    v_cvt_pk_bf16_f32 v29, v186, v187
    ds_write_b64 v2, v[28:29] offset:2368
    v_cvt_pk_bf16_f32 v30, v188, v189
    v_cvt_pk_bf16_f32 v31, v190, v191
    ds_write_b64 v2, v[30:31] offset:2400
    s_waitcnt lgkmcnt(0)
    ds_read_b128 v[32:35], v3 offset:0
    ds_read_b128 v[36:39], v3 offset:1152
    ds_read_b128 v[40:43], v3 offset:2304
    ds_read_b128 v[44:47], v3 offset:3456
    s_sub_u32 s52, s72, s38
    s_cmp_lt_u32 s52, 32
    s_cbranch_scc0 L_no_moe
    s_mov_b32 s57, 0
L_sl115:
    ds_read_b32 v5, v122 offset:64
    s_waitcnt lgkmcnt(0)
    v_cmp_ne_u32 vcc, 0x1, v5
    s_add_u32 s57, s57, 1
    s_nop 0
    s_cbranch_vccz L_sld116
    s_sleep 1
    s_cmp_lt_u32 s57, 262144
    s_cbranch_scc1 L_sl115
L_sld116:
    v_lshlrev_b32 v4, 5, v7
    v_add_u32 v4, 134912, v4
    ds_read_b128 v[48:51], v4
    ds_read_b128 v[52:55], v4 offset:16
    v_lshrrev_b32 v5, 3, v1
    s_waitcnt lgkmcnt(0)
    v_add_u32 v7, 0, v5
    v_cmp_eq_u32 vcc, s52, v7
    s_nop 1
    v_cndmask_b32 v56, 0, v48, vcc
    v_add_f32 v128, v128, v56
    v_cndmask_b32 v56, 0, v49, vcc
    v_add_f32 v129, v129, v56
    v_cndmask_b32 v56, 0, v50, vcc
    v_add_f32 v130, v130, v56
    v_cndmask_b32 v56, 0, v51, vcc
    v_add_f32 v131, v131, v56
    v_cndmask_b32 v56, 0, v52, vcc
    v_add_f32 v132, v132, v56
    v_cndmask_b32 v56, 0, v53, vcc
    v_add_f32 v133, v133, v56
    v_cndmask_b32 v56, 0, v54, vcc
    v_add_f32 v134, v134, v56
    v_cndmask_b32 v56, 0, v55, vcc
    v_add_f32 v135, v135, v56
    v_add_u32 v7, 8, v5
    v_cmp_eq_u32 vcc, s52, v7
    s_nop 1
    v_cndmask_b32 v56, 0, v48, vcc
    v_add_f32 v136, v136, v56
    v_cndmask_b32 v56, 0, v49, vcc
    v_add_f32 v137, v137, v56
    v_cndmask_b32 v56, 0, v50, vcc
    v_add_f32 v138, v138, v56
    v_cndmask_b32 v56, 0, v51, vcc
    v_add_f32 v139, v139, v56
    v_cndmask_b32 v56, 0, v52, vcc
    v_add_f32 v140, v140, v56
    v_cndmask_b32 v56, 0, v53, vcc
    v_add_f32 v141, v141, v56
    v_cndmask_b32 v56, 0, v54, vcc
    v_add_f32 v142, v142, v56
    v_cndmask_b32 v56, 0, v55, vcc
    v_add_f32 v143, v143, v56
    v_add_u32 v7, 16, v5
    v_cmp_eq_u32 vcc, s52, v7
    s_nop 1
    v_cndmask_b32 v56, 0, v48, vcc
    v_add_f32 v144, v144, v56
    v_cndmask_b32 v56, 0, v49, vcc
    v_add_f32 v145, v145, v56
    v_cndmask_b32 v56, 0, v50, vcc
    v_add_f32 v146, v146, v56
    v_cndmask_b32 v56, 0, v51, vcc
    v_add_f32 v147, v147, v56
    v_cndmask_b32 v56, 0, v52, vcc
    v_add_f32 v148, v148, v56
    v_cndmask_b32 v56, 0, v53, vcc
    v_add_f32 v149, v149, v56
    v_cndmask_b32 v56, 0, v54, vcc
    v_add_f32 v150, v150, v56
    v_cndmask_b32 v56, 0, v55, vcc
    v_add_f32 v151, v151, v56
    v_add_u32 v7, 24, v5
    v_cmp_eq_u32 vcc, s52, v7
    s_nop 1
    v_cndmask_b32 v56, 0, v48, vcc
    v_add_f32 v152, v152, v56
    v_cndmask_b32 v56, 0, v49, vcc
    v_add_f32 v153, v153, v56
    v_cndmask_b32 v56, 0, v50, vcc
    v_add_f32 v154, v154, v56
    v_cndmask_b32 v56, 0, v51, vcc
    v_add_f32 v155, v155, v56
    v_cndmask_b32 v56, 0, v52, vcc
    v_add_f32 v156, v156, v56
    v_cndmask_b32 v56, 0, v53, vcc
    v_add_f32 v157, v157, v56
    v_cndmask_b32 v56, 0, v54, vcc
    v_add_f32 v158, v158, v56
    v_cndmask_b32 v56, 0, v55, vcc
    v_add_f32 v159, v159, v56
L_no_moe:
    s_waitcnt lgkmcnt(0)
    v_lshlrev_b32 v60, 16, v32
    v_lshlrev_b32 v62, 16, v33
    v_lshlrev_b32 v64, 16, v34
    v_lshlrev_b32 v66, 16, v35
    v_and_b32 v61, 0xffff0000, v32
    v_and_b32 v63, 0xffff0000, v33
    v_and_b32 v65, 0xffff0000, v34
    v_and_b32 v67, 0xffff0000, v35
    v_pk_add_f32 v[60:61], v[60:61], v[128:129]
    v_pk_add_f32 v[62:63], v[62:63], v[130:131]
    v_pk_add_f32 v[64:65], v[64:65], v[132:133]
    v_pk_add_f32 v[66:67], v[66:67], v[134:135]
    v_cvt_pk_bf16_f32 v32, v60, v61
    v_cvt_pk_bf16_f32 v33, v62, v63
    v_cvt_pk_bf16_f32 v34, v64, v65
    v_cvt_pk_bf16_f32 v35, v66, v67
    buffer_store_dwordx4 v[32:35], v118, s[32:35], s39 offen sc1
    s_add_u32 s39, s39, 16384
    v_lshlrev_b32 v60, 16, v36
    v_lshlrev_b32 v62, 16, v37
    v_lshlrev_b32 v64, 16, v38
    v_lshlrev_b32 v66, 16, v39
    v_and_b32 v61, 0xffff0000, v36
    v_and_b32 v63, 0xffff0000, v37
    v_and_b32 v65, 0xffff0000, v38
    v_and_b32 v67, 0xffff0000, v39
    v_pk_add_f32 v[60:61], v[60:61], v[136:137]
    v_pk_add_f32 v[62:63], v[62:63], v[138:139]
    v_pk_add_f32 v[64:65], v[64:65], v[140:141]
    v_pk_add_f32 v[66:67], v[66:67], v[142:143]
    v_cvt_pk_bf16_f32 v36, v60, v61
    v_cvt_pk_bf16_f32 v37, v62, v63
    v_cvt_pk_bf16_f32 v38, v64, v65
    v_cvt_pk_bf16_f32 v39, v66, v67
    buffer_store_dwordx4 v[36:39], v118, s[32:35], s39 offen sc1
    s_add_u32 s39, s39, 16384
    v_lshlrev_b32 v60, 16, v40
    v_lshlrev_b32 v62, 16, v41
    v_lshlrev_b32 v64, 16, v42
    v_lshlrev_b32 v66, 16, v43
    v_and_b32 v61, 0xffff0000, v40
    v_and_b32 v63, 0xffff0000, v41
    v_and_b32 v65, 0xffff0000, v42
    v_and_b32 v67, 0xffff0000, v43
    v_pk_add_f32 v[60:61], v[60:61], v[144:145]
    v_pk_add_f32 v[62:63], v[62:63], v[146:147]
    v_pk_add_f32 v[64:65], v[64:65], v[148:149]
    v_pk_add_f32 v[66:67], v[66:67], v[150:151]
    v_cvt_pk_bf16_f32 v40, v60, v61
    v_cvt_pk_bf16_f32 v41, v62, v63
    v_cvt_pk_bf16_f32 v42, v64, v65
    v_cvt_pk_bf16_f32 v43, v66, v67
    buffer_store_dwordx4 v[40:43], v118, s[32:35], s39 offen sc1
    s_add_u32 s39, s39, 16384
    v_lshlrev_b32 v60, 16, v44
    v_lshlrev_b32 v62, 16, v45
    v_lshlrev_b32 v64, 16, v46
    v_lshlrev_b32 v66, 16, v47
    v_and_b32 v61, 0xffff0000, v44
    v_and_b32 v63, 0xffff0000, v45
    v_and_b32 v65, 0xffff0000, v46
    v_and_b32 v67, 0xffff0000, v47
    v_pk_add_f32 v[60:61], v[60:61], v[152:153]
    v_pk_add_f32 v[62:63], v[62:63], v[154:155]
    v_pk_add_f32 v[64:65], v[64:65], v[156:157]
    v_pk_add_f32 v[66:67], v[66:67], v[158:159]
    v_cvt_pk_bf16_f32 v44, v60, v61
    v_cvt_pk_bf16_f32 v45, v62, v63
    v_cvt_pk_bf16_f32 v46, v64, v65
    v_cvt_pk_bf16_f32 v47, v66, v67
    buffer_store_dwordx4 v[44:47], v118, s[32:35], s39 offen sc1
L_end:
    s_endpgm
L_cs109:
    s_mov_b32 s57, 0
L_cp111:
    ds_read_b32 v4, v122 offset:0
    s_waitcnt lgkmcnt(0)
    v_cmp_ne_u32 vcc, 0x1010101, v4
    s_add_u32 s57, s57, 1
    s_nop 0
    s_cbranch_vccz L_cb110
    s_cmp_lt_u32 s57, 524288
    s_cbranch_scc1 L_cp111
    s_branch L_cb110
L_cs112:
    s_mov_b32 s57, 0
L_cp114:
    ds_read_b32 v4, v122 offset:24
    s_waitcnt lgkmcnt(0)
    v_cmp_ne_u32 vcc, 0x1010101, v4
    s_add_u32 s57, s57, 1
    s_nop 0
    s_cbranch_vccz L_cb113
    s_cmp_lt_u32 s57, 524288
    s_cbranch_scc1 L_cp114
    s_branch L_cb113
.section .rodata,"a"
.p2align 6
.amdhsa_kernel parallel_sum__linear_attn_block__moe_arch_mod__prompt_kernel
  .amdhsa_next_free_vgpr 256
  .amdhsa_next_free_sgpr 102
  .amdhsa_accum_offset 256
  .amdhsa_group_segment_fixed_size 0
  .amdhsa_kernarg_size 88
  .amdhsa_user_sgpr_count 2
  .amdhsa_user_sgpr_kernarg_segment_ptr 1
  .amdhsa_system_sgpr_workgroup_id_x 1
  .amdhsa_float_denorm_mode_32 3
.end_amdhsa_kernel
```
